```python
import torch

def _softmax(x, axis=-1):
    return torch.softmax(x, dim=axis)
def _gelu(x):
    return torch.nn.functional.gelu(x, approximate="tanh")
def _silu(x):
    return torch.nn.functional.silu(x)
def _sigmoid(x):
    return torch.sigmoid(x)
def _layernorm(x, axis=-1, eps=1e-5):
    m = x.mean(dim=axis, keepdim=True)
    v = x.var(dim=axis, keepdim=True, unbiased=False)
    return (x - m) / torch.sqrt(v + eps)
def _scatter_add(tgt, idx, src, axis=0):
    return tgt.clone().index_add_(axis, idx, src)
def _segment_sum(src, seg, n):
    out = torch.zeros((n,) + src.shape[1:], dtype=src.dtype)
    return out.index_add_(0, seg, src)
def _pad(x, pw):
    flat = tuple(v for pair in reversed(pw) for v in pair)
    return torch.nn.functional.pad(x, flat)

kernel_name = 'interleave_layers__spectral_gfnet__glu_gated_reglu__prompt'

def setup_inputs():

    _w = (lambda a: (lambda t: t.to(torch.bfloat16) if t.is_floating_point() else t)(torch.as_tensor(a)))
    def _A_setup():
        B, S, D = 1, 2048, 640
        Df = D // 2 + 1
        return {
            "x": _w((lambda *s: torch.randn(*s, dtype=torch.bfloat16) * 0.05)(B, S, D)),
            "w_r": _w((lambda *s: torch.randn(*s, dtype=torch.bfloat16) * 0.4)(S, Df) * 0.02),
            "w_i": _w((lambda *s: torch.randn(*s, dtype=torch.bfloat16) * 0.4)(S, Df) * 0.02),
        }
    _A_in = _A_setup()

    def _B_setup():
        B, S, D, F = 1, 2048, 640, 1536
        return {
            "x": _w((lambda *s: torch.randn(*s, dtype=torch.bfloat16) * 0.05)(B, S, D)),
            "W_gate": _w((lambda *s: torch.randn(*s, dtype=torch.bfloat16) * 0.2)(D, F) * (2.0 / D) ** 0.5),
            "W_up": _w((lambda *s: torch.randn(*s, dtype=torch.bfloat16) * 0.2)(D, F) * (2.0 / D) ** 0.5),
            "W_down": _w((lambda *s: torch.randn(*s, dtype=torch.bfloat16) * 0.2)(F, D) * (1.0 / F) ** 0.5),
        }
    _B_in = _B_setup()

    return {
        "A_x": _A_in["x"],
        "A_w_r": _A_in["w_r"],
        "A_w_i": _A_in["w_i"],
        "B_x": _B_in["x"],
        "B_W_gate": _B_in["W_gate"],
        "B_W_up": _B_in["W_up"],
        "B_W_down": _B_in["W_down"],
    }

def reference(A_x, A_w_r, A_w_i, B_x, B_W_gate, B_W_up, B_W_down):
    def _A_ref(x, w_r, w_i):
        B, S, D = x.shape
        X = (lambda x, axes=(-2,-1): torch.fft.rfft2(x.float(), dim=axes))(x, axes=(-2, -1))
        W = w_r + 1j * w_i
        X = X * W
        y = (lambda x, s, axes=(-2,-1): torch.fft.irfft2(x, s=s, dim=axes).to(torch.bfloat16))(X, (S, D), axes=(-2, -1))
        return y

    def _B_ref(x, W_gate, W_up, W_down):
        gate = torch.einsum("bsd,df->bsf", x, W_gate)
        up = torch.einsum("bsd,df->bsf", x, W_up)
        gate = gate * (lambda x, dt: x.to(dt))(gate > 0, gate.dtype)
        h = gate * up
        return torch.einsum("bsf,fd->bsd", h, W_down)

    x = A_x
    x = x + _A_ref(_layernorm(x, axis=-1), A_w_r, A_w_i)
    x = x + _B_ref(_layernorm(x, axis=-1), B_W_gate, B_W_up, B_W_down)
    x = x + _A_ref(_layernorm(x, axis=-1), A_w_r, A_w_i)
    x = x + _B_ref(_layernorm(x, axis=-1), B_W_gate, B_W_up, B_W_down)
    return x
```

```asm
; @launch grid=(256,1,1) block=(256,1,1) lds=163840
.amdgcn_target "amdgcn-amd-amdhsa--gfx950"
.text
.globl interleave_layers__spectral_gfnet__glu_gated_reglu__prompt_kernel
.p2align 12
.p2align 8
.type interleave_layers__spectral_gfnet__glu_gated_reglu__prompt_kernel,@function
interleave_layers__spectral_gfnet__glu_gated_reglu__prompt_kernel:
    s_cmp_lt_u32 s2, 256
    s_cbranch_scc1 L_go
    s_endpgm
L_go:
    s_load_dwordx16 s[4:19], s[0:1], 0
    s_load_dwordx4 s[20:23], s[0:1], 64
    s_getpc_b64 s[28:29]
L_pc:
    s_mov_b32 s30, L_text_end-L_pc
    s_mov_b32 s31, 0x20000
    s_lshr_b32 s3, s2, 3
    s_lshl_b32 s3, s3, 7
    v_lshrrev_b32 v5, 4, v0
    v_lshlrev_b32 v5, 12, v5
    buffer_load_dword v5, v5, s[28:31], s3 offen
    v_lshrrev_b32 v1, 6, v0
    s_nop 0
    v_readfirstlane_b32 s32, v1
    s_and_b32 s33, s2, 7
    s_lshr_b32 s34, s2, 3
    v_and_b32 v1, 63, v0
    v_and_b32 v2, 15, v0
    v_lshrrev_b32 v3, 4, v1
    v_lshlrev_b32 v4, 4, v1
    s_lshr_b32 s35, s33, 2
    s_lshl_b32 s35, s35, 3
    s_and_b32 s46, s34, 7
    s_add_u32 s35, s35, s46
    s_and_b32 s36, s33, 3
    s_lshl_b32 s36, s36, 2
    s_lshr_b32 s46, s34, 3
    s_add_u32 s36, s36, s46
    s_mul_i32 s43, s33, 512
    s_add_u32 s43, s43, 0
    s_and_b32 s97, s2, 15
    s_mul_i32 s97, s97, 4096
    s_add_u32 s97, s97, 0
    s_waitcnt lgkmcnt(0)
    s_add_u32 s22, s22, 0x3ffffff
    s_addc_u32 s23, s23, 0
    s_and_b32 s22, s22, 0xfc000000
    s_mov_b32 s24, s22
    s_mov_b32 s25, s23
    s_mov_b32 s26, 34668544
    s_mov_b32 s27, 0x20000
    s_and_b32 s46, s34, 15
    s_lshl4_add_u32 s37, s33, s46
    s_cmp_ge_u32 s34, 16
    s_cbranch_scc1 L_a_nx
    s_and_b32 s46, s37, -8
    s_lshl1_add_u32 s46, s32, s46
    s_and_b32 s47, s37, 7
    s_lshl2_add_u32 s46, s46, s47
    s_lshl_b32 s46, s46, 2
    s_mov_b32 s28, s4
    s_mov_b32 s29, s5
    s_mov_b32 s30, 2621440
    s_mov_b32 s31, 0x20000
    s_mul_i32 s47, s32, 5120
    s_mul_i32 s46, s46, 1280
    s_add_u32 m0, s47, 0
    s_add_u32 s62, s47, 3072
    buffer_load_dwordx4 v4, s[28:31], s46 offen offset:0 nt lds
    buffer_load_dwordx4 v4, s[28:31], s46 offen offset:1024 nt lds
    buffer_load_dwordx4 v4, s[28:31], s46 offen offset:2048 nt lds
    s_add_u32 s63, s46, 3072
    s_branch L_a_c
L_a_nx:
    s_lshl2_add_u32 s46, s34, s32
    s_cmp_lg_u32 s46, 115
    s_cbranch_scc1 L_a_nc
    v_mov_b32 v8, 0
    v_mov_b32 v9, 0
    v_mov_b32 v10, 0
    v_mov_b32 v11, 0
    v_lshrrev_b32 v12, 3, v1
    v_mul_u32_u24 v12, 384, v12
    v_add_u32 v12, v12, v4
    s_mul_i32 s46, s33, 4096
    buffer_store_dwordx4 v[8:11], v12, s[24:27], s46 offen sc1
    s_add_u32 s46, s46, 32768
    buffer_store_dwordx4 v[8:11], v12, s[24:27], s46 offen sc1
    s_add_u32 s46, s46, 32768
    s_mul_i32 s46, s33, 4096
    buffer_store_dwordx4 v[8:11], v12, s[24:27], s46 offen offset:128 sc1
    global_load_ubyte v7, v2, s[20:21] offset:128
L_a_nc:
    s_bitcmp0_b32 s37, 0
    s_cselect_b32 s28, s6, s8
    s_cselect_b32 s29, s7, s9
    s_mov_b32 s30, 1314816
    s_mov_b32 s31, 0x20000
    s_and_b32 s47, s37, 6
    s_and_b32 s48, s32, 1
    s_add_u32 s47, s47, s48
    s_and_b32 s48, s32, 2
    s_lshl2_add_u32 s47, s48, s47
    s_lshl_b32 s47, s47, 5
    s_lshr_b32 s48, s37, 3
    s_add_u32 s47, s47, s48
    s_mul_i32 s47, s47, 2568
    s_and_b32 s47, s47, -16
    s_mul_i32 m0, s32, 5152
    s_add_u32 s63, s47, 41088
    buffer_load_dwordx4 v4, s[28:31], s47 offen offset:0 nt lds
    buffer_load_dwordx4 v4, s[28:31], s47 offen offset:1024 nt lds
    s_mov_b32 exec_hi, 1
    buffer_load_dwordx4 v4, s[28:31], s47 offen offset:2048 nt lds
    s_mov_b32 exec_hi, -1
    s_add_u32 s62, m0, 2576
L_a_c:
    v_mul_u32_u24 v93, 512, v2
    v_and_b32 v94, 28, v1
    v_mov_b32 v203, -1
    v_mov_b32 v204, -1
    v_mov_b32 v205, -1
    v_mov_b32 v206, -1
    v_lshlrev_b32 v184, 2, v3
    v_cvt_f32_u32 v184, v184
    v_cvt_f32_u32 v186, v2
    v_mul_f32 v185, 0x3d4ccccd, v186
    v_mul_f32 v216, v185, v184
    v_add_f32 v217, v216, v185
    v_fma_f32 v218, v185, 2.0, v216
    v_fma_f32 v219, v185, 2.0, v217
    v_mul_f32 v220, 0x41800000, v185
    v_add_f32 v221, v220, v185
    v_fma_f32 v222, v185, 2.0, v220
    v_fma_f32 v223, v185, 2.0, v221
    v_mov_b32 v252, 0x3d64f92e
    v_cmp_gt_u32 vcc, 16, v1
    s_nop 1
    v_cndmask_b32 v253, 0, v252, vcc
    v_cos_f32 v224, v216
    v_sin_f32 v216, v216
    v_cos_f32 v225, v217
    v_sin_f32 v217, v217
    v_cos_f32 v226, v218
    v_sin_f32 v218, v218
    v_cos_f32 v227, v219
    v_sin_f32 v219, v219
    v_cos_f32 v228, v220
    v_sin_f32 v220, v220
    v_cos_f32 v229, v221
    v_sin_f32 v221, v221
    v_cos_f32 v230, v222
    v_sin_f32 v222, v222
    v_cos_f32 v231, v223
    v_sin_f32 v223, v223
    v_mul_f32 v224, v224, v252
    v_mul_f32 v216, v216, v252
    v_mul_f32 v225, v225, v252
    v_mul_f32 v217, v217, v252
    v_mul_f32 v226, v226, v252
    v_mul_f32 v218, v218, v252
    v_mul_f32 v227, v227, v252
    v_mul_f32 v219, v219, v252
    v_mul_f32 v228, v228, v253
    v_mul_f32 v220, v220, v253
    v_mul_f32 v229, v229, v253
    v_mul_f32 v221, v221, v253
    v_mul_f32 v230, v230, v253
    v_mul_f32 v222, v222, v253
    v_mul_f32 v231, v231, v253
    v_mul_f32 v223, v223, v253
    v_cvt_pk_bf16_f32 v96, v224, v225
    v_cvt_pk_bf16_f32 v100, -v216, -v217
    v_cvt_pk_bf16_f32 v97, v226, v227
    v_cvt_pk_bf16_f32 v101, -v218, -v219
    v_cvt_pk_bf16_f32 v98, v228, v229
    v_cvt_pk_bf16_f32 v102, -v220, -v221
    v_cvt_pk_bf16_f32 v99, v230, v231
    v_cvt_pk_bf16_f32 v103, -v222, -v223
L_ha_1:
    s_bitcmp1_b32 s32, 0
    s_cselect_b32 s51, 0x80008000, 0
    s_cselect_b32 s52, 0, 0x80008000
    s_cselect_b32 s53, 320, 0
    s_lshr_b32 s47, s32, 1
    s_add_u32 s53, s53, s47
    s_cmp_eq_u32 s32, 1
    s_cselect_b32 s48, 10, s47
    s_add_u32 s53, s53, 2
    v_mad_u32_u24 v185, v2, 20, s53
    v_cvt_f32_u32 v185, v185
    v_mul_f32 v185, 0x3acccccd, v185
    v_mul_f32 v216, v185, v184
    v_add_f32 v217, v216, v185
    v_fma_f32 v218, v185, 2.0, v216
    v_fma_f32 v219, v185, 2.0, v217
    v_mul_f32 v248, 0x41800000, v185
    v_add_f32 v220, v216, v248
    v_add_f32 v221, v217, v248
    v_add_f32 v222, v218, v248
    v_add_f32 v223, v219, v248
    v_mov_b32 v185, 0x3b4ccccd
    v_mul_f32 v224, v185, v184
    v_add_f32 v225, v224, v185
    v_fma_f32 v226, v185, 2.0, v224
    v_fma_f32 v227, v185, 2.0, v225
    v_mul_f32 v248, 0x41800000, v185
    v_add_f32 v228, v224, v248
    v_add_f32 v229, v225, v248
    v_add_f32 v230, v226, v248
    v_add_f32 v231, v227, v248
    v_cos_f32 v24, v216
    v_sin_f32 v32, v216
    v_cos_f32 v25, v217
    v_sin_f32 v33, v217
    v_cos_f32 v26, v218
    v_sin_f32 v34, v218
    v_cos_f32 v27, v219
    v_sin_f32 v35, v219
    v_cos_f32 v28, v220
    v_sin_f32 v36, v220
    v_cos_f32 v29, v221
    v_sin_f32 v37, v221
    v_cos_f32 v30, v222
    v_sin_f32 v38, v222
    v_cos_f32 v31, v223
    v_sin_f32 v39, v223
    s_cmp_lt_u32 s34, 16
    s_cbranch_scc0 L_ha_2
    s_mov_b32 m0, s62
    s_nop 0
    buffer_load_dwordx4 v4, s[28:31], s63 offen offset:0 nt lds
    buffer_load_dwordx4 v4, s[28:31], s63 offen offset:1024 nt lds
L_ha_2:
    v_cos_f32 v232, v224
    v_sin_f32 v240, v224
    v_cos_f32 v233, v225
    v_sin_f32 v241, v225
    v_cos_f32 v234, v226
    v_sin_f32 v242, v226
    v_cos_f32 v235, v227
    v_sin_f32 v243, v227
    v_cos_f32 v236, v228
    v_sin_f32 v244, v228
    v_cos_f32 v237, v229
    v_sin_f32 v245, v229
    v_cos_f32 v238, v230
    v_sin_f32 v246, v230
    v_cos_f32 v239, v231
    v_sin_f32 v247, v231
    s_cmp_lt_u32 s34, 16
    s_cbranch_scc1 L_ha_3
    s_mov_b32 m0, s62
    s_nop 0
    buffer_load_dwordx4 v4, s[28:31], s63 offen offset:0 nt lds
    buffer_load_dwordx4 v4, s[28:31], s63 offen offset:1024 nt lds
    s_mov_b32 exec_hi, 1
    buffer_load_dwordx4 v4, s[28:31], s63 offen offset:2048 nt lds
    s_mov_b32 exec_hi, -1
L_ha_3:
    v_cvt_pk_bf16_f32 v120, v24, v25
    v_cvt_pk_bf16_f32 v121, v26, v27
    v_cvt_pk_bf16_f32 v122, v28, v29
    v_cvt_pk_bf16_f32 v123, v30, v31
    v_cvt_pk_bf16_f32 v124, v32, v33
    v_cvt_pk_bf16_f32 v125, v34, v35
    v_cvt_pk_bf16_f32 v126, v36, v37
    v_cvt_pk_bf16_f32 v127, v38, v39
    v_xor_b32 v128, s51, v120
    v_xor_b32 v132, s52, v124
    v_xor_b32 v129, s51, v121
    v_xor_b32 v133, s52, v125
    v_xor_b32 v130, s51, v122
    v_xor_b32 v134, s52, v126
    v_xor_b32 v131, s51, v123
    v_xor_b32 v135, s52, v127
    v_pk_mul_f32 v[40:41], v[24:25], v[232:233]
    v_pk_mul_f32 v[42:43], v[26:27], v[234:235]
    v_pk_mul_f32 v[44:45], v[28:29], v[236:237]
    v_pk_mul_f32 v[46:47], v[30:31], v[238:239]
    v_pk_mul_f32 v[48:49], v[32:33], v[232:233]
    v_pk_mul_f32 v[50:51], v[34:35], v[234:235]
    v_pk_mul_f32 v[52:53], v[36:37], v[236:237]
    v_pk_mul_f32 v[54:55], v[38:39], v[238:239]
    v_pk_fma_f32 v[40:41], v[32:33], v[240:241], v[40:41] neg_lo:[1,0,0] neg_hi:[1,0,0]
    v_pk_fma_f32 v[42:43], v[34:35], v[242:243], v[42:43] neg_lo:[1,0,0] neg_hi:[1,0,0]
    v_pk_fma_f32 v[44:45], v[36:37], v[244:245], v[44:45] neg_lo:[1,0,0] neg_hi:[1,0,0]
    v_pk_fma_f32 v[46:47], v[38:39], v[246:247], v[46:47] neg_lo:[1,0,0] neg_hi:[1,0,0]
    v_pk_fma_f32 v[48:49], v[24:25], v[240:241], v[48:49]
    v_pk_fma_f32 v[50:51], v[26:27], v[242:243], v[50:51]
    v_pk_fma_f32 v[52:53], v[28:29], v[244:245], v[52:53]
    v_pk_fma_f32 v[54:55], v[30:31], v[246:247], v[54:55]
    v_pk_add_f32 v[232:233], v[232:233], v[232:233]
    v_pk_add_f32 v[234:235], v[234:235], v[234:235]
    v_pk_add_f32 v[236:237], v[236:237], v[236:237]
    v_pk_add_f32 v[238:239], v[238:239], v[238:239]
    v_cvt_pk_bf16_f32 v136, v40, v41
    v_cvt_pk_bf16_f32 v137, v42, v43
    v_cvt_pk_bf16_f32 v138, v44, v45
    v_cvt_pk_bf16_f32 v139, v46, v47
    v_cvt_pk_bf16_f32 v140, v48, v49
    v_cvt_pk_bf16_f32 v141, v50, v51
    v_cvt_pk_bf16_f32 v142, v52, v53
    v_cvt_pk_bf16_f32 v143, v54, v55
    v_xor_b32 v144, s51, v136
    v_xor_b32 v148, s52, v140
    v_xor_b32 v145, s51, v137
    v_xor_b32 v149, s52, v141
    v_xor_b32 v146, s51, v138
    v_xor_b32 v150, s52, v142
    v_xor_b32 v147, s51, v139
    v_xor_b32 v151, s52, v143
L_ha_4:
    s_lshl_b32 s56, s33, 5
    s_add_u32 s56, s56, s34
    s_lshl2_add_u32 s56, s56, s32
    s_mul_i32 s56, s56, 1920
    s_mov_b64 s[58:59], s[16:17]
    s_cmp_eq_u32 s32, 1
    s_cselect_b64 s[58:59], s[22:23], s[58:59]
    s_cselect_b32 s56, 98304, s56
    s_cmp_eq_u32 s32, 2
    s_cselect_b64 s[58:59], s[20:21], s[58:59]
    s_cselect_b32 s56, 128, s56
    v_mov_b32 v210, s56
    global_load_ubyte v7, v210, s[58:59]
    v_pk_fma_f32 v[56:57], v[232:233], v[40:41], v[24:25] neg_lo:[0,0,1] neg_hi:[0,0,1]
    v_pk_fma_f32 v[58:59], v[234:235], v[42:43], v[26:27] neg_lo:[0,0,1] neg_hi:[0,0,1]
    v_pk_fma_f32 v[60:61], v[236:237], v[44:45], v[28:29] neg_lo:[0,0,1] neg_hi:[0,0,1]
    v_pk_fma_f32 v[62:63], v[238:239], v[46:47], v[30:31] neg_lo:[0,0,1] neg_hi:[0,0,1]
    v_pk_fma_f32 v[64:65], v[232:233], v[48:49], v[32:33] neg_lo:[0,0,1] neg_hi:[0,0,1]
    v_pk_fma_f32 v[66:67], v[234:235], v[50:51], v[34:35] neg_lo:[0,0,1] neg_hi:[0,0,1]
    v_pk_fma_f32 v[68:69], v[236:237], v[52:53], v[36:37] neg_lo:[0,0,1] neg_hi:[0,0,1]
    v_pk_fma_f32 v[70:71], v[238:239], v[54:55], v[38:39] neg_lo:[0,0,1] neg_hi:[0,0,1]
    v_pk_fma_f32 v[8:9], v[232:233], v[24:25], v[40:41] neg_lo:[0,0,1] neg_hi:[0,0,1]
    v_pk_fma_f32 v[10:11], v[234:235], v[26:27], v[42:43] neg_lo:[0,0,1] neg_hi:[0,0,1]
    v_pk_fma_f32 v[12:13], v[236:237], v[28:29], v[44:45] neg_lo:[0,0,1] neg_hi:[0,0,1]
    v_pk_fma_f32 v[14:15], v[238:239], v[30:31], v[46:47] neg_lo:[0,0,1] neg_hi:[0,0,1]
    v_pk_fma_f32 v[16:17], v[232:233], v[32:33], v[48:49] neg_lo:[0,0,1] neg_hi:[0,0,1]
    v_pk_fma_f32 v[18:19], v[234:235], v[34:35], v[50:51] neg_lo:[0,0,1] neg_hi:[0,0,1]
    v_pk_fma_f32 v[20:21], v[236:237], v[36:37], v[52:53] neg_lo:[0,0,1] neg_hi:[0,0,1]
    v_pk_fma_f32 v[22:23], v[238:239], v[38:39], v[54:55] neg_lo:[0,0,1] neg_hi:[0,0,1]
    v_cvt_pk_bf16_f32 v152, v56, v57
    v_cvt_pk_bf16_f32 v153, v58, v59
    v_cvt_pk_bf16_f32 v154, v60, v61
    v_cvt_pk_bf16_f32 v155, v62, v63
    v_cvt_pk_bf16_f32 v156, v64, v65
    v_cvt_pk_bf16_f32 v157, v66, v67
    v_cvt_pk_bf16_f32 v158, v68, v69
    v_cvt_pk_bf16_f32 v159, v70, v71
    v_xor_b32 v160, s51, v152
    v_xor_b32 v164, s52, v156
    v_xor_b32 v161, s51, v153
    v_xor_b32 v165, s52, v157
    v_xor_b32 v162, s51, v154
    v_xor_b32 v166, s52, v158
    v_xor_b32 v163, s51, v155
    v_xor_b32 v167, s52, v159
    v_pk_fma_f32 v[72:73], v[232:233], v[56:57], v[40:41] neg_lo:[0,0,1] neg_hi:[0,0,1]
    v_pk_fma_f32 v[74:75], v[234:235], v[58:59], v[42:43] neg_lo:[0,0,1] neg_hi:[0,0,1]
    v_pk_fma_f32 v[76:77], v[236:237], v[60:61], v[44:45] neg_lo:[0,0,1] neg_hi:[0,0,1]
    v_pk_fma_f32 v[78:79], v[238:239], v[62:63], v[46:47] neg_lo:[0,0,1] neg_hi:[0,0,1]
    v_pk_fma_f32 v[80:81], v[232:233], v[64:65], v[48:49] neg_lo:[0,0,1] neg_hi:[0,0,1]
    v_pk_fma_f32 v[82:83], v[234:235], v[66:67], v[50:51] neg_lo:[0,0,1] neg_hi:[0,0,1]
    v_pk_fma_f32 v[84:85], v[236:237], v[68:69], v[52:53] neg_lo:[0,0,1] neg_hi:[0,0,1]
    v_pk_fma_f32 v[86:87], v[238:239], v[70:71], v[54:55] neg_lo:[0,0,1] neg_hi:[0,0,1]
    s_cmp_lg_u32 s32, 1
    s_cbranch_scc1 L_k10_5
    v_pk_fma_f32 v[8:9], v[232:233], v[72:73], v[56:57] neg_lo:[0,0,1] neg_hi:[0,0,1]
    v_pk_fma_f32 v[10:11], v[234:235], v[74:75], v[58:59] neg_lo:[0,0,1] neg_hi:[0,0,1]
    v_pk_fma_f32 v[12:13], v[236:237], v[76:77], v[60:61] neg_lo:[0,0,1] neg_hi:[0,0,1]
    v_pk_fma_f32 v[14:15], v[238:239], v[78:79], v[62:63] neg_lo:[0,0,1] neg_hi:[0,0,1]
    v_pk_fma_f32 v[16:17], v[232:233], v[80:81], v[64:65] neg_lo:[0,0,1] neg_hi:[0,0,1]
    v_pk_fma_f32 v[18:19], v[234:235], v[82:83], v[66:67] neg_lo:[0,0,1] neg_hi:[0,0,1]
    v_pk_fma_f32 v[20:21], v[236:237], v[84:85], v[68:69] neg_lo:[0,0,1] neg_hi:[0,0,1]
    v_pk_fma_f32 v[22:23], v[238:239], v[86:87], v[70:71] neg_lo:[0,0,1] neg_hi:[0,0,1]
L_k10_5:
L_ha_6:
    s_bitcmp0_b32 s33, 0
    s_cselect_b32 s28, s12, s14
    s_cselect_b32 s29, s13, s15
    s_mov_b32 s30, 1966080
    v_min_u32 v209, 29, v1
    v_mul_u32_u24 v208, 171, v209
    v_lshrrev_b32 v208, 10, v208
    v_mul_u32_u24 v208, 2304, v208
    v_lshl_add_u32 v208, v209, 7, v208
    s_lshl2_add_u32 s56, s34, s32
    s_mul_i32 s56, s56, 15360
    s_and_b32 s57, s33, 6
    s_mul_i32 s57, s57, 384
    s_add_u32 s56, s56, s57
    buffer_load_dword v5, v208, s[28:31], s56 offen
    v_cvt_pk_bf16_f32 v168, v72, v73
    v_cvt_pk_bf16_f32 v169, v74, v75
    v_cvt_pk_bf16_f32 v170, v76, v77
    v_cvt_pk_bf16_f32 v171, v78, v79
    v_cvt_pk_bf16_f32 v172, v80, v81
    v_cvt_pk_bf16_f32 v173, v82, v83
    v_cvt_pk_bf16_f32 v174, v84, v85
    v_cvt_pk_bf16_f32 v175, v86, v87
    v_xor_b32 v176, s51, v168
    v_xor_b32 v180, s52, v172
    v_xor_b32 v177, s51, v169
    v_xor_b32 v181, s52, v173
    v_xor_b32 v178, s51, v170
    v_xor_b32 v182, s52, v174
    v_xor_b32 v179, s51, v171
    v_xor_b32 v183, s52, v175
    v_cvt_pk_bf16_f32 v104, v8, v9
    v_cvt_pk_bf16_f32 v105, v10, v11
    v_cvt_pk_bf16_f32 v106, v12, v13
    v_cvt_pk_bf16_f32 v107, v14, v15
    v_cvt_pk_bf16_f32 v108, v16, v17
    v_cvt_pk_bf16_f32 v109, v18, v19
    v_cvt_pk_bf16_f32 v110, v20, v21
    v_cvt_pk_bf16_f32 v111, v22, v23
    v_xor_b32 v112, s51, v104
    v_xor_b32 v116, s52, v108
    v_xor_b32 v113, s51, v105
    v_xor_b32 v117, s52, v109
    v_xor_b32 v114, s51, v106
    v_xor_b32 v118, s52, v110
    v_xor_b32 v115, s51, v107
    v_xor_b32 v119, s52, v111
    s_cmp_eq_u32 s32, 0
    s_cselect_b32 s72, 0x10001, 0
    s_mov_b32 s73, s72
    v_mov_b32 v248, 0xbf353f35
    v_mov_b32 v249, 0x3f353f35
    v_cndmask_b32 v104, v104, v248, s[72:73]
    v_cndmask_b32 v116, v116, v249, s[72:73]
    v_cndmask_b32 v105, v105, v248, s[72:73]
    v_cndmask_b32 v117, v117, v249, s[72:73]
    v_cndmask_b32 v106, v106, v248, s[72:73]
    v_cndmask_b32 v118, v118, v249, s[72:73]
    v_cndmask_b32 v107, v107, v248, s[72:73]
    v_cndmask_b32 v119, v119, v249, s[72:73]
    v_cndmask_b32 v215, 1.0, 0, s[72:73]
    s_lshl_b32 s46, s32, 6
    s_add_u32 s46, s46, 90112
    v_mul_u32_u24 v212, 2064, v2
    v_lshl_add_u32 v212, v3, 8, v212
    v_add_u32 v212, s46, v212
    s_mul_i32 s47, s47, 2064
    s_mul_i32 s48, s48, 2064
    s_add_u32 s47, s47, 90112
    s_add_u32 s48, s48, 90112
    v_add_u32 v213, s48, v4
    v_add_u32 v214, s47, v4
    v_cmp_gt_u32 s[76:77], 11, v2
L_ha_7:
    s_cmp_lg_u32 s32, 1
    s_cbranch_scc1 L_tn_9
    s_call_b64 s[40:41], L_fftt
    s_branch L_te_8
L_tn_9:
    s_cmp_lg_u32 s32, 2
    s_cbranch_scc1 L_tn_10
    s_call_b64 s[40:41], L_pg1
    s_branch L_te_8
L_tn_10:
    s_cmp_lg_u32 s32, 3
    s_cbranch_scc1 L_tn_11
    s_call_b64 s[40:41], L_pg2
    s_branch L_te_8
L_tn_11:
    s_cmp_lg_u32 s32, 0
    s_cbranch_scc1 L_te_8
    s_call_b64 s[40:41], L_pg3
L_te_8:
    s_cmp_ge_u32 s34, 16
    s_cbranch_scc1 L_a_wt
    v_lshrrev_b32 v248, 2, v1
    v_and_b32 v249, 3, v1
    s_mul_i32 s46, s32, 5120
    s_add_u32 s46, s46, 0
    v_lshl_add_u32 v249, v249, 3, s46
    v_lshl_add_u32 v200, v248, 6, v249
    v_and_b32 v248, 3, v248
    v_lshl_add_u32 v201, v248, 6, v249
    s_waitcnt vmcnt(2)
    ds_read_b64_tr_b16 a[0:1], v200 offset:0
    ds_read_b64_tr_b16 a[2:3], v201 offset:1024
    ds_read_b64_tr_b16 a[4:5], v200 offset:32
    ds_read_b64_tr_b16 a[6:7], v201 offset:1056
    ds_read_b64_tr_b16 a[8:9], v200 offset:1280
    ds_read_b64_tr_b16 a[10:11], v201 offset:2304
    ds_read_b64_tr_b16 a[12:13], v200 offset:1312
    ds_read_b64_tr_b16 a[14:15], v201 offset:2336
    ds_read_b64_tr_b16 a[16:17], v200 offset:2560
    ds_read_b64_tr_b16 a[18:19], v201 offset:3584
    ds_read_b64_tr_b16 a[20:21], v200 offset:2592
    ds_read_b64_tr_b16 a[22:23], v201 offset:3616
    ds_read_b64_tr_b16 a[24:25], v200 offset:3840
    ds_read_b64_tr_b16 a[26:27], v201 offset:4864
    ds_read_b64_tr_b16 a[28:29], v200 offset:3872
    s_waitcnt lgkmcnt(11)
    ds_read_b64_tr_b16 a[30:31], v201 offset:4896
    v_lshrrev_b32 v202, 1, v2
    v_mul_u32_u24 v202, 16512, v202
    v_lshl_add_u32 v202, v2, 6, v202
    v_lshl_add_u32 v202, v3, 4, v202
    s_mul_i32 s46, s32, 133120
    s_lshl_b32 s47, s37, 7
    s_add_u32 s46, s46, s47
    s_add_u32 s54, s46, 81920
    s_add_u32 s55, s46, 614400
    s_add_u32 s56, s46, 1146880
    s_add_u32 s57, s46, 1679360
    s_add_u32 s58, s46, 2211840
    v_mfma_f32_16x16x32_bf16 v[216:219], a[0:3], v[96:99], 0
    v_mfma_f32_16x16x32_bf16 v[224:227], a[0:3], v[100:103], 0
    v_mfma_f32_16x16x32_bf16 v[220:223], a[4:7], v[96:99], 0
    v_mfma_f32_16x16x32_bf16 v[228:231], a[4:7], v[100:103], 0
    s_waitcnt lgkmcnt(10)
    v_mfma_f32_16x16x32_bf16 v[232:235], a[8:11], v[96:99], 0
    v_mfma_f32_16x16x32_bf16 v[240:243], a[8:11], v[100:103], 0
    s_waitcnt lgkmcnt(8)
    v_mfma_f32_16x16x32_bf16 v[236:239], a[12:15], v[96:99], 0
    v_mfma_f32_16x16x32_bf16 v[244:247], a[12:15], v[100:103], 0
    v_cvt_pk_bf16_f32 v184, v216, v217
    v_cvt_pk_bf16_f32 v185, v218, v219
    v_cvt_pk_bf16_f32 v186, v220, v221
    v_cvt_pk_bf16_f32 v187, v222, v223
    v_cvt_pk_bf16_f32 v188, v224, v225
    v_cvt_pk_bf16_f32 v189, v226, v227
    v_cvt_pk_bf16_f32 v190, v228, v229
    v_cvt_pk_bf16_f32 v191, v230, v231
    s_waitcnt lgkmcnt(6)
    v_mfma_f32_16x16x32_bf16 v[216:219], a[16:19], v[96:99], 0
    v_mfma_f32_16x16x32_bf16 v[224:227], a[16:19], v[100:103], 0
    s_waitcnt lgkmcnt(4)
    v_mfma_f32_16x16x32_bf16 v[220:223], a[20:23], v[96:99], 0
    v_mfma_f32_16x16x32_bf16 v[228:231], a[20:23], v[100:103], 0
    s_mov_b64 exec, s[76:77]
    ds_write_b128 v212, v[184:187] offset:0
    ds_write_b128 v212, v[188:191] offset:1024
    s_mov_b64 exec, -1
    v_cvt_pk_bf16_f32 v192, v232, v233
    v_cvt_pk_bf16_f32 v193, v234, v235
    v_cvt_pk_bf16_f32 v194, v236, v237
    v_cvt_pk_bf16_f32 v195, v238, v239
    v_cvt_pk_bf16_f32 v196, v240, v241
    v_cvt_pk_bf16_f32 v197, v242, v243
    v_cvt_pk_bf16_f32 v198, v244, v245
    v_cvt_pk_bf16_f32 v199, v246, v247
    s_waitcnt lgkmcnt(4)
    v_mfma_f32_16x16x32_bf16 v[232:235], a[24:27], v[96:99], 0
    v_mfma_f32_16x16x32_bf16 v[240:243], a[24:27], v[100:103], 0
    s_waitcnt lgkmcnt(2)
    v_mfma_f32_16x16x32_bf16 v[236:239], a[28:31], v[96:99], 0
    v_mfma_f32_16x16x32_bf16 v[244:247], a[28:31], v[100:103], 0
    s_mov_b64 exec, s[76:77]
    ds_write_b128 v212, v[192:195] offset:16
    ds_write_b128 v212, v[196:199] offset:1040
    s_mov_b64 exec, -1
    v_cvt_pk_bf16_f32 v184, v216, v217
    v_cvt_pk_bf16_f32 v185, v218, v219
    v_cvt_pk_bf16_f32 v186, v220, v221
    v_cvt_pk_bf16_f32 v187, v222, v223
    v_cvt_pk_bf16_f32 v188, v224, v225
    v_cvt_pk_bf16_f32 v189, v226, v227
    v_cvt_pk_bf16_f32 v190, v228, v229
    v_cvt_pk_bf16_f32 v191, v230, v231
    s_mov_b64 exec, s[76:77]
    ds_write_b128 v212, v[184:187] offset:32
    ds_write_b128 v212, v[188:191] offset:1056
    s_mov_b64 exec, -1
    v_cvt_pk_bf16_f32 v192, v232, v233
    v_cvt_pk_bf16_f32 v193, v234, v235
    v_cvt_pk_bf16_f32 v194, v236, v237
    v_cvt_pk_bf16_f32 v195, v238, v239
    v_cvt_pk_bf16_f32 v196, v240, v241
    v_cvt_pk_bf16_f32 v197, v242, v243
    v_cvt_pk_bf16_f32 v198, v244, v245
    s_branch L_pgx1
L_pg1:
    s_setpc_b64 s[40:41]
L_pgx1:
    v_cvt_pk_bf16_f32 v199, v246, v247
    s_mov_b64 exec, s[76:77]
    ds_write_b128 v212, v[192:195] offset:48
    ds_write_b128 v212, v[196:199] offset:1072
    s_mov_b64 exec, -1
    s_waitcnt lgkmcnt(0)
    s_barrier
    ds_read_b128 a[0:3], v213 offset:0
    ds_read_b128 a[4:7], v213 offset:1024
    ds_read_b128 a[8:11], v214 offset:4128
    ds_read_b128 a[12:15], v214 offset:5152
    ds_read_b128 a[16:19], v214 offset:8256
    ds_read_b128 a[20:23], v214 offset:9280
    ds_read_b128 a[24:27], v214 offset:12384
    ds_read_b128 a[28:31], v214 offset:13408
    ds_read_b128 a[32:35], v214 offset:16512
    ds_read_b128 a[36:39], v214 offset:17536
    s_waitcnt lgkmcnt(8)
    v_mfma_f32_16x16x32_bf16 v[216:219], a[0:3], v[104:107], 0
    v_mfma_f32_16x16x32_bf16 v[220:223], a[0:3], v[116:119], 0
    v_mfma_f32_16x16x32_bf16 v[216:219], a[4:7], v[108:111], v[216:219]
    v_mfma_f32_16x16x32_bf16 v[220:223], a[4:7], v[112:115], v[220:223]
    s_waitcnt lgkmcnt(6)
    v_mfma_f32_16x16x32_bf16 v[224:227], a[8:11], v[120:123], 0
    v_mfma_f32_16x16x32_bf16 v[228:231], a[8:11], v[132:135], 0
    v_mfma_f32_16x16x32_bf16 v[224:227], a[12:15], v[124:127], v[224:227]
    v_mfma_f32_16x16x32_bf16 v[228:231], a[12:15], v[128:131], v[228:231]
    s_nop 2
    v_cvt_pk_bf16_f32 v184, v216, v220
    v_cvt_pk_bf16_f32 v185, v217, v221
    v_cvt_pk_bf16_f32 v186, v218, v222
    v_cvt_pk_bf16_f32 v187, v219, v223
    buffer_store_dwordx4 v[184:187], v202, s[24:27], s54 offen sc1
    s_waitcnt lgkmcnt(4)
    v_mfma_f32_16x16x32_bf16 v[232:235], a[16:19], v[136:139], 0
    v_mfma_f32_16x16x32_bf16 v[236:239], a[16:19], v[148:151], 0
    v_mfma_f32_16x16x32_bf16 v[232:235], a[20:23], v[140:143], v[232:235]
    v_mfma_f32_16x16x32_bf16 v[236:239], a[20:23], v[144:147], v[236:239]
    v_mul_f32 v220, v220, v215
    v_mul_f32 v208, v216, v216
    v_mul_f32 v221, v221, v215
    v_mul_f32 v209, v217, v217
    v_mul_f32 v222, v222, v215
    v_mul_f32 v210, v218, v218
    v_mul_f32 v223, v223, v215
    v_mul_f32 v211, v219, v219
    v_fmac_f32 v208, v220, v220
    v_fmac_f32 v209, v221, v221
    v_fmac_f32 v210, v222, v222
    v_fmac_f32 v211, v223, v223
    v_cvt_pk_bf16_f32 v188, v224, v228
    v_cvt_pk_bf16_f32 v189, v225, v229
    v_cvt_pk_bf16_f32 v190, v226, v230
    v_cvt_pk_bf16_f32 v191, v227, v231
    buffer_store_dwordx4 v[188:191], v202, s[24:27], s55 offen sc1
    s_waitcnt lgkmcnt(2)
    v_mfma_f32_16x16x32_bf16 v[240:243], a[24:27], v[152:155], 0
    v_mfma_f32_16x16x32_bf16 v[244:247], a[24:27], v[164:167], 0
    v_mfma_f32_16x16x32_bf16 v[240:243], a[28:31], v[156:159], v[240:243]
    v_mfma_f32_16x16x32_bf16 v[244:247], a[28:31], v[160:163], v[244:247]
    s_waitcnt lgkmcnt(0)
    v_mfma_f32_16x16x32_bf16 v[216:219], a[32:35], v[168:171], 0
    v_mfma_f32_16x16x32_bf16 v[220:223], a[32:35], v[180:183], 0
    v_mfma_f32_16x16x32_bf16 v[216:219], a[36:39], v[172:175], v[216:219]
    v_mfma_f32_16x16x32_bf16 v[220:223], a[36:39], v[176:179], v[220:223]
    v_cvt_pk_bf16_f32 v192, v232, v236
    v_cvt_pk_bf16_f32 v193, v233, v237
    v_cvt_pk_bf16_f32 v194, v234, v238
    v_cvt_pk_bf16_f32 v195, v235, v239
    buffer_store_dwordx4 v[192:195], v202, s[24:27], s56 offen sc1
    v_cvt_pk_bf16_f32 v196, v240, v244
    v_cvt_pk_bf16_f32 v197, v241, v245
    v_cvt_pk_bf16_f32 v198, v242, v246
    v_cvt_pk_bf16_f32 v199, v243, v247
    buffer_store_dwordx4 v[196:199], v202, s[24:27], s57 offen sc1
    v_fmac_f32 v208, v224, v224
    v_fmac_f32 v209, v225, v225
    v_fmac_f32 v210, v226, v226
    v_fmac_f32 v211, v227, v227
    v_fmac_f32 v208, v228, v228
    v_fmac_f32 v209, v229, v229
    v_fmac_f32 v210, v230, v230
    v_fmac_f32 v211, v231, v231
    v_cvt_pk_bf16_f32 v184, v216, v220
    v_cvt_pk_bf16_f32 v185, v217, v221
    v_cvt_pk_bf16_f32 v186, v218, v222
    v_cvt_pk_bf16_f32 v187, v219, v223
    buffer_store_dwordx4 v[184:187], v202, s[24:27], s58 offen sc1
    v_fmac_f32 v208, v232, v232
    v_fmac_f32 v209, v233, v233
    v_fmac_f32 v210, v234, v234
    v_fmac_f32 v211, v235, v235
    v_fmac_f32 v208, v236, v236
    v_fmac_f32 v209, v237, v237
    v_fmac_f32 v210, v238, v238
    v_fmac_f32 v211, v239, v239
    v_fmac_f32 v208, v240, v240
    v_fmac_f32 v209, v241, v241
    v_fmac_f32 v210, v242, v242
    v_fmac_f32 v211, v243, v243
    v_fmac_f32 v208, v244, v244
    v_fmac_f32 v209, v245, v245
    v_fmac_f32 v210, v246, v246
    v_fmac_f32 v211, v247, v247
    v_fmac_f32 v208, v216, v216
    v_fmac_f32 v209, v217, v217
    v_fmac_f32 v210, v218, v218
    v_fmac_f32 v211, v219, v219
    v_fmac_f32 v208, v220, v220
    v_fmac_f32 v209, v221, v221
    v_fmac_f32 v210, v222, v222
    v_fmac_f32 v211, v223, v223
    v_add_f32_dpp v208, v208, v208 row_ror:8 row_mask:0xf bank_mask:0xf
    v_add_f32_dpp v209, v209, v209 row_ror:8 row_mask:0xf bank_mask:0xf
    v_add_f32_dpp v210, v210, v210 row_ror:8 row_mask:0xf bank_mask:0xf
    v_add_f32_dpp v211, v211, v211 row_ror:8 row_mask:0xf bank_mask:0xf
    v_add_f32_dpp v208, v208, v208 row_ror:4 row_mask:0xf bank_mask:0xf
    v_add_f32_dpp v209, v209, v209 row_ror:4 row_mask:0xf bank_mask:0xf
    v_add_f32_dpp v210, v210, v210 row_ror:4 row_mask:0xf bank_mask:0xf
    v_add_f32_dpp v211, v211, v211 row_ror:4 row_mask:0xf bank_mask:0xf
    v_add_f32_dpp v208, v208, v208 row_ror:2 row_mask:0xf bank_mask:0xf
    v_add_f32_dpp v209, v209, v209 row_ror:2 row_mask:0xf bank_mask:0xf
    v_add_f32_dpp v210, v210, v210 row_ror:2 row_mask:0xf bank_mask:0xf
    v_add_f32_dpp v211, v211, v211 row_ror:2 row_mask:0xf bank_mask:0xf
    v_add_f32_dpp v208, v208, v208 row_ror:1 row_mask:0xf bank_mask:0xf
    v_add_f32_dpp v209, v209, v209 row_ror:1 row_mask:0xf bank_mask:0xf
    v_add_f32_dpp v210, v210, v210 row_ror:1 row_mask:0xf bank_mask:0xf
    v_add_f32_dpp v211, v211, v211 row_ror:1 row_mask:0xf bank_mask:0xf
    s_lshl_b32 s46, s32, 6
    s_add_u32 s46, s46, 140032
    v_lshl_add_u32 v248, v3, 4, s46
    ds_write_b128 v248, v[208:211]
    v_lshlrev_b32 v248, 2, v2
    v_add_u32 v249, 140032, v248
    s_and_b32 s46, s37, 1
    s_and_b32 s47, s37, 6
    s_lshl3_add_u32 s46, s46, s47
    s_bfe_u32 s47, s37, 0x20003
    s_lshl1_add_u32 s46, s46, s47
    s_and_b32 s47, s37, -32
    s_add_u32 s46, s46, s47
    s_lshl_b32 s46, s46, 6
    s_add_u32 s46, s46, 65536
    s_waitcnt lgkmcnt(0)
    s_barrier
    s_cmp_lg_u32 s32, 3
    s_cbranch_scc1 L_ss_13
    ds_read_b32 v208, v249 offset:0
    ds_read_b32 v209, v249 offset:64
    ds_read_b32 v210, v249 offset:128
    ds_read_b32 v211, v249 offset:192
    s_waitcnt lgkmcnt(0)
    v_add_f32 v208, v208, v209
    v_add_f32 v210, v210, v211
    v_add_f32 v208, v208, v210
    buffer_store_dword v208, v248, s[24:27], s46 offen sc1
L_ss_13:
    global_load_dword v6, v94, s[20:21] sc1
    s_sub_u32 s37, s34, 8
    s_cbranch_scc0 L_a_s
    s_call_b64 s[40:41], L_fftc
    s_waitcnt vmcnt(0)
    s_mov_b32 s42, 65536
L_ga_14:
    v_cmp_eq_u32 vcc, 0, v6
    s_cbranch_vccz L_gb_15
    global_load_dword v6, v94, s[20:21] sc1
    s_sub_u32 s42, s42, 1
    s_waitcnt vmcnt(0)
    s_cbranch_scc0 L_ga_14
L_gb_15:
    v_mul_u32_u24 v200, 4096, v1
    v_mov_b32 v201, 1
    s_barrier
    s_cmp_lg_u32 s32, 0
    s_cbranch_scc1 L_sg_16
    s_mov_b64 exec, 0xffff
    buffer_atomic_add v201, v200, s[24:27], s43 offen offset:0 sc1
    s_mov_b64 exec, -1
L_sg_16:
    s_call_b64 s[40:41], L_fftd
    s_and_b32 s57, s34, 7
    s_lshl2_add_u32 s57, s57, s32
    s_lshl_b32 s57, s57, 1
    s_add_u32 s61, s57, 1
    s_mul_i32 s59, s33, 40
    s_mul_i32 s62, s33, 61440
    s_add_u32 s62, s62, 34177024
    s_cmp_ge_u32 s57, 60
    s_cbranch_scc1 L_ge_18
L_g_17:
    s_mul_i32 s58, s57, 69
    s_lshr_b32 s58, s58, 10
    s_mul_i32 s60, s58, 15
    s_sub_u32 s60, s57, s60
    s_mul_i32 s53, s60, 86
    s_lshr_b32 s53, s53, 8
    s_lshl_b32 s54, s53, 2
    s_add_u32 s54, s54, s58
    s_mul_i32 s53, s53, 3
    s_sub_u32 s53, s60, s53
    s_lshl_b32 s53, s53, 4
    s_add_u32 s53, s53, s59
    s_lshr_b32 s55, s54, 1
    s_cmp_eq_u32 s54, 1
    s_cselect_b32 s55, 10, s55
    s_sub_u32 s56, 320, s55
    s_bitcmp1_b32 s54, 0
    s_cselect_b32 s55, s56, s55
    s_cselect_b32 s56, -20, 20
    v_add_u32 v224, s53, v2
    v_lshlrev_b32 v225, 2, v3
    v_mul_i32_i24 v225, s56, v225
    v_add_u32 v225, s55, v225
    v_cmp_eq_u32 vcc, 0, v225
    v_mov_b32 v226, 320
    s_nop 0
    v_cndmask_b32 v226, v225, v226, vcc
    v_mov_b32 v227, 0x3d64f92e
    v_mov_b32 v221, 0x3d21e89b
    v_cndmask_b32 v220, v227, v221, vcc
    v_mul_u32_u24 v216, v224, v226
    v_add_u32 v225, s56, v225
    v_mul_u32_u24 v217, v224, v225
    v_add_u32 v225, s56, v225
    v_mul_u32_u24 v218, v224, v225
    v_add_u32 v225, s56, v225
    v_mul_u32_u24 v219, v224, v225
    v_cvt_f32_u32 v216, v216
    v_mul_f32 v216, 0x3acccccd, v216
    v_cvt_f32_u32 v217, v217
    v_mul_f32 v217, 0x3acccccd, v217
    v_cvt_f32_u32 v218, v218
    v_mul_f32 v218, 0x3acccccd, v218
    v_cvt_f32_u32 v219, v219
    v_mul_f32 v219, 0x3acccccd, v219
    v_cos_f32 v224, v216
    v_sin_f32 v228, v216
    v_cos_f32 v225, v217
    v_sin_f32 v229, v217
    v_cos_f32 v226, v218
    v_sin_f32 v230, v218
    v_cos_f32 v227, v219
    v_sin_f32 v231, v219
    v_mul_f32 v224, v220, v224
    v_mul_f32 v225, 0x3d64f92e, v225
    v_mul_f32 v226, 0x3d64f92e, v226
    v_mul_f32 v227, 0x3d64f92e, v227
    v_mul_f32 v228, 0xbd64f92e, v228
    v_mul_f32 v229, 0xbd64f92e, v229
    v_mul_f32 v230, 0xbd64f92e, v230
    v_mul_f32 v231, 0xbd64f92e, v231
    v_cndmask_b32 v228, v228, v221, vcc
    v_cvt_pk_bf16_f32 v184, v224, v225
    v_cvt_pk_bf16_f32 v185, v226, v227
    v_cvt_pk_bf16_f32 v186, v228, v229
    v_cvt_pk_bf16_f32 v187, v230, v231
    s_lshl_b32 s53, s57, 10
    s_add_u32 s53, s53, s62
    buffer_store_dwordx4 v[184:187], v4, s[24:27], s53 offen sc1
    s_add_u32 s57, s57, 1
    s_cmp_le_u32 s57, s61
    s_cbranch_scc1 L_g_17
L_ge_18:
    s_and_b32 s53, s34, 3
    s_lshl2_add_u32 s53, s33, s53
    s_lshl2_add_u32 s53, s53, s32
    s_lshl_b32 s53, s53, 6
    s_add_u32 s53, s53, 73728
    v_lshlrev_b32 v224, 2, v2
    v_mov_b32 v225, 0
    buffer_store_dword v225, v224, s[24:27], s53 offen sc1
    v_mov_b32 v95, 0
    s_branch L_a_end
L_a_s:
    s_mul_i32 s46, s33, 12
    s_add_u32 s37, s37, s46
    s_lshl2_add_u32 s46, s37, s32
    s_mul_i32 s47, s46, 171
    s_lshr_b32 s47, s47, 10
    s_mul_i32 s47, s47, 6
    s_sub_u32 s47, s46, s47
    s_cmp_eq_u32 s47, 1
    s_addc_u32 s46, s46, 0
    s_cmp_eq_u32 s47, 2
    s_subb_u32 s46, s46, 0
    s_lshl_b32 s46, s46, 2
    s_mov_b32 s28, s16
    s_mov_b32 s29, s17
    s_mov_b32 s30, 1966080
    s_mov_b32 s31, 0x20000
    s_mul_i32 s47, s32, 5120
    s_mul_i32 s46, s46, 1280
    s_add_u32 m0, s47, 45056
    s_add_u32 s62, s47, 48128
    buffer_load_dwordx4 v4, s[28:31], s46 offen offset:0 lds
    buffer_load_dwordx4 v4, s[28:31], s46 offen offset:1024 lds
    buffer_load_dwordx4 v4, s[28:31], s46 offen offset:2048 lds
    s_add_u32 s63, s46, 3072
    s_mov_b32 m0, s62
    s_nop 0
    buffer_load_dwordx4 v4, s[28:31], s63 offen offset:0 lds
    buffer_load_dwordx4 v4, s[28:31], s63 offen offset:1024 lds
    s_call_b64 s[40:41], L_fftc
    s_cmp_ge_u32 s34, 16
    s_cselect_b32 s50, 32769, 1
    v_mul_u32_u24 v200, 4096, v1
    v_mov_b32 v201, s50
    s_waitcnt vmcnt(5)
    s_mov_b32 s42, 65536
L_ga_19:
    v_cmp_eq_u32 vcc, 0, v6
    s_cbranch_vccz L_gb_20
    global_load_dword v6, v94, s[20:21] sc1
    s_sub_u32 s42, s42, 1
    s_waitcnt vmcnt(0)
    s_cbranch_scc0 L_ga_19
L_gb_20:
    s_barrier
    s_cmp_lg_u32 s32, 0
    s_cbranch_scc1 L_sg_21
    s_mov_b64 exec, 0xffff
    buffer_atomic_add v201, v200, s[24:27], s43 offen offset:0 sc1
    s_mov_b64 exec, -1
L_sg_21:
    s_call_b64 s[40:41], L_fftd
    v_lshrrev_b32 v248, 2, v1
    v_and_b32 v249, 3, v1
    s_mul_i32 s46, s32, 5120
    s_add_u32 s46, s46, 45056
    v_lshl_add_u32 v249, v249, 3, s46
    v_lshl_add_u32 v200, v248, 6, v249
    v_and_b32 v248, 3, v248
    v_lshl_add_u32 v201, v248, 6, v249
    s_waitcnt vmcnt(1)
    s_cmp_eq_u32 s32, 0
    s_cbranch_scc1 L_gw_22
    s_waitcnt vmcnt(0)
L_gw_22:
    ds_read_b64_tr_b16 a[0:1], v200 offset:0
    ds_read_b64_tr_b16 a[2:3], v201 offset:1024
    ds_read_b64_tr_b16 a[4:5], v200 offset:32
    ds_read_b64_tr_b16 a[6:7], v201 offset:1056
    ds_read_b64_tr_b16 a[8:9], v200 offset:1280
    ds_read_b64_tr_b16 a[10:11], v201 offset:2304
    ds_read_b64_tr_b16 a[12:13], v200 offset:1312
    ds_read_b64_tr_b16 a[14:15], v201 offset:2336
    ds_read_b64_tr_b16 a[16:17], v200 offset:2560
    ds_read_b64_tr_b16 a[18:19], v201 offset:3584
    ds_read_b64_tr_b16 a[20:21], v200 offset:2592
    ds_read_b64_tr_b16 a[22:23], v201 offset:3616
    ds_read_b64_tr_b16 a[24:25], v200 offset:3840
    ds_read_b64_tr_b16 a[26:27], v201 offset:4864
    ds_read_b64_tr_b16 a[28:29], v200 offset:3872
    s_waitcnt lgkmcnt(11)
    ds_read_b64_tr_b16 a[30:31], v201 offset:4896
    s_lshr_b32 s46, s37, 1
    s_mul_i32 s46, s46, 5120
    s_and_b32 s47, s37, 1
    s_lshl_b32 s47, s47, 9
    s_add_u32 s46, s46, s47
    s_add_u32 s54, s46, 27582464
    v_and_b32 v248, 7, v2
    v_and_b32 v249, 1, v3
    v_lshl_add_u32 v248, v248, 1, v249
    v_lshrrev_b32 v249, 1, v3
    v_lshl_add_u32 v248, v249, 4, v248
    v_lshlrev_b32 v248, 4, v248
    v_lshrrev_b32 v249, 3, v2
    v_lshl_add_u32 v249, s32, 1, v249
    s_mov_b32 s46, 240640
    v_mul_u32_u24 v250, 52, v249
    v_lshrrev_b32 v250, 8, v250
    v_mad_u32_u24 v250, v250, s46, v248
    v_lshl_add_u32 v202, v249, 10, v250
    v_add_u32 v249, 8, v249
    v_mul_u32_u24 v250, 52, v249
    v_lshrrev_b32 v250, 8, v250
    v_mad_u32_u24 v250, v250, s46, v248
    v_lshl_add_u32 v203, v249, 10, v250
    v_add_u32 v249, 8, v249
    v_mul_u32_u24 v250, 52, v249
    v_lshrrev_b32 v250, 8, v250
    v_mad_u32_u24 v250, v250, s46, v248
    v_lshl_add_u32 v204, v249, 10, v250
    v_add_u32 v249, 8, v249
    v_mul_u32_u24 v250, 52, v249
    v_lshrrev_b32 v250, 8, v250
    v_mad_u32_u24 v250, v250, s46, v248
    v_lshl_add_u32 v205, v249, 10, v250
    v_add_u32 v249, 8, v249
    v_mul_u32_u24 v250, 52, v249
    v_lshrrev_b32 v250, 8, v250
    v_mad_u32_u24 v250, v250, s46, v248
    v_lshl_add_u32 v206, v249, 10, v250
    v_mfma_f32_16x16x32_bf16 v[216:219], a[0:3], v[96:99], 0
    v_mfma_f32_16x16x32_bf16 v[224:227], a[0:3], v[100:103], 0
    v_mfma_f32_16x16x32_bf16 v[220:223], a[4:7], v[96:99], 0
    v_mfma_f32_16x16x32_bf16 v[228:231], a[4:7], v[100:103], 0
    s_waitcnt lgkmcnt(10)
    v_mfma_f32_16x16x32_bf16 v[232:235], a[8:11], v[96:99], 0
    v_mfma_f32_16x16x32_bf16 v[240:243], a[8:11], v[100:103], 0
    s_waitcnt lgkmcnt(8)
    v_mfma_f32_16x16x32_bf16 v[236:239], a[12:15], v[96:99], 0
    v_mfma_f32_16x16x32_bf16 v[244:247], a[12:15], v[100:103], 0
    v_cvt_pk_bf16_f32 v184, v216, v217
    v_cvt_pk_bf16_f32 v185, v218, v219
    v_cvt_pk_bf16_f32 v186, v220, v221
    v_cvt_pk_bf16_f32 v187, v222, v223
    v_cvt_pk_bf16_f32 v188, v224, v225
    v_cvt_pk_bf16_f32 v189, v226, v227
    v_cvt_pk_bf16_f32 v190, v228, v229
    v_cvt_pk_bf16_f32 v191, v230, v231
    s_waitcnt lgkmcnt(6)
    v_mfma_f32_16x16x32_bf16 v[216:219], a[16:19], v[96:99], 0
    v_mfma_f32_16x16x32_bf16 v[224:227], a[16:19], v[100:103], 0
    s_waitcnt lgkmcnt(4)
    v_mfma_f32_16x16x32_bf16 v[220:223], a[20:23], v[96:99], 0
    v_mfma_f32_16x16x32_bf16 v[228:231], a[20:23], v[100:103], 0
    s_mov_b64 exec, s[76:77]
    ds_write_b128 v212, v[184:187] offset:0
    ds_write_b128 v212, v[188:191] offset:1024
    s_mov_b64 exec, -1
    v_cvt_pk_bf16_f32 v192, v232, v233
    v_cvt_pk_bf16_f32 v193, v234, v235
    v_cvt_pk_bf16_f32 v194, v236, v237
    v_cvt_pk_bf16_f32 v195, v238, v239
    v_cvt_pk_bf16_f32 v196, v240, v241
    v_cvt_pk_bf16_f32 v197, v242, v243
    v_cvt_pk_bf16_f32 v198, v244, v245
    v_cvt_pk_bf16_f32 v199, v246, v247
    s_waitcnt lgkmcnt(4)
    v_mfma_f32_16x16x32_bf16 v[232:235], a[24:27], v[96:99], 0
    v_mfma_f32_16x16x32_bf16 v[240:243], a[24:27], v[100:103], 0
    s_waitcnt lgkmcnt(2)
    v_mfma_f32_16x16x32_bf16 v[236:239], a[28:31], v[96:99], 0
    v_mfma_f32_16x16x32_bf16 v[244:247], a[28:31], v[100:103], 0
    s_mov_b64 exec, s[76:77]
    ds_write_b128 v212, v[192:195] offset:16
    ds_write_b128 v212, v[196:199] offset:1040
    s_mov_b64 exec, -1
    v_cvt_pk_bf16_f32 v184, v216, v217
    v_cvt_pk_bf16_f32 v185, v218, v219
    v_cvt_pk_bf16_f32 v186, v220, v221
    v_cvt_pk_bf16_f32 v187, v222, v223
    v_cvt_pk_bf16_f32 v188, v224, v225
    v_cvt_pk_bf16_f32 v189, v226, v227
    v_cvt_pk_bf16_f32 v190, v228, v229
    v_cvt_pk_bf16_f32 v191, v230, v231
    s_mov_b64 exec, s[76:77]
    ds_write_b128 v212, v[184:187] offset:32
    ds_write_b128 v212, v[188:191] offset:1056
    s_mov_b64 exec, -1
    v_cvt_pk_bf16_f32 v192, v232, v233
    v_cvt_pk_bf16_f32 v193, v234, v235
    v_cvt_pk_bf16_f32 v194, v236, v237
    v_cvt_pk_bf16_f32 v195, v238, v239
    v_cvt_pk_bf16_f32 v196, v240, v241
    v_cvt_pk_bf16_f32 v197, v242, v243
    v_cvt_pk_bf16_f32 v198, v244, v245
    v_cvt_pk_bf16_f32 v199, v246, v247
    s_mov_b64 exec, s[76:77]
    ds_write_b128 v212, v[192:195] offset:48
    ds_write_b128 v212, v[196:199] offset:1072
    s_mov_b64 exec, -1
    s_waitcnt lgkmcnt(0)
    s_barrier
    ds_read_b128 a[0:3], v213 offset:0
    ds_read_b128 a[4:7], v213 offset:1024
    ds_read_b128 a[8:11], v214 offset:4128
    ds_read_b128 a[12:15], v214 offset:5152
    ds_read_b128 a[16:19], v214 offset:8256
    ds_read_b128 a[20:23], v214 offset:9280
    ds_read_b128 a[24:27], v214 offset:12384
    ds_read_b128 a[28:31], v214 offset:13408
    ds_read_b128 a[32:35], v214 offset:16512
    ds_read_b128 a[36:39], v214 offset:17536
    s_cmp_lg_u32 s32, 0
    s_cbranch_scc1 L_sm_23
    v_mov_b32 v95, 0
    s_mov_b64 exec, 0xff
    buffer_atomic_add v95, v93, s[24:27], s97 offen offset:0 sc0 sc1
    s_mov_b64 exec, -1
L_sm_23:
    s_waitcnt lgkmcnt(8)
    v_mfma_f32_16x16x32_bf16 v[216:219], a[0:3], v[104:107], 0
    v_mfma_f32_16x16x32_bf16 v[220:223], a[0:3], v[116:119], 0
    v_mfma_f32_16x16x32_bf16 v[216:219], a[4:7], v[108:111], v[216:219]
    v_mfma_f32_16x16x32_bf16 v[220:223], a[4:7], v[112:115], v[220:223]
    s_waitcnt lgkmcnt(6)
    v_mfma_f32_16x16x32_bf16 v[224:227], a[8:11], v[120:123], 0
    v_mfma_f32_16x16x32_bf16 v[228:231], a[8:11], v[132:135], 0
    v_mfma_f32_16x16x32_bf16 v[224:227], a[12:15], v[124:127], v[224:227]
    v_mfma_f32_16x16x32_bf16 v[228:231], a[12:15], v[128:131], v[228:231]
    s_nop 1
    v_cvt_pk_bf16_f32 v184, v216, v217
    v_cvt_pk_bf16_f32 v185, v218, v219
    v_cvt_pk_bf16_f32 v186, v220, v221
    v_cvt_pk_bf16_f32 v187, v222, v223
    s_nop 0
    v_permlane16_swap_b32 v184, v186
    v_permlane16_swap_b32 v185, v187
    s_waitcnt lgkmcnt(4)
    v_mfma_f32_16x16x32_bf16 v[232:235], a[16:19], v[136:139], 0
    v_mfma_f32_16x16x32_bf16 v[236:239], a[16:19], v[148:151], 0
    v_mfma_f32_16x16x32_bf16 v[232:235], a[20:23], v[140:143], v[232:235]
    v_mfma_f32_16x16x32_bf16 v[236:239], a[20:23], v[144:147], v[236:239]
    v_cvt_pk_bf16_f32 v188, v224, v225
    v_cvt_pk_bf16_f32 v189, v226, v227
    v_cvt_pk_bf16_f32 v190, v228, v229
    v_cvt_pk_bf16_f32 v191, v230, v231
    s_nop 0
    v_permlane16_swap_b32 v188, v190
    v_permlane16_swap_b32 v189, v191
    s_waitcnt lgkmcnt(2)
    v_mfma_f32_16x16x32_bf16 v[240:243], a[24:27], v[152:155], 0
    v_mfma_f32_16x16x32_bf16 v[244:247], a[24:27], v[164:167], 0
    v_mfma_f32_16x16x32_bf16 v[240:243], a[28:31], v[156:159], v[240:243]
    v_mfma_f32_16x16x32_bf16 v[244:247], a[28:31], v[160:163], v[244:247]
    s_waitcnt lgkmcnt(0)
    v_mfma_f32_16x16x32_bf16 v[216:219], a[32:35], v[168:171], 0
    v_mfma_f32_16x16x32_bf16 v[220:223], a[32:35], v[180:183], 0
    v_mfma_f32_16x16x32_bf16 v[216:219], a[36:39], v[172:175], v[216:219]
    v_mfma_f32_16x16x32_bf16 v[220:223], a[36:39], v[176:179], v[220:223]
    v_cvt_pk_bf16_f32 v192, v232, v233
    v_cvt_pk_bf16_f32 v193, v234, v235
    v_cvt_pk_bf16_f32 v194, v236, v237
    v_cvt_pk_bf16_f32 v195, v238, v239
    s_nop 0
    v_permlane16_swap_b32 v192, v194
    v_permlane16_swap_b32 v193, v195
    v_cvt_pk_bf16_f32 v196, v240, v241
    v_cvt_pk_bf16_f32 v197, v242, v243
    v_cvt_pk_bf16_f32 v198, v244, v245
    v_cvt_pk_bf16_f32 v199, v246, v247
    s_nop 0
    v_permlane16_swap_b32 v196, v198
    v_permlane16_swap_b32 v197, v199
    v_cvt_pk_bf16_f32 v216, v216, v217
    v_cvt_pk_bf16_f32 v217, v218, v219
    v_cvt_pk_bf16_f32 v218, v220, v221
    v_cvt_pk_bf16_f32 v219, v222, v223
    s_nop 0
    v_permlane16_swap_b32 v216, v218
    v_permlane16_swap_b32 v217, v219
    s_waitcnt vmcnt(0)
    s_branch L_a_end
L_a_wt:
    s_lshl2_add_u32 s46, s34, s32
    s_cmp_lg_u32 s46, 115
    s_cbranch_scc1 L_a_w2
    v_mov_b32 v6, 1
    v_lshlrev_b32 v248, 2, s33
    s_waitcnt vmcnt(9)
    s_mov_b64 exec, 1
    global_store_dword v248, v6, s[20:21] sc1
    s_mov_b64 exec, -1
L_a_w2:
    s_and_b32 s49, s32, 1
    s_mul_i32 s49, s49, 5
    s_bitcmp1_b32 s32, 1
    s_cselect_b32 s52, -40, 40
    s_cselect_b32 s54, 620, 0
    s_cselect_b32 s53, -1, 1
    s_cselect_b32 s50, 133120, 0
    s_cmp_eq_u32 s32, 2
    s_cselect_b32 s51, 9, s53
    s_mul_i32 s53, s53, 266240
    s_mul_i32 s51, s51, 266240
    s_lshl1_add_u32 s54, s49, s54
    s_and_b32 s55, s37, 8
    v_bfrev_b32 v250, v3
    v_lshrrev_b32 v250, 30, v250
    v_mul_i32_i24 v249, s52, v2
    v_add_u32 v249, s54, v249
    v_mul_u32_u24 v251, 642, v250
    v_add_u32 v251, s55, v251
    v_add_u32 v200, v251, v249
    v_add_u32 v251, 640, v251
    v_cndmask_b32 v201, v200, v251, s[72:73]
    v_add_u32 v200, 2, v200
    v_and_b32 v203, 2, v200
    v_and_b32 v200, -4, v200
    v_lshrrev_b32 v202, 1, v2
    v_mul_u32_u24 v202, 16512, v202
    v_lshl_add_u32 v202, v2, 6, v202
    v_lshl_add_u32 v202, v250, 4, v202
    s_and_b32 s46, s37, 1
    s_lshl_b32 s46, s46, 12
    s_lshr_b32 s47, s37, 5
    s_lshl_b32 s47, s47, 10
    s_add_u32 s46, s46, s47
    s_and_b32 s47, s37, 6
    s_lshl_b32 s47, s47, 7
    s_add_u32 s46, s46, s47
    s_and_b32 s47, s37, 24
    s_lshl3_add_u32 s46, s47, s46
    s_mul_i32 s49, s49, 266240
    s_lshl1_add_u32 s46, s46, s49
    s_add_u32 s46, s46, s50
    s_add_u32 s46, s46, 31514624
    s_mov_b32 s47, 0x05040100
    s_mov_b32 s48, 0x07060302
    s_lshl2_add_u32 s56, s34, s32
    s_cmp_eq_u32 s56, 115
    s_waitcnt vmcnt(3)
    s_cbranch_scc1 L_a_w3
    s_waitcnt vmcnt(2)
L_a_w3:
    s_barrier
    ds_read_u16 v192, v201 offset:0
    ds_read_u16 v193, v201 offset:2576
    ds_read_u16 v194, v201 offset:5152
    ds_read_u16 v195, v201 offset:7728
    ds_read_u16 v196, v201 offset:10304
    ds_read_u16 v197, v201 offset:12880
    ds_read_u16 v198, v201 offset:15456
    ds_read_u16 v199, v201 offset:18032
    ds_read2_b32 v[184:185], v200 offset0:0 offset1:1
    ds_read_b32 v244, v200 offset:8
    v_add_u32 v200, 2576, v200
    ds_read2_b32 v[186:187], v200 offset0:0 offset1:1
    ds_read_b32 v245, v200 offset:8
    v_add_u32 v200, 2576, v200
    ds_read2_b32 v[188:189], v200 offset0:0 offset1:1
    ds_read_b32 v246, v200 offset:8
    v_add_u32 v200, 2576, v200
    s_waitcnt lgkmcnt(6)
    ds_read2_b32 v[190:191], v200 offset0:0 offset1:1
    ds_read_b32 v247, v200 offset:8
    v_add_u32 v200, 2576, v200
    ds_read2_b32 v[236:237], v200 offset0:0 offset1:1
    ds_read_b32 v208, v200 offset:8
    v_add_u32 v200, 2576, v200
    ds_read2_b32 v[238:239], v200 offset0:0 offset1:1
    ds_read_b32 v209, v200 offset:8
    v_add_u32 v200, 2576, v200
    ds_read2_b32 v[240:241], v200 offset0:0 offset1:1
    ds_read_b32 v210, v200 offset:8
    v_add_u32 v200, 2576, v200
    v_lshl_or_b32 v216, v193, 16, v192
    v_lshl_or_b32 v217, v195, 16, v194
    v_lshl_or_b32 v218, v197, 16, v196
    v_lshl_or_b32 v219, v199, 16, v198
    buffer_store_dwordx4 v[216:219], v202, s[24:27], s46 offen sc1
    s_add_u32 s46, s46, s51
    s_waitcnt lgkmcnt(12)
    ds_read2_b32 v[242:243], v200 offset0:0 offset1:1
    ds_read_b32 v211, v200 offset:8
    v_alignbyte_b32 v184, v185, v184, v203
    v_alignbyte_b32 v185, v244, v185, v203
    s_waitcnt lgkmcnt(12)
    v_alignbyte_b32 v186, v187, v186, v203
    v_alignbyte_b32 v187, v245, v187, v203
    s_waitcnt lgkmcnt(10)
    v_alignbyte_b32 v188, v189, v188, v203
    v_alignbyte_b32 v189, v246, v189, v203
    s_waitcnt lgkmcnt(8)
    v_alignbyte_b32 v190, v191, v190, v203
    v_alignbyte_b32 v191, v247, v191, v203
    s_waitcnt lgkmcnt(6)
    v_alignbyte_b32 v236, v237, v236, v203
    v_alignbyte_b32 v237, v208, v237, v203
    s_waitcnt lgkmcnt(4)
    v_alignbyte_b32 v238, v239, v238, v203
    v_alignbyte_b32 v239, v209, v239, v203
    s_waitcnt lgkmcnt(2)
    v_alignbyte_b32 v240, v241, v240, v203
    v_alignbyte_b32 v241, v210, v241, v203
    s_waitcnt lgkmcnt(0)
    v_alignbyte_b32 v242, v243, v242, v203
    v_alignbyte_b32 v243, v211, v243, v203
    v_perm_b32 v220, v186, v184, s47
    v_perm_b32 v221, v190, v188, s47
    v_perm_b32 v222, v238, v236, s47
    v_perm_b32 v223, v242, v240, s47
    buffer_store_dwordx4 v[220:223], v202, s[24:27], s46 offen sc1
    s_branch L_pgx2
L_pg2:
    s_setpc_b64 s[40:41]
L_pgx2:
    s_add_u32 s46, s46, s53
    v_perm_b32 v224, v186, v184, s48
    v_perm_b32 v225, v190, v188, s48
    v_perm_b32 v226, v238, v236, s48
    v_perm_b32 v227, v242, v240, s48
    buffer_store_dwordx4 v[224:227], v202, s[24:27], s46 offen sc1
    s_add_u32 s46, s46, s53
    v_perm_b32 v228, v187, v185, s47
    v_perm_b32 v229, v191, v189, s47
    v_perm_b32 v230, v239, v237, s47
    v_perm_b32 v231, v243, v241, s47
    buffer_store_dwordx4 v[228:231], v202, s[24:27], s46 offen sc1
    s_add_u32 s46, s46, s53
    v_perm_b32 v232, v187, v185, s48
    v_perm_b32 v233, v191, v189, s48
    v_perm_b32 v234, v239, v237, s48
    v_perm_b32 v235, v243, v241, s48
    buffer_store_dwordx4 v[232:235], v202, s[24:27], s46 offen sc1
    global_load_dword v6, v94, s[20:21] sc1
    s_sub_u32 s37, s34, 20
    s_cmp_ge_u32 s34, 28
    s_cbranch_scc1 L_a_s
    s_and_b32 s56, s33, 6
    s_mul_i32 s75, s56, 24
    s_and_b32 s56, s34, 15
    s_lshl2_add_u32 s75, s56, s75
    s_mov_b32 s70, 0
    s_bitcmp0_b32 s33, 0
    s_cselect_b32 s28, s12, s14
    s_cselect_b32 s29, s13, s15
    s_mov_b32 s30, 1966080
    v_lshrrev_b32 v204, 2, v1
    v_and_b32 v206, 3, v1
    v_and_b32 v207, 1, v3
    v_lshlrev_b32 v207, 1, v207
    v_xor_b32 v207, v207, v206
    v_and_b32 v205, 3, v204
    v_lshl_add_u32 v205, v205, 5, v3
    v_mul_u32_u24 v204, 98304, v204
    v_mul_u32_u24 v205, 3072, v205
    v_lshl_add_u32 v204, v207, 4, v204
    v_lshl_add_u32 v205, v206, 4, v205
    s_mul_i32 s59, s32, 12288
    s_lshl4_add_u32 s59, s75, s59
    s_mul_i32 s61, s32, 10240
    s_add_u32 m0, s61, 53248
    s_add_u32 s60, s59, 1572864
    buffer_load_dwordx4 v205, s[28:31], s60 offen lds
    v_lshlrev_b32 v252, 2, v3
    v_cvt_f32_u32 v252, v252
    v_cvt_f32_u32 v254, v2
    s_lshl_b32 s46, s32, 4
    v_add_u32 v248, s46, v2
    v_cvt_f32_u32 v72, v248
    s_mov_b32 s47, 0x80008000
    v_mul_f32 v253, 0x3c800000, v72
    v_mul_f32 v240, v253, v252
    v_add_f32 v241, v240, v253
    v_fma_f32 v242, v253, 2.0, v240
    v_fma_f32 v243, v253, 2.0, v241
    v_mul_f32 v248, 0x41800000, v253
    v_add_f32 v244, v240, v248
    v_add_f32 v245, v241, v248
    v_add_f32 v246, v242, v248
    v_add_f32 v247, v243, v248
    v_cos_f32 v248, v240
    v_cos_f32 v249, v241
    v_sin_f32 v250, v240
    v_sin_f32 v251, v241
    v_cvt_pk_bf16_f32 v8, v248, v249
    v_cvt_pk_bf16_f32 v16, v250, v251
    s_add_u32 m0, s61, 45056
    s_add_u32 s60, s59, 0
    buffer_load_dwordx4 v204, s[28:31], s60 offen lds
    v_cos_f32 v248, v242
    v_cos_f32 v249, v243
    v_sin_f32 v250, v242
    v_sin_f32 v251, v243
    v_cvt_pk_bf16_f32 v9, v248, v249
    v_cvt_pk_bf16_f32 v17, v250, v251
    v_cos_f32 v248, v244
    v_cos_f32 v249, v245
    v_sin_f32 v250, v244
    v_sin_f32 v251, v245
    v_cvt_pk_bf16_f32 v10, v248, v249
    s_add_u32 m0, s61, 46080
    s_add_u32 s60, s59, 3072
    buffer_load_dwordx4 v204, s[28:31], s60 offen lds
    v_cvt_pk_bf16_f32 v18, v250, v251
    v_cos_f32 v248, v246
    v_cos_f32 v249, v247
    v_sin_f32 v250, v246
    v_sin_f32 v251, v247
    v_cvt_pk_bf16_f32 v11, v248, v249
    v_cvt_pk_bf16_f32 v19, v250, v251
    v_and_b32 v248, 1, v2
    v_mul_lo_u32 v248, v248, s47
    v_xor_b32 v12, v248, v8
    v_xor_b32 v20, v248, v16
    v_xor_b32 v13, v248, v9
    v_xor_b32 v21, v248, v17
    v_xor_b32 v14, v248, v10
    v_xor_b32 v22, v248, v18
    v_xor_b32 v15, v248, v11
    v_xor_b32 v23, v248, v19
    v_xor_b32 v24, s47, v16
    v_xor_b32 v25, s47, v17
    v_xor_b32 v26, s47, v18
    v_xor_b32 v27, s47, v19
    v_xor_b32 v28, s47, v20
    v_xor_b32 v29, s47, v21
    s_add_u32 m0, s61, 47104
    s_add_u32 s60, s59, 6144
    buffer_load_dwordx4 v204, s[28:31], s60 offen lds
    v_xor_b32 v30, s47, v22
    v_xor_b32 v31, s47, v23
    v_mul_f32 v253, 0x3a000000, v72
    v_mul_f32 v240, v253, v252
    v_add_f32 v241, v240, v253
    v_fma_f32 v242, v253, 2.0, v240
    v_fma_f32 v243, v253, 2.0, v241
    v_mul_f32 v248, 0x41800000, v253
    v_add_f32 v244, v240, v248
    v_add_f32 v245, v241, v248
    v_add_f32 v246, v242, v248
    v_add_f32 v247, v243, v248
    v_cos_f32 v56, v240
    v_sin_f32 v64, v240
    v_cos_f32 v57, v241
    v_sin_f32 v65, v241
    v_cos_f32 v58, v242
    v_sin_f32 v66, v242
    s_add_u32 m0, s61, 48128
    s_add_u32 s60, s59, 9216
    buffer_load_dwordx4 v204, s[28:31], s60 offen lds
    v_cos_f32 v59, v243
    v_sin_f32 v67, v243
    v_cos_f32 v60, v244
    v_sin_f32 v68, v244
    v_cos_f32 v61, v245
    v_sin_f32 v69, v245
    v_cos_f32 v62, v246
    v_sin_f32 v70, v246
    v_cos_f32 v63, v247
    s_add_u32 m0, s61, 54272
    s_add_u32 s60, s59, 1622016
    buffer_load_dwordx4 v205, s[28:31], s60 offen lds
    v_sin_f32 v71, v247
    v_mul_f32 v253, 0x3d000000, v254
    v_mul_f32 v240, v253, v252
    v_add_f32 v241, v240, v253
    v_fma_f32 v242, v253, 2.0, v240
    v_fma_f32 v243, v253, 2.0, v241
    v_mul_f32 v248, 0x41800000, v253
    v_add_f32 v244, v240, v248
    v_add_f32 v245, v241, v248
    v_add_f32 v246, v242, v248
    v_add_f32 v247, v243, v248
    v_cos_f32 v248, v240
    v_cos_f32 v249, v241
    v_sin_f32 v250, v240
    v_sin_f32 v251, v241
    v_cvt_pk_bf16_f32 v32, v248, v249
    v_cvt_pk_bf16_f32 v40, v250, v251
    s_add_u32 m0, s61, 49152
    s_add_u32 s60, s59, 49152
    buffer_load_dwordx4 v204, s[28:31], s60 offen lds
    v_cos_f32 v248, v242
    v_cos_f32 v249, v243
    v_sin_f32 v250, v242
    v_sin_f32 v251, v243
    v_cvt_pk_bf16_f32 v33, v248, v249
    v_cvt_pk_bf16_f32 v41, v250, v251
    v_cos_f32 v248, v244
    v_cos_f32 v249, v245
    v_sin_f32 v250, v244
    v_sin_f32 v251, v245
    v_cvt_pk_bf16_f32 v34, v248, v249
    s_add_u32 m0, s61, 50176
    s_add_u32 s60, s59, 52224
    buffer_load_dwordx4 v204, s[28:31], s60 offen lds
    v_cvt_pk_bf16_f32 v42, v250, v251
    v_cos_f32 v248, v246
    v_cos_f32 v249, v247
    v_sin_f32 v250, v246
    v_sin_f32 v251, v247
    v_cvt_pk_bf16_f32 v35, v248, v249
    v_cvt_pk_bf16_f32 v43, v250, v251
    v_xor_b32 v36, 0x80000000, v32
    v_xor_b32 v44, 0x80000000, v40
    v_xor_b32 v37, 0x80000000, v33
    v_xor_b32 v45, 0x80000000, v41
    v_xor_b32 v38, 0x80000000, v34
    v_xor_b32 v46, 0x80000000, v42
    v_xor_b32 v39, 0x80000000, v35
    v_xor_b32 v47, 0x80000000, v43
    v_xor_b32 v48, s47, v40
    v_xor_b32 v49, s47, v41
    v_xor_b32 v50, s47, v42
    v_xor_b32 v51, s47, v43
    v_xor_b32 v52, s47, v44
    v_xor_b32 v53, s47, v45
    v_xor_b32 v54, s47, v46
    s_add_u32 m0, s61, 51200
    s_add_u32 s60, s59, 55296
    buffer_load_dwordx4 v204, s[28:31], s60 offen lds
    v_xor_b32 v55, s47, v47
    v_cvt_f32_u32 v248, s46
    v_add_f32 v248, v248, v252
    v_mul_f32 v253, 0x3a000000, v254
    v_mul_f32 v240, v253, v248
    v_add_f32 v241, v240, v253
    v_fma_f32 v242, v253, 2.0, v240
    v_fma_f32 v243, v253, 2.0, v241
    v_mul_f32 v253, 0x3a000000, v254
    v_add_f32 v253, 0x3c000000, v253
    v_mul_f32 v244, v253, v248
    v_add_f32 v245, v244, v253
    v_fma_f32 v246, v253, 2.0, v244
    v_fma_f32 v247, v253, 2.0, v245
    v_cos_f32 v72, v240
    v_sin_f32 v80, v240
    v_cos_f32 v73, v241
    v_sin_f32 v81, v241
    v_cos_f32 v74, v242
    v_sin_f32 v82, v242
    s_add_u32 m0, s61, 52224
    s_add_u32 s60, s59, 58368
    buffer_load_dwordx4 v204, s[28:31], s60 offen lds
    v_cos_f32 v75, v243
    v_sin_f32 v83, v243
    v_cos_f32 v76, v244
    v_sin_f32 v84, v244
    v_cos_f32 v77, v245
    v_sin_f32 v85, v245
    v_cos_f32 v78, v246
    v_sin_f32 v86, v246
    s_waitcnt vmcnt(10)
    s_mov_b32 s42, 65536
L_ga_24:
    v_cmp_eq_u32 vcc, 0, v6
    s_cbranch_vccz L_gb_25
    global_load_dword v6, v94, s[20:21] sc1
    s_sub_u32 s42, s42, 1
    s_waitcnt vmcnt(0)
    s_cbranch_scc0 L_ga_24
L_gb_25:
    v_mul_u32_u24 v200, 4096, v1
    v_mov_b32 v201, 1
    s_barrier
    s_cmp_lg_u32 s32, 0
    s_cbranch_scc1 L_sg_26
    s_mov_b64 exec, 0xffff
    buffer_atomic_add v201, v200, s[24:27], s43 offen offset:0 sc1
    s_mov_b64 exec, -1
L_sg_26:
    v_cos_f32 v79, v247
    v_sin_f32 v87, v247
    s_lshl_b32 s48, s32, 10
    v_lshrrev_b32 v248, 1, v2
    v_and_b32 v248, 2, v248
    v_xor_b32 v248, v248, v3
    v_lshlrev_b32 v248, 4, v248
    v_lshl_add_u32 v248, v2, 6, v248
    v_add_u32 v90, s48, v248
    v_lshrrev_b32 v248, 2, v1
    v_lshlrev_b32 v248, 6, v248
    v_and_b32 v249, 3, v1
    v_lshl_add_u32 v248, v249, 3, v248
    v_and_b32 v249, 1, v3
    v_lshl_add_u32 v88, v249, 5, v248
    v_xor_b32 v89, 32, v88
    s_lshr_b32 s48, s32, 1
    s_lshl_b32 s48, s48, 6
    s_and_b32 s49, s32, 1
    s_lshl_b32 s49, s49, 3
    s_add_u32 s48, s48, s49
    v_mul_u32_u24 v91, 144, v2
    v_lshl_add_u32 v91, v3, 4, v91
    v_add_u32 v91, s48, v91
    v_and_b32 v248, 12, v2
    v_add_u32 v248, v248, v2
    v_mul_u32_u24 v248, 144, v248
    v_lshl_add_u32 v92, v3, 4, v248
    s_mul_i32 s46, s32, 10240
    s_add_u32 s46, s46, 45056
    v_lshrrev_b32 v248, 2, v2
    v_and_b32 v249, 3, v1
    v_lshl_add_u32 v249, v249, 3, s46
    v_lshl_add_u32 v201, v248, 6, v249
    v_and_b32 v248, 1, v3
    v_lshl_add_u32 v248, v3, 3, v248
    v_lshl_add_u32 v200, v248, 5, v201
    s_lshl_b32 s46, s32, 8
    s_add_u32 s46, s46, 90112
    v_lshl_add_u32 v250, v2, 4, s46
    v_mul_u32_u24 v251, 8256, v3
    v_add_u32 v212, v250, v251
    v_cndmask_b32 v116, v116, 0, s[72:73]
    v_cndmask_b32 v117, v117, 0, s[72:73]
    v_cndmask_b32 v118, v118, 0, s[72:73]
    v_cndmask_b32 v119, v119, 0, s[72:73]
    v_lshrrev_b32 v250, 1, v2
    v_xor_b32 v250, v250, v2
    v_and_b32 v250, 2, v250
    v_mul_u32_u24 v250, 3, v250
    v_xor_b32 v250, v250, v2
    v_and_b32 v250, 7, v250
    v_lshl_add_u32 v250, v3, 4, v250
    v_lshlrev_b32 v203, 4, v250
    v_lshrrev_b32 v204, 3, v2
    s_and_b32 s53, s33, 1
    s_mul_i32 s52, s53, 896
    s_lshl_b32 s53, s53, 10
    s_sub_u32 s51, 1920, s52
    s_add_u32 s52, s52, 59392
    s_waitcnt vmcnt(1)
    s_cmp_eq_u32 s32, 0
    s_cbranch_scc1 L_gw_27
    s_waitcnt vmcnt(0)
L_gw_27:
    ds_read_b64_tr_b16 a[0:1], v200 offset:0
    ds_read_b64_tr_b16 a[2:3], v201 offset:8192
    ds_read_b64_tr_b16 a[4:5], v200 offset:1024
    ds_read_b64_tr_b16 a[6:7], v201 offset:8448
    ds_read_b64_tr_b16 a[8:9], v200 offset:2048
    ds_read_b64_tr_b16 a[10:11], v201 offset:8704
    ds_read_b64_tr_b16 a[12:13], v200 offset:3072
    ds_read_b64_tr_b16 a[14:15], v201 offset:8960
    ds_read_b64_tr_b16 a[16:17], v200 offset:4096
    ds_read_b64_tr_b16 a[18:19], v201 offset:9216
    ds_read_b64_tr_b16 a[20:21], v200 offset:5120
    ds_read_b64_tr_b16 a[22:23], v201 offset:9472
    ds_read_b64_tr_b16 a[24:25], v200 offset:6144
    ds_read_b64_tr_b16 a[26:27], v201 offset:9728
    v_xor_b32 v205, 32, v200
    v_xor_b32 v206, 32, v201
    s_mul_i32 s47, s75, 171
    s_lshr_b32 s47, s47, 9
    s_mul_i32 s48, s47, 3
    s_sub_u32 s48, s75, s48
    s_cmp_eq_u32 s48, 0
    s_cselect_b32 s49, 128, s51
    s_cselect_b32 s46, 0, 128
    s_cmp_eq_u32 s48, 2
    s_cselect_b32 s49, s52, s49
    s_cselect_b32 s48, s51, 0
    v_mad_u32_u24 v202, v204, s49, v203
    s_mul_i32 s47, s47, 61440
    s_add_u32 s46, s46, s48
    s_add_u32 s46, s46, s47
    v_add_u32 v202, s46, v202
    ds_read_b64_tr_b16 a[28:29], v200 offset:7168
    s_waitcnt lgkmcnt(11)
    ds_read_b64_tr_b16 a[30:31], v201 offset:9984
    v_mfma_f32_16x16x32_bf16 v[216:219], v[96:99], a[0:3], 0
    ds_read_b64_tr_b16 a[32:33], v205 offset:0
    ds_read_b64_tr_b16 a[34:35], v206 offset:8192
    v_mfma_f32_16x16x32_bf16 v[220:223], v[96:99], a[4:7], 0
    ds_read_b64_tr_b16 a[36:37], v205 offset:1024
    s_waitcnt lgkmcnt(11)
    ds_read_b64_tr_b16 a[38:39], v206 offset:8448
    v_mfma_f32_16x16x32_bf16 v[224:227], v[96:99], a[8:11], 0
    ds_read_b64_tr_b16 a[40:41], v205 offset:2048
    ds_read_b64_tr_b16 a[42:43], v206 offset:8704
    v_mfma_f32_16x16x32_bf16 v[228:231], v[96:99], a[12:15], 0
    ds_read_b64_tr_b16 a[44:45], v205 offset:3072
    s_waitcnt lgkmcnt(11)
    ds_read_b64_tr_b16 a[46:47], v206 offset:8960
    v_mfma_f32_16x16x32_bf16 v[232:235], v[96:99], a[16:19], 0
    ds_read_b64_tr_b16 a[48:49], v205 offset:4096
    ds_read_b64_tr_b16 a[50:51], v206 offset:9216
    v_mfma_f32_16x16x32_bf16 v[236:239], v[96:99], a[20:23], 0
    ds_read_b64_tr_b16 a[52:53], v205 offset:5120
    s_waitcnt lgkmcnt(11)
    ds_read_b64_tr_b16 a[54:55], v206 offset:9472
    v_mfma_f32_16x16x32_bf16 v[240:243], v[96:99], a[24:27], 0
    ds_read_b64_tr_b16 a[56:57], v205 offset:6144
    ds_read_b64_tr_b16 a[58:59], v206 offset:9728
    v_mfma_f32_16x16x32_bf16 v[244:247], v[96:99], a[28:31], 0
    ds_read_b64_tr_b16 a[60:61], v205 offset:7168
    s_waitcnt lgkmcnt(11)
    ds_read_b64_tr_b16 a[62:63], v206 offset:9984
    v_cvt_pk_bf16_f32 v184, v216, v220
    v_cvt_pk_bf16_f32 v188, v217, v221
    v_cvt_pk_bf16_f32 v192, v218, v222
    v_cvt_pk_bf16_f32 v196, v219, v223
    v_mfma_f32_16x16x32_bf16 v[216:219], v[100:103], a[0:3], 0
    v_mfma_f32_16x16x32_bf16 v[220:223], v[100:103], a[4:7], 0
    v_cvt_pk_bf16_f32 v185, v224, v228
    v_cvt_pk_bf16_f32 v189, v225, v229
    v_cvt_pk_bf16_f32 v193, v226, v230
    v_cvt_pk_bf16_f32 v197, v227, v231
    v_mfma_f32_16x16x32_bf16 v[224:227], v[100:103], a[8:11], 0
    v_mfma_f32_16x16x32_bf16 v[228:231], v[100:103], a[12:15], 0
    v_cvt_pk_bf16_f32 v186, v232, v236
    v_cvt_pk_bf16_f32 v190, v233, v237
    v_cvt_pk_bf16_f32 v194, v234, v238
    v_cvt_pk_bf16_f32 v198, v235, v239
    v_mfma_f32_16x16x32_bf16 v[232:235], v[100:103], a[16:19], 0
    v_mfma_f32_16x16x32_bf16 v[236:239], v[100:103], a[20:23], 0
    v_cvt_pk_bf16_f32 v187, v240, v244
    v_cvt_pk_bf16_f32 v191, v241, v245
    v_cvt_pk_bf16_f32 v195, v242, v246
    v_cvt_pk_bf16_f32 v199, v243, v247
    v_mfma_f32_16x16x32_bf16 v[240:243], v[100:103], a[24:27], 0
    v_mfma_f32_16x16x32_bf16 v[244:247], v[100:103], a[28:31], 0
    s_mov_b32 exec_hi, 0xffff
    ds_write_b128 v212, v[184:187] offset:0
    ds_write_b128 v212, v[188:191] offset:2064
    ds_write_b128 v212, v[192:195] offset:4128
    s_waitcnt lgkmcnt(11)
    ds_write_b128 v212, v[196:199] offset:6192
    s_mov_b32 exec_hi, -1
    v_cvt_pk_bf16_f32 v184, v216, v220
    v_cvt_pk_bf16_f32 v188, v217, v221
    v_cvt_pk_bf16_f32 v192, v218, v222
    v_cvt_pk_bf16_f32 v196, v219, v223
    v_mfma_f32_16x16x32_bf16 v[216:219], v[96:99], a[32:35], 0
    v_mfma_f32_16x16x32_bf16 v[220:223], v[96:99], a[36:39], 0
    v_cvt_pk_bf16_f32 v185, v224, v228
    v_cvt_pk_bf16_f32 v189, v225, v229
    v_cvt_pk_bf16_f32 v193, v226, v230
    v_cvt_pk_bf16_f32 v197, v227, v231
    v_mfma_f32_16x16x32_bf16 v[224:227], v[96:99], a[40:43], 0
    v_mfma_f32_16x16x32_bf16 v[228:231], v[96:99], a[44:47], 0
    v_cvt_pk_bf16_f32 v186, v232, v236
    v_cvt_pk_bf16_f32 v190, v233, v237
    v_cvt_pk_bf16_f32 v194, v234, v238
    v_cvt_pk_bf16_f32 v198, v235, v239
    s_waitcnt lgkmcnt(10)
    v_mfma_f32_16x16x32_bf16 v[232:235], v[96:99], a[48:51], 0
    s_waitcnt lgkmcnt(8)
    v_mfma_f32_16x16x32_bf16 v[236:239], v[96:99], a[52:55], 0
    v_cvt_pk_bf16_f32 v187, v240, v244
    v_cvt_pk_bf16_f32 v191, v241, v245
    v_cvt_pk_bf16_f32 v195, v242, v246
    v_cvt_pk_bf16_f32 v199, v243, v247
    s_waitcnt lgkmcnt(6)
    v_mfma_f32_16x16x32_bf16 v[240:243], v[96:99], a[56:59], 0
    s_waitcnt lgkmcnt(4)
    v_mfma_f32_16x16x32_bf16 v[244:247], v[96:99], a[60:63], 0
    s_mov_b32 exec_hi, 0xffff
    ds_write_b128 v212, v[184:187] offset:1024
    ds_write_b128 v212, v[188:191] offset:3088
    ds_write_b128 v212, v[192:195] offset:5152
    ds_write_b128 v212, v[196:199] offset:7216
    s_mov_b32 exec_hi, -1
    v_cvt_pk_bf16_f32 v184, v216, v220
    v_cvt_pk_bf16_f32 v188, v217, v221
    v_cvt_pk_bf16_f32 v192, v218, v222
    v_cvt_pk_bf16_f32 v196, v219, v223
    v_mfma_f32_16x16x32_bf16 v[216:219], v[100:103], a[32:35], 0
    v_mfma_f32_16x16x32_bf16 v[220:223], v[100:103], a[36:39], 0
    v_cvt_pk_bf16_f32 v185, v224, v228
    v_cvt_pk_bf16_f32 v189, v225, v229
    v_cvt_pk_bf16_f32 v193, v226, v230
    v_cvt_pk_bf16_f32 v197, v227, v231
    v_mfma_f32_16x16x32_bf16 v[224:227], v[100:103], a[40:43], 0
    v_mfma_f32_16x16x32_bf16 v[228:231], v[100:103], a[44:47], 0
    v_cvt_pk_bf16_f32 v186, v232, v236
    v_cvt_pk_bf16_f32 v190, v233, v237
    v_cvt_pk_bf16_f32 v194, v234, v238
    v_cvt_pk_bf16_f32 v198, v235, v239
    v_mfma_f32_16x16x32_bf16 v[232:235], v[100:103], a[48:51], 0
    v_mfma_f32_16x16x32_bf16 v[236:239], v[100:103], a[52:55], 0
    v_cvt_pk_bf16_f32 v187, v240, v244
    v_cvt_pk_bf16_f32 v191, v241, v245
    v_cvt_pk_bf16_f32 v195, v242, v246
    v_cvt_pk_bf16_f32 v199, v243, v247
    v_mfma_f32_16x16x32_bf16 v[240:243], v[100:103], a[56:59], 0
    v_mfma_f32_16x16x32_bf16 v[244:247], v[100:103], a[60:63], 0
    s_mov_b32 exec_hi, 0xffff
    ds_write_b128 v212, v[184:187] offset:24832
    ds_write_b128 v212, v[188:191] offset:26896
    ds_write_b128 v212, v[192:195] offset:28960
    ds_write_b128 v212, v[196:199] offset:31024
    s_mov_b32 exec_hi, -1
    v_cvt_pk_bf16_f32 v184, v216, v220
    v_cvt_pk_bf16_f32 v188, v217, v221
    v_cvt_pk_bf16_f32 v192, v218, v222
    v_cvt_pk_bf16_f32 v196, v219, v223
    v_cvt_pk_bf16_f32 v185, v224, v228
    v_cvt_pk_bf16_f32 v189, v225, v229
    v_cvt_pk_bf16_f32 v193, v226, v230
    v_cvt_pk_bf16_f32 v197, v227, v231
    v_cvt_pk_bf16_f32 v186, v232, v236
    v_cvt_pk_bf16_f32 v190, v233, v237
    v_cvt_pk_bf16_f32 v194, v234, v238
    v_cvt_pk_bf16_f32 v198, v235, v239
    v_cvt_pk_bf16_f32 v187, v240, v244
    v_cvt_pk_bf16_f32 v191, v241, v245
    v_cvt_pk_bf16_f32 v195, v242, v246
    v_cvt_pk_bf16_f32 v199, v243, v247
    s_mov_b32 exec_hi, 0xffff
    ds_write_b128 v212, v[184:187] offset:25856
    ds_write_b128 v212, v[188:191] offset:27920
    ds_write_b128 v212, v[192:195] offset:29984
    s_waitcnt lgkmcnt(11)
    ds_write_b128 v212, v[196:199] offset:32048
    s_mov_b32 exec_hi, -1
    s_add_u32 s75, s75, 2
    s_mul_i32 s47, s75, 171
    s_lshr_b32 s47, s47, 9
    s_mul_i32 s48, s47, 3
    s_sub_u32 s48, s75, s48
    s_cmp_eq_u32 s48, 0
    s_cselect_b32 s49, 128, s51
    s_cselect_b32 s46, 0, 128
    s_cmp_eq_u32 s48, 2
    s_cselect_b32 s49, s52, s49
    s_cselect_b32 s48, s51, 0
    v_mad_u32_u24 v207, v204, s49, v203
    s_mul_i32 s47, s47, 61440
    s_add_u32 s46, s46, s48
    s_add_u32 s46, s46, s47
    v_add_u32 v207, s46, v207
    s_mul_i32 s46, s32, 3072
    s_add_u32 s46, s46, s53
    s_add_u32 s54, s46, 23650304
    s_add_u32 s55, s46, 23662592
    s_add_u32 s56, s46, 23674880
    s_add_u32 s57, s46, 23687168
    s_add_u32 s58, s46, 23699456
    s_waitcnt lgkmcnt(0)
    s_barrier
    ds_read_b128 a[0:3], v213 offset:0
    ds_read_b128 a[4:7], v213 offset:1024
    ds_read_b128 a[8:11], v214 offset:4128
    ds_read_b128 a[12:15], v214 offset:5152
    ds_read_b128 a[16:19], v214 offset:8256
    ds_read_b128 a[20:23], v214 offset:9280
    ds_read_b128 a[24:27], v214 offset:12384
    ds_read_b128 a[28:31], v214 offset:13408
    s_waitcnt lgkmcnt(6)
    v_mfma_f32_16x16x32_bf16 v[216:219], v[104:107], a[0:3], 0
    v_mfma_f32_16x16x32_bf16 v[220:223], v[116:119], a[0:3], 0
    v_mfma_f32_16x16x32_bf16 v[216:219], v[108:111], a[4:7], v[216:219]
    v_mfma_f32_16x16x32_bf16 v[220:223], v[112:115], a[4:7], v[220:223]
    ds_read_b128 a[32:35], v214 offset:16512
    ds_read_b128 a[36:39], v214 offset:17536
    s_waitcnt lgkmcnt(6)
    v_mfma_f32_16x16x32_bf16 v[224:227], v[120:123], a[8:11], 0
    v_mfma_f32_16x16x32_bf16 v[228:231], v[132:135], a[8:11], 0
    v_mfma_f32_16x16x32_bf16 v[224:227], v[124:127], a[12:15], v[224:227]
    v_mfma_f32_16x16x32_bf16 v[228:231], v[128:131], a[12:15], v[228:231]
    ds_read_b128 a[40:43], v213 offset:24832
    ds_read_b128 a[44:47], v213 offset:25856
    v_cvt_pk_bf16_f32 v184, v216, v217
    v_cvt_pk_bf16_f32 v185, v218, v219
    v_cvt_pk_bf16_f32 v186, v220, v221
    v_cvt_pk_bf16_f32 v187, v222, v223
    buffer_store_dwordx4 v[184:187], v202, s[24:27], s54 offen sc1
    s_waitcnt lgkmcnt(6)
    v_mfma_f32_16x16x32_bf16 v[232:235], v[136:139], a[16:19], 0
    v_mfma_f32_16x16x32_bf16 v[236:239], v[148:151], a[16:19], 0
    v_mfma_f32_16x16x32_bf16 v[232:235], v[140:143], a[20:23], v[232:235]
    v_mfma_f32_16x16x32_bf16 v[236:239], v[144:147], a[20:23], v[236:239]
    ds_read_b128 a[48:51], v214 offset:28960
    ds_read_b128 a[52:55], v214 offset:29984
    v_cvt_pk_bf16_f32 v188, v224, v225
    v_cvt_pk_bf16_f32 v189, v226, v227
    v_cvt_pk_bf16_f32 v190, v228, v229
    v_cvt_pk_bf16_f32 v191, v230, v231
    buffer_store_dwordx4 v[188:191], v202, s[24:27], s55 offen sc1
    s_waitcnt lgkmcnt(6)
    v_mfma_f32_16x16x32_bf16 v[240:243], v[152:155], a[24:27], 0
    v_mfma_f32_16x16x32_bf16 v[244:247], v[164:167], a[24:27], 0
    v_mfma_f32_16x16x32_bf16 v[240:243], v[156:159], a[28:31], v[240:243]
    v_mfma_f32_16x16x32_bf16 v[244:247], v[160:163], a[28:31], v[244:247]
    ds_read_b128 a[56:59], v214 offset:33088
    ds_read_b128 a[60:63], v214 offset:34112
    v_cvt_pk_bf16_f32 v192, v232, v233
    v_cvt_pk_bf16_f32 v193, v234, v235
    v_cvt_pk_bf16_f32 v194, v236, v237
    v_cvt_pk_bf16_f32 v195, v238, v239
    buffer_store_dwordx4 v[192:195], v202, s[24:27], s56 offen sc1
    s_waitcnt lgkmcnt(6)
    v_mfma_f32_16x16x32_bf16 v[216:219], v[168:171], a[32:35], 0
    v_mfma_f32_16x16x32_bf16 v[220:223], v[180:183], a[32:35], 0
    v_mfma_f32_16x16x32_bf16 v[216:219], v[172:175], a[36:39], v[216:219]
    v_mfma_f32_16x16x32_bf16 v[220:223], v[176:179], a[36:39], v[220:223]
    ds_read_b128 a[64:67], v214 offset:37216
    ds_read_b128 a[68:71], v214 offset:38240
    v_cvt_pk_bf16_f32 v196, v240, v241
    v_cvt_pk_bf16_f32 v197, v242, v243
    v_cvt_pk_bf16_f32 v198, v244, v245
    v_cvt_pk_bf16_f32 v199, v246, v247
    buffer_store_dwordx4 v[196:199], v202, s[24:27], s57 offen sc1
    s_waitcnt lgkmcnt(6)
    v_mfma_f32_16x16x32_bf16 v[224:227], v[104:107], a[40:43], 0
    v_mfma_f32_16x16x32_bf16 v[228:231], v[116:119], a[40:43], 0
    v_mfma_f32_16x16x32_bf16 v[224:227], v[108:111], a[44:47], v[224:227]
    v_mfma_f32_16x16x32_bf16 v[228:231], v[112:115], a[44:47], v[228:231]
    ds_read_b128 a[72:75], v214 offset:41344
    ds_read_b128 a[76:79], v214 offset:42368
    v_cvt_pk_bf16_f32 v184, v216, v217
    v_cvt_pk_bf16_f32 v185, v218, v219
    v_cvt_pk_bf16_f32 v186, v220, v221
    v_cvt_pk_bf16_f32 v187, v222, v223
    buffer_store_dwordx4 v[184:187], v202, s[24:27], s58 offen sc1
    s_waitcnt lgkmcnt(6)
    v_mfma_f32_16x16x32_bf16 v[232:235], v[120:123], a[48:51], 0
    v_mfma_f32_16x16x32_bf16 v[236:239], v[132:135], a[48:51], 0
    v_mfma_f32_16x16x32_bf16 v[232:235], v[124:127], a[52:55], v[232:235]
    v_mfma_f32_16x16x32_bf16 v[236:239], v[128:131], a[52:55], v[236:239]
    s_cmp_lg_u32 s70, 0
    s_cbranch_scc1 L_nm_28
    s_cmp_lg_u32 s32, 0
    s_cbranch_scc1 L_sm_29
    v_mov_b32 v95, 0
    s_mov_b64 exec, 0xff
    buffer_atomic_add v95, v93, s[24:27], s97 offen offset:0 sc0 sc1
    s_mov_b64 exec, -1
L_sm_29:
L_nm_28:
    v_cvt_pk_bf16_f32 v188, v224, v225
    v_cvt_pk_bf16_f32 v189, v226, v227
    v_cvt_pk_bf16_f32 v190, v228, v229
    v_cvt_pk_bf16_f32 v191, v230, v231
    buffer_store_dwordx4 v[188:191], v207, s[24:27], s54 offen sc1
    s_waitcnt lgkmcnt(4)
    v_mfma_f32_16x16x32_bf16 v[240:243], v[136:139], a[56:59], 0
    v_mfma_f32_16x16x32_bf16 v[244:247], v[148:151], a[56:59], 0
    v_mfma_f32_16x16x32_bf16 v[240:243], v[140:143], a[60:63], v[240:243]
    v_mfma_f32_16x16x32_bf16 v[244:247], v[144:147], a[60:63], v[244:247]
    v_cvt_pk_bf16_f32 v192, v232, v233
    v_cvt_pk_bf16_f32 v193, v234, v235
    v_cvt_pk_bf16_f32 v194, v236, v237
    v_cvt_pk_bf16_f32 v195, v238, v239
    buffer_store_dwordx4 v[192:195], v207, s[24:27], s55 offen sc1
    s_waitcnt lgkmcnt(2)
    v_mfma_f32_16x16x32_bf16 v[216:219], v[152:155], a[64:67], 0
    v_mfma_f32_16x16x32_bf16 v[220:223], v[164:167], a[64:67], 0
    v_mfma_f32_16x16x32_bf16 v[216:219], v[156:159], a[68:71], v[216:219]
    v_mfma_f32_16x16x32_bf16 v[220:223], v[160:163], a[68:71], v[220:223]
    v_cvt_pk_bf16_f32 v196, v240, v241
    v_cvt_pk_bf16_f32 v197, v242, v243
    v_cvt_pk_bf16_f32 v198, v244, v245
    v_cvt_pk_bf16_f32 v199, v246, v247
    buffer_store_dwordx4 v[196:199], v207, s[24:27], s56 offen sc1
    s_waitcnt lgkmcnt(0)
    v_mfma_f32_16x16x32_bf16 v[224:227], v[168:171], a[72:75], 0
    s_branch L_pgx3
L_pg3:
    s_setpc_b64 s[40:41]
L_pgx3:
    v_mfma_f32_16x16x32_bf16 v[228:231], v[180:183], a[72:75], 0
    v_mfma_f32_16x16x32_bf16 v[224:227], v[172:175], a[76:79], v[224:227]
    v_mfma_f32_16x16x32_bf16 v[228:231], v[176:179], a[76:79], v[228:231]
    v_cvt_pk_bf16_f32 v184, v216, v217
    v_cvt_pk_bf16_f32 v185, v218, v219
    v_cvt_pk_bf16_f32 v186, v220, v221
    v_cvt_pk_bf16_f32 v187, v222, v223
    buffer_store_dwordx4 v[184:187], v207, s[24:27], s57 offen sc1
    s_nop 1
    v_cvt_pk_bf16_f32 v188, v224, v225
    v_cvt_pk_bf16_f32 v189, v226, v227
    v_cvt_pk_bf16_f32 v190, v228, v229
    v_cvt_pk_bf16_f32 v191, v230, v231
    buffer_store_dwordx4 v[188:191], v207, s[24:27], s58 offen sc1
L_a_e5:
    s_cmp_lg_u32 s32, 0
    s_cbranch_scc1 L_a_end
    s_waitcnt vmcnt(5)
L_a_end:
    s_lshl_b32 s46, s36, 2
    s_add_u32 s46, s46, s32
    s_mul_i32 s46, s46, 61440
    s_add_u32 s46, s46, 23650304
    s_xor_b32 s47, s32, 0
    s_mul_i32 s47, s47, 3072
    s_add_u32 s80, s46, s47
    s_xor_b32 s47, s32, 1
    s_mul_i32 s47, s47, 3072
    s_add_u32 s81, s46, s47
    s_xor_b32 s47, s32, 2
    s_mul_i32 s47, s47, 3072
    s_add_u32 s82, s46, s47
    s_xor_b32 s47, s32, 3
    s_mul_i32 s47, s47, 3072
    s_add_u32 s83, s46, s47
    s_sub_u32 s46, s34, 0
    s_cselect_b32 s47, 0, 8
    s_sub_u32 s47, s34, s47
    s_mul_i32 s48, s33, 24
    s_add_u32 s47, s47, s48
    s_lshl3_add_u32 s48, s33, s46
    s_lshl1_add_u32 s48, s48, 192
    s_cmp_lt_u32 s46, 8
    s_cselect_b32 s67, 1, 0
    s_cselect_b32 s38, s48, s47
    s_lshl_b32 s46, s32, 11
    s_add_u32 s60, s46, 65536
    s_lshr_b32 s47, s38, 1
    s_mul_i32 s47, s47, 16512
    s_lshl_b32 s48, s38, 6
    s_add_u32 s47, s47, s48
    s_add_u32 s47, s47, s46
    s_add_u32 s46, s46, s47
    s_add_u32 s61, s46, 81920
    s_add_u32 s62, s47, 31514624
    s_add_u32 s63, s46, 81984
    s_add_u32 s64, s47, 31514688
    v_and_b32 v241, 3, v2
    v_and_or_b32 v248, v2, 12, v3
    v_lshlrev_b32 v252, 4, v241
    v_lshl_add_u32 v252, v248, 8, v252
    v_and_b32 v250, -64, v4
    v_add_u32 v250, v250, v4
    v_add_u32 v251, 8192, v250
    s_and_b32 s46, s38, -16
    s_add_u32 s46, s46, s38
    s_lshl_b32 s58, s46, 6
    s_lshr_b32 s46, s46, 1
    s_and_b32 s46, s46, 2
    s_mul_i32 s47, s32, 657920
    s_add_u32 s58, s58, s47
    s_add_u32 s58, s58, 5693440
    v_xor_b32 v240, s46, v241
    v_mul_u32_u24 v248, 40960, v248
    v_and_b32 v241, 12, v2
    v_mul_u32_u24 v241, 160, v241
    v_add_u32 v248, v248, v241
    v_lshl_add_u32 v248, v240, 4, v248
    s_mov_b32 s55, 0x45cccccd
L_m1:
    s_cmp_lg_u32 s32, 1
    s_cbranch_scc1 L_tn_32
    s_call_b64 s[40:41], L_onet0
    s_call_b64 s[40:41], L_pg6
    s_nop 0
    s_branch L_te_31
L_tn_32:
    s_cmp_lg_u32 s32, 2
    s_cbranch_scc1 L_tn_33
    s_call_b64 s[40:41], L_pg4
    s_call_b64 s[40:41], L_pg7
    s_nop 0
    s_branch L_te_31
L_tn_33:
    s_cmp_lg_u32 s32, 3
    s_cbranch_scc1 L_te_31
    s_call_b64 s[40:41], L_pg5
    s_call_b64 s[40:41], L_pg8
    s_nop 0
L_te_31:
    s_cmp_lg_u32 s32, 0
    s_cbranch_scc1 L_pe_38
    s_mov_b32 s42, 65536
    s_mov_b64 exec, 0xff
    s_branch L_pc_36
L_pl_35:
    v_mov_b32 v95, 0
    buffer_atomic_add v95, v93, s[24:27], s97 offen offset:0 sc0 sc1
    s_waitcnt vmcnt(0)
L_pc_36:
    v_and_b32 v94, 32, v95
    v_cmp_ne_u32 vcc, 32, v94
    s_cbranch_vccz L_pd_37
    s_sub_u32 s42, s42, 1
    s_cbranch_scc0 L_pl_35
L_pd_37:
    s_mov_b64 exec, -1
L_pe_38:
    s_barrier
    buffer_load_dwordx4 v[208:211], v4, s[24:27], s60 offen offset:0 sc1
    buffer_load_dwordx4 v[212:215], v4, s[24:27], s60 offen offset:1024 sc1
    buffer_load_dwordx4 v[96:99], v252, s[24:27], s61 offen offset:0 sc1
    buffer_load_dwordx4 v[100:103], v252, s[24:27], s61 offen offset:128 sc1
    s_cmp_eq_u32 s67, 0
    s_cbranch_scc1 L_one0
    buffer_load_dwordx4 v[104:107], v252, s[24:27], s63 offen offset:0 sc1
    buffer_load_dwordx4 v[108:111], v252, s[24:27], s63 offen offset:128 sc1
    buffer_load_dwordx4 v[112:115], v250, s[24:27], s62 offen sc1
    buffer_load_dwordx4 v[116:119], v251, s[24:27], s62 offen sc1
    buffer_load_dwordx4 v[120:123], v250, s[24:27], s64 offen sc1
    buffer_load_dwordx4 v[124:127], v251, s[24:27], s64 offen sc1
    v_mov_b32 v240, 0x4227c5ac
    s_waitcnt vmcnt(8)
    v_fma_f32 v208, v208, s55, v240
    v_fma_f32 v209, v209, s55, v240
    v_fma_f32 v210, v210, s55, v240
    v_fma_f32 v211, v211, s55, v240
    v_fma_f32 v212, v212, s55, v240
    v_fma_f32 v213, v213, s55, v240
    v_fma_f32 v214, v214, s55, v240
    v_fma_f32 v215, v215, s55, v240
    v_rsq_f32 v208, v208
    v_rsq_f32 v209, v209
    v_rsq_f32 v210, v210
    v_rsq_f32 v211, v211
    v_rsq_f32 v212, v212
    v_rsq_f32 v213, v213
    v_rsq_f32 v214, v214
    v_rsq_f32 v215, v215
    s_waitcnt vmcnt(6)
    v_lshlrev_b32 v128, 16, v96
    v_lshlrev_b32 v129, 16, v97
    v_lshlrev_b32 v130, 16, v98
    v_lshlrev_b32 v131, 16, v99
    v_lshlrev_b32 v132, 16, v100
    v_lshlrev_b32 v133, 16, v101
    v_lshlrev_b32 v134, 16, v102
    v_lshlrev_b32 v135, 16, v103
    v_pk_mul_f32 v[128:129], v[128:129], v[208:209]
    v_pk_mul_f32 v[130:131], v[130:131], v[210:211]
    v_pk_mul_f32 v[132:133], v[132:133], v[212:213]
    v_pk_mul_f32 v[134:135], v[134:135], v[214:215]
    v_cvt_pk_bf16_f32 v224, v128, v129
    v_cvt_pk_bf16_f32 v225, v130, v131
    v_cvt_pk_bf16_f32 v226, v132, v133
    v_cvt_pk_bf16_f32 v227, v134, v135
    ds_write_b128 v90, v[224:227] offset:0
    v_and_b32 v136, 0xffff0000, v96
    v_and_b32 v137, 0xffff0000, v97
    v_and_b32 v138, 0xffff0000, v98
    v_and_b32 v139, 0xffff0000, v99
    v_and_b32 v140, 0xffff0000, v100
    v_and_b32 v141, 0xffff0000, v101
    v_and_b32 v142, 0xffff0000, v102
    v_and_b32 v143, 0xffff0000, v103
    v_pk_mul_f32 v[136:137], v[136:137], v[208:209]
    v_pk_mul_f32 v[138:139], v[138:139], v[210:211]
    v_pk_mul_f32 v[140:141], v[140:141], v[212:213]
    v_pk_mul_f32 v[142:143], v[142:143], v[214:215]
    v_cvt_pk_bf16_f32 v228, v136, v137
    v_cvt_pk_bf16_f32 v229, v138, v139
    v_cvt_pk_bf16_f32 v230, v140, v141
    v_cvt_pk_bf16_f32 v231, v142, v143
    ds_write_b128 v90, v[228:231] offset:4096
    s_waitcnt vmcnt(4)
    v_lshlrev_b32 v160, 16, v104
    v_lshlrev_b32 v161, 16, v105
    v_lshlrev_b32 v162, 16, v106
    v_lshlrev_b32 v163, 16, v107
    v_lshlrev_b32 v164, 16, v108
    v_lshlrev_b32 v165, 16, v109
    v_lshlrev_b32 v166, 16, v110
    v_lshlrev_b32 v167, 16, v111
    v_pk_mul_f32 v[160:161], v[160:161], v[208:209]
    v_pk_mul_f32 v[162:163], v[162:163], v[210:211]
    v_pk_mul_f32 v[164:165], v[164:165], v[212:213]
    v_pk_mul_f32 v[166:167], v[166:167], v[214:215]
    v_cvt_pk_bf16_f32 v232, v160, v161
    v_cvt_pk_bf16_f32 v233, v162, v163
    v_cvt_pk_bf16_f32 v234, v164, v165
    v_cvt_pk_bf16_f32 v235, v166, v167
    s_waitcnt lgkmcnt(0)
    s_barrier
    ds_read_b64_tr_b16 v[128:129], v88 offset:0
    ds_read_b64_tr_b16 v[130:131], v88 offset:1024
    ds_read_b64_tr_b16 v[144:145], v88 offset:4096
    ds_read_b64_tr_b16 v[146:147], v88 offset:5120
    ds_read_b64_tr_b16 v[136:137], v88 offset:2048
    ds_read_b64_tr_b16 v[138:139], v88 offset:3072
    ds_read_b64_tr_b16 v[152:153], v88 offset:6144
    ds_read_b64_tr_b16 v[154:155], v88 offset:7168
    ds_read_b64_tr_b16 v[132:133], v89 offset:0
    ds_read_b64_tr_b16 v[134:135], v89 offset:1024
    ds_read_b64_tr_b16 v[148:149], v89 offset:4096
    ds_read_b64_tr_b16 v[150:151], v89 offset:5120
    v_and_b32 v168, 0xffff0000, v104
    v_and_b32 v169, 0xffff0000, v105
    v_and_b32 v170, 0xffff0000, v106
    v_and_b32 v171, 0xffff0000, v107
    ds_read_b64_tr_b16 v[140:141], v89 offset:2048
    v_and_b32 v172, 0xffff0000, v108
    v_and_b32 v173, 0xffff0000, v109
    v_and_b32 v174, 0xffff0000, v110
    ds_read_b64_tr_b16 v[142:143], v89 offset:3072
    v_and_b32 v175, 0xffff0000, v111
    v_pk_mul_f32 v[168:169], v[168:169], v[208:209]
    v_pk_mul_f32 v[170:171], v[170:171], v[210:211]
    ds_read_b64_tr_b16 v[156:157], v89 offset:6144
    v_pk_mul_f32 v[172:173], v[172:173], v[212:213]
    v_pk_mul_f32 v[174:175], v[174:175], v[214:215]
    v_cvt_pk_bf16_f32 v236, v168, v169
    s_waitcnt lgkmcnt(11)
    ds_read_b64_tr_b16 v[158:159], v89 offset:7168
    v_cvt_pk_bf16_f32 v237, v170, v171
    v_cvt_pk_bf16_f32 v238, v172, v173
    v_cvt_pk_bf16_f32 v239, v174, v175
    ds_write_b128 v90, v[232:235] offset:8192
    ds_write_b128 v90, v[236:239] offset:12288
    v_mfma_f32_16x16x32_bf16 v[192:195], v[128:131], v[8:11], 0
    v_mfma_f32_16x16x32_bf16 v[192:195], v[144:147], v[16:19], v[192:195]
    v_mfma_f32_16x16x32_bf16 v[200:203], v[144:147], v[8:11], 0
    v_mfma_f32_16x16x32_bf16 v[200:203], v[128:131], v[24:27], v[200:203]
    s_waitcnt lgkmcnt(10)
    v_mfma_f32_16x16x32_bf16 v[192:195], v[136:139], v[12:15], v[192:195]
    v_mfma_f32_16x16x32_bf16 v[192:195], v[152:155], v[20:23], v[192:195]
    s_waitcnt lgkmcnt(0)
    s_barrier
    v_mfma_f32_16x16x32_bf16 v[200:203], v[152:155], v[12:15], v[200:203]
    ds_read_b64_tr_b16 v[160:161], v88 offset:8192
    ds_read_b64_tr_b16 v[162:163], v88 offset:9216
    v_mfma_f32_16x16x32_bf16 v[200:203], v[136:139], v[28:31], v[200:203]
    ds_read_b64_tr_b16 v[176:177], v88 offset:12288
    ds_read_b64_tr_b16 v[178:179], v88 offset:13312
    v_mfma_f32_16x16x32_bf16 v[196:199], v[132:135], v[8:11], 0
    ds_read_b64_tr_b16 v[168:169], v88 offset:10240
    ds_read_b64_tr_b16 v[170:171], v88 offset:11264
    v_mfma_f32_16x16x32_bf16 v[196:199], v[148:151], v[16:19], v[196:199]
    ds_read_b64_tr_b16 v[184:185], v88 offset:14336
    ds_read_b64_tr_b16 v[186:187], v88 offset:15360
    v_mfma_f32_16x16x32_bf16 v[204:207], v[148:151], v[8:11], 0
    ds_read_b64_tr_b16 v[164:165], v89 offset:8192
    ds_read_b64_tr_b16 v[166:167], v89 offset:9216
    v_mfma_f32_16x16x32_bf16 v[204:207], v[132:135], v[24:27], v[204:207]
    ds_read_b64_tr_b16 v[180:181], v89 offset:12288
    ds_read_b64_tr_b16 v[182:183], v89 offset:13312
    v_mfma_f32_16x16x32_bf16 v[196:199], v[140:143], v[12:15], v[196:199]
    ds_read_b64_tr_b16 v[172:173], v89 offset:10240
    v_mfma_f32_16x16x32_bf16 v[196:199], v[156:159], v[20:23], v[196:199]
    ds_read_b64_tr_b16 v[174:175], v89 offset:11264
    v_mfma_f32_16x16x32_bf16 v[204:207], v[156:159], v[12:15], v[204:207]
    ds_read_b64_tr_b16 v[188:189], v89 offset:14336
    v_mfma_f32_16x16x32_bf16 v[204:207], v[140:143], v[28:31], v[204:207]
    s_waitcnt lgkmcnt(11)
    ds_read_b64_tr_b16 v[190:191], v89 offset:15360
    v_pk_mul_f32 v[240:241], v[192:193], v[56:57]
    v_pk_mul_f32 v[242:243], v[194:195], v[58:59]
    v_pk_mul_f32 v[244:245], v[196:197], v[60:61]
    v_pk_mul_f32 v[246:247], v[198:199], v[62:63]
    v_pk_fma_f32 v[240:241], v[200:201], v[64:65], v[240:241]
    v_pk_fma_f32 v[242:243], v[202:203], v[66:67], v[242:243]
    v_pk_fma_f32 v[244:245], v[204:205], v[68:69], v[244:245]
    v_pk_fma_f32 v[246:247], v[206:207], v[70:71], v[246:247]
    v_pk_mul_f32 v[200:201], v[200:201], v[56:57]
    v_pk_mul_f32 v[202:203], v[202:203], v[58:59]
    v_pk_mul_f32 v[204:205], v[204:205], v[60:61]
    v_pk_mul_f32 v[206:207], v[206:207], v[62:63]
    v_pk_fma_f32 v[200:201], v[192:193], v[64:65], v[200:201] neg_lo:[1,0,0] neg_hi:[1,0,0]
    v_pk_fma_f32 v[202:203], v[194:195], v[66:67], v[202:203] neg_lo:[1,0,0] neg_hi:[1,0,0]
    v_pk_fma_f32 v[204:205], v[196:197], v[68:69], v[204:205] neg_lo:[1,0,0] neg_hi:[1,0,0]
    v_pk_fma_f32 v[206:207], v[198:199], v[70:71], v[206:207] neg_lo:[1,0,0] neg_hi:[1,0,0]
    v_mfma_f32_16x16x32_bf16 v[208:211], v[160:163], v[8:11], 0
    v_cvt_pk_bf16_f32 v224, v240, v241
    v_cvt_pk_bf16_f32 v228, v200, v201
    v_mfma_f32_16x16x32_bf16 v[208:211], v[176:179], v[16:19], v[208:211]
    v_cvt_pk_bf16_f32 v225, v242, v243
    v_cvt_pk_bf16_f32 v229, v202, v203
    v_mfma_f32_16x16x32_bf16 v[216:219], v[176:179], v[8:11], 0
    v_cvt_pk_bf16_f32 v226, v244, v245
    v_cvt_pk_bf16_f32 v230, v204, v205
    v_mfma_f32_16x16x32_bf16 v[216:219], v[160:163], v[24:27], v[216:219]
    v_cvt_pk_bf16_f32 v227, v246, v247
    v_cvt_pk_bf16_f32 v231, v206, v207
    s_waitcnt lgkmcnt(8)
    v_mfma_f32_16x16x32_bf16 v[208:211], v[168:171], v[12:15], v[208:211]
    s_waitcnt vmcnt(2)
    v_lshlrev_b32 v128, 16, v112
    v_mfma_f32_16x16x32_bf16 v[208:211], v[184:187], v[20:23], v[208:211]
    v_and_b32 v129, 0xffff0000, v112
    v_lshlrev_b32 v130, 16, v113
    v_mfma_f32_16x16x32_bf16 v[216:219], v[184:187], v[12:15], v[216:219]
    v_and_b32 v131, 0xffff0000, v113
    v_lshlrev_b32 v132, 16, v114
    v_mfma_f32_16x16x32_bf16 v[216:219], v[168:171], v[28:31], v[216:219]
    v_and_b32 v133, 0xffff0000, v114
    v_lshlrev_b32 v134, 16, v115
    s_waitcnt lgkmcnt(4)
    v_mfma_f32_16x16x32_bf16 v[212:215], v[164:167], v[8:11], 0
    v_and_b32 v135, 0xffff0000, v115
    v_lshlrev_b32 v136, 16, v116
    v_mfma_f32_16x16x32_bf16 v[212:215], v[180:183], v[16:19], v[212:215]
    v_and_b32 v137, 0xffff0000, v116
    v_lshlrev_b32 v138, 16, v117
    v_mfma_f32_16x16x32_bf16 v[220:223], v[180:183], v[8:11], 0
    v_and_b32 v139, 0xffff0000, v117
    v_lshlrev_b32 v140, 16, v118
    v_mfma_f32_16x16x32_bf16 v[220:223], v[164:167], v[24:27], v[220:223]
    v_and_b32 v141, 0xffff0000, v118
    v_lshlrev_b32 v142, 16, v119
    s_waitcnt lgkmcnt(0)
    v_mfma_f32_16x16x32_bf16 v[212:215], v[172:175], v[12:15], v[212:215]
    v_and_b32 v143, 0xffff0000, v119
    s_waitcnt vmcnt(0)
    v_mfma_f32_16x16x32_bf16 v[212:215], v[188:191], v[20:23], v[212:215]
    v_lshlrev_b32 v144, 16, v120
    v_and_b32 v145, 0xffff0000, v120
    v_mfma_f32_16x16x32_bf16 v[220:223], v[188:191], v[12:15], v[220:223]
    v_lshlrev_b32 v146, 16, v121
    v_and_b32 v147, 0xffff0000, v121
    v_mfma_f32_16x16x32_bf16 v[220:223], v[172:175], v[28:31], v[220:223]
    v_lshlrev_b32 v148, 16, v122
    v_and_b32 v149, 0xffff0000, v122
    v_lshlrev_b32 v150, 16, v123
    v_and_b32 v151, 0xffff0000, v123
    v_pk_mul_f32 v[240:241], v[208:209], v[56:57]
    v_pk_mul_f32 v[242:243], v[210:211], v[58:59]
    v_pk_mul_f32 v[244:245], v[212:213], v[60:61]
    v_pk_mul_f32 v[246:247], v[214:215], v[62:63]
    v_pk_fma_f32 v[240:241], v[216:217], v[64:65], v[240:241]
    v_pk_fma_f32 v[242:243], v[218:219], v[66:67], v[242:243]
    v_pk_fma_f32 v[244:245], v[220:221], v[68:69], v[244:245]
    v_pk_fma_f32 v[246:247], v[222:223], v[70:71], v[246:247]
    v_pk_mul_f32 v[216:217], v[216:217], v[56:57]
    v_pk_mul_f32 v[218:219], v[218:219], v[58:59]
    v_pk_mul_f32 v[220:221], v[220:221], v[60:61]
    v_pk_mul_f32 v[222:223], v[222:223], v[62:63]
    v_pk_fma_f32 v[216:217], v[208:209], v[64:65], v[216:217] neg_lo:[1,0,0] neg_hi:[1,0,0]
    v_pk_fma_f32 v[218:219], v[210:211], v[66:67], v[218:219] neg_lo:[1,0,0] neg_hi:[1,0,0]
    v_pk_fma_f32 v[220:221], v[212:213], v[68:69], v[220:221] neg_lo:[1,0,0] neg_hi:[1,0,0]
    v_pk_fma_f32 v[222:223], v[214:215], v[70:71], v[222:223] neg_lo:[1,0,0] neg_hi:[1,0,0]
    v_mfma_f32_16x16x32_bf16 v[192:195], v[32:35], v[224:227], 0
    v_cvt_pk_bf16_f32 v232, v240, v241
    v_cvt_pk_bf16_f32 v236, v216, v217
    v_mfma_f32_16x16x32_bf16 v[192:195], v[40:43], v[228:231], v[192:195]
    v_cvt_pk_bf16_f32 v233, v242, v243
    v_cvt_pk_bf16_f32 v237, v218, v219
    v_mfma_f32_16x16x32_bf16 v[200:203], v[32:35], v[228:231], 0
    v_cvt_pk_bf16_f32 v234, v244, v245
    v_cvt_pk_bf16_f32 v238, v220, v221
    v_mfma_f32_16x16x32_bf16 v[200:203], v[48:51], v[224:227], v[200:203]
    v_cvt_pk_bf16_f32 v235, v246, v247
    v_cvt_pk_bf16_f32 v239, v222, v223
    v_mfma_f32_16x16x32_bf16 v[196:199], v[36:39], v[224:227], 0
    v_lshlrev_b32 v152, 16, v124
    v_and_b32 v153, 0xffff0000, v124
    v_mfma_f32_16x16x32_bf16 v[196:199], v[44:47], v[228:231], v[196:199]
    v_lshlrev_b32 v154, 16, v125
    v_and_b32 v155, 0xffff0000, v125
    v_mfma_f32_16x16x32_bf16 v[204:207], v[36:39], v[228:231], 0
    v_lshlrev_b32 v156, 16, v126
    v_and_b32 v157, 0xffff0000, v126
    v_mfma_f32_16x16x32_bf16 v[204:207], v[52:55], v[224:227], v[204:207]
    v_lshlrev_b32 v158, 16, v127
    v_and_b32 v159, 0xffff0000, v127
    v_pk_mul_f32 v[240:241], v[192:193], v[128:129]
    v_pk_mul_f32 v[242:243], v[194:195], v[130:131]
    v_pk_mul_f32 v[244:245], v[196:197], v[132:133]
    v_pk_mul_f32 v[246:247], v[198:199], v[134:135]
    v_pk_fma_f32 v[240:241], v[200:201], v[136:137], v[240:241] neg_lo:[1,0,0] neg_hi:[1,0,0]
    v_pk_fma_f32 v[242:243], v[202:203], v[138:139], v[242:243] neg_lo:[1,0,0] neg_hi:[1,0,0]
    v_pk_fma_f32 v[244:245], v[204:205], v[140:141], v[244:245] neg_lo:[1,0,0] neg_hi:[1,0,0]
    v_pk_fma_f32 v[246:247], v[206:207], v[142:143], v[246:247] neg_lo:[1,0,0] neg_hi:[1,0,0]
    v_pk_mul_f32 v[200:201], v[200:201], v[128:129]
    v_pk_mul_f32 v[202:203], v[202:203], v[130:131]
    v_pk_mul_f32 v[204:205], v[204:205], v[132:133]
    v_pk_mul_f32 v[206:207], v[206:207], v[134:135]
    v_pk_fma_f32 v[200:201], v[192:193], v[136:137], v[200:201]
    v_pk_fma_f32 v[202:203], v[194:195], v[138:139], v[202:203]
    v_pk_fma_f32 v[204:205], v[196:197], v[140:141], v[204:205]
    v_pk_fma_f32 v[206:207], v[198:199], v[142:143], v[206:207]
    v_mfma_f32_16x16x32_bf16 v[208:211], v[32:35], v[232:235], 0
    v_cvt_pk_bf16_f32 v224, v240, v241
    v_cvt_pk_bf16_f32 v228, v200, v201
    v_mfma_f32_16x16x32_bf16 v[208:211], v[40:43], v[236:239], v[208:211]
    v_cvt_pk_bf16_f32 v225, v242, v243
    v_cvt_pk_bf16_f32 v229, v202, v203
    v_mfma_f32_16x16x32_bf16 v[216:219], v[32:35], v[236:239], 0
    v_cvt_pk_bf16_f32 v226, v244, v245
    v_cvt_pk_bf16_f32 v230, v204, v205
    v_mfma_f32_16x16x32_bf16 v[216:219], v[48:51], v[232:235], v[216:219]
    v_cvt_pk_bf16_f32 v227, v246, v247
    v_mfma_f32_16x16x32_bf16 v[212:215], v[36:39], v[232:235], 0
    v_cvt_pk_bf16_f32 v231, v206, v207
    v_mfma_f32_16x16x32_bf16 v[212:215], v[44:47], v[236:239], v[212:215]
    v_mul_f32 v240, v208, v144
    v_mul_f32 v241, v209, v145
    s_nop 1
    v_fma_f32 v240, -v216, v152, v240
    v_mfma_f32_16x16x32_bf16 v[220:223], v[36:39], v[236:239], 0
    v_fma_f32 v241, -v217, v153, v241
    v_mul_f32 v216, v216, v144
    v_mul_f32 v217, v217, v145
    v_mfma_f32_16x16x32_bf16 v[220:223], v[52:55], v[232:235], v[220:223]
    v_fmac_f32 v216, v208, v152
    v_fmac_f32 v217, v209, v153
    v_pk_mul_f32 v[242:243], v[210:211], v[146:147]
    v_pk_mul_f32 v[244:245], v[212:213], v[148:149]
    v_pk_mul_f32 v[246:247], v[214:215], v[150:151]
    v_pk_fma_f32 v[242:243], v[218:219], v[154:155], v[242:243] neg_lo:[1,0,0] neg_hi:[1,0,0]
    s_nop 1
    v_pk_fma_f32 v[244:245], v[220:221], v[156:157], v[244:245] neg_lo:[1,0,0] neg_hi:[1,0,0]
    v_pk_fma_f32 v[246:247], v[222:223], v[158:159], v[246:247] neg_lo:[1,0,0] neg_hi:[1,0,0]
    v_pk_mul_f32 v[218:219], v[218:219], v[146:147]
    v_pk_mul_f32 v[220:221], v[220:221], v[148:149]
    v_pk_mul_f32 v[222:223], v[222:223], v[150:151]
    v_pk_fma_f32 v[218:219], v[210:211], v[154:155], v[218:219]
    v_pk_fma_f32 v[220:221], v[212:213], v[156:157], v[220:221]
    v_pk_fma_f32 v[222:223], v[214:215], v[158:159], v[222:223]
    v_mfma_f32_16x16x32_bf16 v[192:195], v[224:227], v[32:35], 0
    v_cvt_pk_bf16_f32 v232, v240, v241
    v_cvt_pk_bf16_f32 v236, v216, v217
    v_mfma_f32_16x16x32_bf16 v[192:195], v[228:231], v[48:51], v[192:195]
    v_cvt_pk_bf16_f32 v233, v242, v243
    v_cvt_pk_bf16_f32 v237, v218, v219
    v_mfma_f32_16x16x32_bf16 v[200:203], v[228:231], v[32:35], 0
    v_cvt_pk_bf16_f32 v234, v244, v245
    v_cvt_pk_bf16_f32 v238, v220, v221
    v_mfma_f32_16x16x32_bf16 v[200:203], v[224:227], v[40:43], v[200:203]
    v_cvt_pk_bf16_f32 v235, v246, v247
    v_mfma_f32_16x16x32_bf16 v[196:199], v[224:227], v[36:39], 0
    v_cvt_pk_bf16_f32 v239, v222, v223
    v_mfma_f32_16x16x32_bf16 v[196:199], v[228:231], v[52:55], v[196:199]
    v_mul_f32 v240, v192, v72
    v_mul_f32 v241, v193, v73
    s_nop 1
    v_fma_f32 v240, -v200, v80, v240
    v_mfma_f32_16x16x32_bf16 v[204:207], v[228:231], v[36:39], 0
    v_fma_f32 v241, -v201, v81, v241
    v_mul_f32 v200, v200, v72
    v_mul_f32 v201, v201, v73
    v_mfma_f32_16x16x32_bf16 v[204:207], v[224:227], v[44:47], v[204:207]
    v_fmac_f32 v200, v192, v80
    v_fmac_f32 v201, v193, v81
    v_pk_mul_f32 v[242:243], v[194:195], v[74:75]
    v_pk_mul_f32 v[244:245], v[196:197], v[76:77]
    v_pk_mul_f32 v[246:247], v[198:199], v[78:79]
    v_pk_fma_f32 v[242:243], v[202:203], v[82:83], v[242:243] neg_lo:[1,0,0] neg_hi:[1,0,0]
    s_nop 1
    v_pk_fma_f32 v[244:245], v[204:205], v[84:85], v[244:245] neg_lo:[1,0,0] neg_hi:[1,0,0]
    v_pk_fma_f32 v[246:247], v[206:207], v[86:87], v[246:247] neg_lo:[1,0,0] neg_hi:[1,0,0]
    v_pk_mul_f32 v[202:203], v[202:203], v[74:75]
    v_pk_mul_f32 v[204:205], v[204:205], v[76:77]
    v_pk_mul_f32 v[206:207], v[206:207], v[78:79]
    v_pk_fma_f32 v[202:203], v[194:195], v[82:83], v[202:203]
    v_pk_fma_f32 v[204:205], v[196:197], v[84:85], v[204:205]
    v_pk_fma_f32 v[206:207], v[198:199], v[86:87], v[206:207]
    v_mfma_f32_16x16x32_bf16 v[208:211], v[232:235], v[32:35], 0
    v_cvt_pk_bf16_f32 v224, v240, v241
    v_cvt_pk_bf16_f32 v228, v200, v201
    v_mfma_f32_16x16x32_bf16 v[208:211], v[236:239], v[48:51], v[208:211]
    v_cvt_pk_bf16_f32 v225, v242, v243
    v_cvt_pk_bf16_f32 v229, v202, v203
    v_mfma_f32_16x16x32_bf16 v[216:219], v[236:239], v[32:35], 0
    ds_write_b64 v91, v[224:225] offset:16384
    ds_write_b64 v91, v[228:229] offset:20992
    v_mfma_f32_16x16x32_bf16 v[216:219], v[232:235], v[40:43], v[216:219]
    v_cvt_pk_bf16_f32 v226, v244, v245
    v_cvt_pk_bf16_f32 v230, v204, v205
    v_mfma_f32_16x16x32_bf16 v[212:215], v[232:235], v[36:39], 0
    v_cvt_pk_bf16_f32 v227, v246, v247
    v_cvt_pk_bf16_f32 v231, v206, v207
    v_mfma_f32_16x16x32_bf16 v[212:215], v[236:239], v[52:55], v[212:215]
    ds_write_b64 v91, v[226:227] offset:18688
    ds_write_b64 v91, v[230:231] offset:23296
    v_mfma_f32_16x16x32_bf16 v[220:223], v[236:239], v[36:39], 0
    v_lshlrev_b32 v192, 16, v96
    v_lshlrev_b32 v193, 16, v97
    v_mfma_f32_16x16x32_bf16 v[220:223], v[232:235], v[44:47], v[220:223]
    v_lshlrev_b32 v194, 16, v98
    v_lshlrev_b32 v195, 16, v99
    s_waitcnt lgkmcnt(0)
    s_cmp_lg_u32 s32, 0
    s_cbranch_scc1 L_sm_47
    v_mov_b32 v95, 0
    s_mov_b64 exec, 0xff
    buffer_atomic_add v95, v93, s[24:27], s97 offen offset:0 sc0 sc1
    s_mov_b64 exec, -1
L_sm_47:
    s_barrier
    ds_read_b128 v[128:131], v92 offset:16384
    ds_read_b128 v[144:147], v92 offset:20992
    ds_read_b128 v[136:139], v92 offset:16448
    ds_read_b128 v[152:155], v92 offset:21056
    ds_read_b128 v[132:135], v92 offset:16960
    ds_read_b128 v[148:151], v92 offset:21568
    ds_read_b128 v[140:143], v92 offset:17024
    ds_read_b128 v[156:159], v92 offset:21632
    v_pk_mul_f32 v[240:241], v[208:209], v[72:73]
    v_pk_mul_f32 v[242:243], v[210:211], v[74:75]
    v_pk_mul_f32 v[244:245], v[212:213], v[76:77]
    v_pk_mul_f32 v[246:247], v[214:215], v[78:79]
    v_pk_fma_f32 v[240:241], v[216:217], v[80:81], v[240:241] neg_lo:[1,0,0] neg_hi:[1,0,0]
    v_pk_fma_f32 v[242:243], v[218:219], v[82:83], v[242:243] neg_lo:[1,0,0] neg_hi:[1,0,0]
    v_pk_fma_f32 v[244:245], v[220:221], v[84:85], v[244:245] neg_lo:[1,0,0] neg_hi:[1,0,0]
    v_pk_fma_f32 v[246:247], v[222:223], v[86:87], v[246:247] neg_lo:[1,0,0] neg_hi:[1,0,0]
    v_pk_mul_f32 v[216:217], v[216:217], v[72:73]
    v_pk_mul_f32 v[218:219], v[218:219], v[74:75]
    v_pk_mul_f32 v[220:221], v[220:221], v[76:77]
    v_pk_mul_f32 v[222:223], v[222:223], v[78:79]
    v_pk_fma_f32 v[216:217], v[208:209], v[80:81], v[216:217]
    v_pk_fma_f32 v[218:219], v[210:211], v[82:83], v[218:219]
    v_pk_fma_f32 v[220:221], v[212:213], v[84:85], v[220:221]
    v_pk_fma_f32 v[222:223], v[214:215], v[86:87], v[222:223]
    s_waitcnt lgkmcnt(6)
    v_mfma_f32_16x16x32_bf16 v[192:195], v[128:131], v[8:11], v[192:195]
    v_lshlrev_b32 v196, 16, v100
    v_lshlrev_b32 v197, 16, v101
    v_lshlrev_b32 v198, 16, v102
    v_mfma_f32_16x16x32_bf16 v[192:195], v[144:147], v[24:27], v[192:195]
    v_lshlrev_b32 v199, 16, v103
    v_cvt_pk_bf16_f32 v232, v240, v241
    v_cvt_pk_bf16_f32 v236, v216, v217
    s_waitcnt lgkmcnt(4)
    v_mfma_f32_16x16x32_bf16 v[192:195], v[136:139], v[12:15], v[192:195]
    v_cvt_pk_bf16_f32 v233, v242, v243
    v_cvt_pk_bf16_f32 v237, v218, v219
    v_mfma_f32_16x16x32_bf16 v[192:195], v[152:155], v[28:31], v[192:195]
    ds_write_b64 v91, v[232:233] offset:25600
    ds_write_b64 v91, v[236:237] offset:30208
    s_waitcnt lgkmcnt(4)
    v_mfma_f32_16x16x32_bf16 v[196:199], v[132:135], v[8:11], v[196:199]
    v_cvt_pk_bf16_f32 v234, v244, v245
    v_cvt_pk_bf16_f32 v238, v220, v221
    v_cvt_pk_bf16_f32 v235, v246, v247
    v_mfma_f32_16x16x32_bf16 v[196:199], v[148:151], v[24:27], v[196:199]
    v_cvt_pk_bf16_f32 v239, v222, v223
    ds_write_b64 v91, v[234:235] offset:27904
    ds_write_b64 v91, v[238:239] offset:32512
    s_waitcnt lgkmcnt(4)
    v_mfma_f32_16x16x32_bf16 v[196:199], v[140:143], v[12:15], v[196:199]
    v_and_b32 v200, 0xffff0000, v96
    v_and_b32 v201, 0xffff0000, v97
    v_mfma_f32_16x16x32_bf16 v[196:199], v[156:159], v[28:31], v[196:199]
    v_and_b32 v202, 0xffff0000, v98
    v_and_b32 v203, 0xffff0000, v99
    s_nop 1
    v_mfma_f32_16x16x32_bf16 v[200:203], v[144:147], v[8:11], v[200:203]
    v_and_b32 v204, 0xffff0000, v100
    v_and_b32 v205, 0xffff0000, v101
    v_mfma_f32_16x16x32_bf16 v[200:203], v[128:131], v[16:19], v[200:203]
    v_and_b32 v206, 0xffff0000, v102
    v_and_b32 v207, 0xffff0000, v103
    s_waitcnt lgkmcnt(0)
    s_barrier
    v_mfma_f32_16x16x32_bf16 v[200:203], v[152:155], v[12:15], v[200:203]
    ds_read_b128 v[160:163], v92 offset:25600
    ds_read_b128 v[176:179], v92 offset:30208
    v_mfma_f32_16x16x32_bf16 v[200:203], v[136:139], v[20:23], v[200:203]
    ds_read_b128 v[168:171], v92 offset:25664
    ds_read_b128 v[184:187], v92 offset:30272
    v_mfma_f32_16x16x32_bf16 v[204:207], v[148:151], v[8:11], v[204:207]
    ds_read_b128 v[164:167], v92 offset:26176
    ds_read_b128 v[180:183], v92 offset:30784
    v_mfma_f32_16x16x32_bf16 v[204:207], v[132:135], v[16:19], v[204:207]
    ds_read_b128 v[172:175], v92 offset:26240
    ds_read_b128 v[188:191], v92 offset:30848
    v_mfma_f32_16x16x32_bf16 v[204:207], v[156:159], v[12:15], v[204:207]
    v_lshlrev_b32 v208, 16, v104
    v_lshlrev_b32 v209, 16, v105
    v_mfma_f32_16x16x32_bf16 v[204:207], v[140:143], v[20:23], v[204:207]
    v_lshlrev_b32 v210, 16, v106
    v_lshlrev_b32 v211, 16, v107
    s_waitcnt lgkmcnt(6)
    s_nop 0
    v_mfma_f32_16x16x32_bf16 v[208:211], v[160:163], v[8:11], v[208:211]
    v_lshlrev_b32 v212, 16, v108
    v_lshlrev_b32 v213, 16, v109
    v_mfma_f32_16x16x32_bf16 v[208:211], v[176:179], v[24:27], v[208:211]
    v_lshlrev_b32 v214, 16, v110
    v_lshlrev_b32 v215, 16, v111
    s_waitcnt lgkmcnt(4)
    v_mfma_f32_16x16x32_bf16 v[208:211], v[168:171], v[12:15], v[208:211]
    v_cvt_pk_bf16_f32 v224, v192, v193
    v_cvt_pk_bf16_f32 v225, v194, v195
    v_mfma_f32_16x16x32_bf16 v[208:211], v[184:187], v[28:31], v[208:211]
    v_cvt_pk_bf16_f32 v226, v196, v197
    v_cvt_pk_bf16_f32 v227, v198, v199
    s_waitcnt lgkmcnt(2)
    v_mfma_f32_16x16x32_bf16 v[212:215], v[164:167], v[8:11], v[212:215]
    s_branch L_pgx4
L_pg4:
    s_setpc_b64 s[40:41]
L_pgx4:
    buffer_store_dwordx4 v[224:227], v248, s[24:27], s58 offen offset:0 sc1
    v_and_b32 v216, 0xffff0000, v104
    v_and_b32 v217, 0xffff0000, v105
    v_mfma_f32_16x16x32_bf16 v[212:215], v[180:183], v[24:27], v[212:215]
    v_and_b32 v218, 0xffff0000, v106
    v_and_b32 v219, 0xffff0000, v107
    s_waitcnt lgkmcnt(0)
    v_mfma_f32_16x16x32_bf16 v[212:215], v[172:175], v[12:15], v[212:215]
    v_and_b32 v220, 0xffff0000, v108
    v_and_b32 v221, 0xffff0000, v109
    v_mfma_f32_16x16x32_bf16 v[212:215], v[188:191], v[28:31], v[212:215]
    v_and_b32 v222, 0xffff0000, v110
    v_and_b32 v223, 0xffff0000, v111
    v_mfma_f32_16x16x32_bf16 v[216:219], v[176:179], v[8:11], v[216:219]
    v_cvt_pk_bf16_f32 v228, v200, v201
    v_cvt_pk_bf16_f32 v229, v202, v203
    v_mfma_f32_16x16x32_bf16 v[216:219], v[160:163], v[16:19], v[216:219]
    v_cvt_pk_bf16_f32 v230, v204, v205
    v_cvt_pk_bf16_f32 v231, v206, v207
    v_mfma_f32_16x16x32_bf16 v[216:219], v[184:187], v[12:15], v[216:219]
    buffer_store_dwordx4 v[228:231], v248, s[24:27], s58 offen offset:1024 sc1
    v_cvt_pk_bf16_f32 v232, v208, v209
    v_mfma_f32_16x16x32_bf16 v[216:219], v[168:171], v[20:23], v[216:219]
    v_cvt_pk_bf16_f32 v233, v210, v211
    v_cvt_pk_bf16_f32 v234, v212, v213
    v_mfma_f32_16x16x32_bf16 v[220:223], v[180:183], v[8:11], v[220:223]
    v_cvt_pk_bf16_f32 v235, v214, v215
    v_mfma_f32_16x16x32_bf16 v[220:223], v[164:167], v[16:19], v[220:223]
    buffer_store_dwordx4 v[232:235], v248, s[24:27], s58 offen offset:64 sc1
    v_mfma_f32_16x16x32_bf16 v[220:223], v[188:191], v[12:15], v[220:223]
    s_nop 0
    v_cvt_pk_bf16_f32 v236, v216, v217
    v_mfma_f32_16x16x32_bf16 v[220:223], v[172:175], v[20:23], v[220:223]
    v_cvt_pk_bf16_f32 v237, v218, v219
    s_nop 6
    v_cvt_pk_bf16_f32 v238, v220, v221
    v_cvt_pk_bf16_f32 v239, v222, v223
    buffer_store_dwordx4 v[236:239], v248, s[24:27], s58 offen offset:1088 sc1
    s_cmp_lg_u32 s32, 0
    s_cbranch_scc1 L_pe_51
    s_mov_b32 s42, 65536
    s_mov_b64 exec, 0xff
    s_waitcnt vmcnt(4)
    s_branch L_pc_49
L_pl_48:
    v_mov_b32 v95, 0
    buffer_atomic_add v95, v93, s[24:27], s97 offen offset:0 sc0 sc1
    s_waitcnt vmcnt(0)
L_pc_49:
    v_and_b32 v94, 524288, v95
    v_cmp_ne_u32 vcc, 524288, v94
    s_cbranch_vccz L_pd_50
    s_sub_u32 s42, s42, 1
    s_cbranch_scc0 L_pl_48
L_pd_50:
    s_mov_b64 exec, -1
L_pe_51:
L_join_30:
    s_barrier
    s_lshl_b32 s46, s67, 20
    s_sub_u32 s46, 1049088, s46
    v_mul_u32_u24 v240, 4096, v1
    v_mov_b32 v241, s46
    buffer_load_dwordx4 a[0:3], v4, s[24:27], s80 offen offset:0 sc1
    buffer_load_dwordx4 a[4:7], v4, s[24:27], s80 offen offset:1024 sc1
    buffer_load_dwordx4 a[8:11], v4, s[24:27], s80 offen offset:2048 sc1
    s_add_u32 s80, s80, 12288
    s_and_b32 s95, s36, 7
    s_lshr_b32 s96, s36, 3
    s_lshl_b32 s85, s32, 11
    s_mul_i32 s84, s35, 164480
    s_add_u32 s84, s84, 5693440
    v_add_u32 v133, s84, v4
    s_mul_i32 s46, s35, 393216
    s_add_u32 s46, s46, 11067392
    s_lshl_b32 s47, s36, 2
    s_add_u32 s47, s47, s32
    s_mul_i32 s47, s47, 768
    s_add_u32 s86, s46, s47
    s_mul_i32 s47, s96, 49152
    s_mul_i32 s48, s32, 12288
    s_add_u32 s87, s46, s47
    s_add_u32 s87, s87, s48
    s_lshl_b32 s48, s95, 2
    s_add_u32 s48, s48, s32
    s_mul_i32 s88, s48, 61440
    buffer_load_dwordx4 a[12:15], v4, s[24:27], s81 offen offset:0 sc1
    s_add_u32 s88, s88, 27582464
    s_mul_i32 s89, s48, 15360
    s_add_u32 s89, s89, 34177024
    s_mul_i32 s48, s35, 2048
    s_add_u32 s48, s48, 128
    s_lshr_b32 s49, s36, 2
    s_mul_i32 s49, s49, 512
    s_add_u32 s90, s48, s49
    s_mul_i32 s49, s32, 512
    s_add_u32 s91, s48, s49
    v_xor_b32 v5, s96, v3
    v_mul_u32_u24 v5, 49152, v5
    v_lshl_add_u32 v16, v2, 4, v5
    v_lshrrev_b32 v5, 1, v3
    v_mul_u32_u24 v5, 98048, v5
    v_sub_u32 v17, v16, v5
    s_add_u32 s78, s86, 196608
    s_add_u32 s79, s86, 294912
    v_lshrrev_b32 v5, 2, v1
    buffer_load_dwordx4 a[16:19], v4, s[24:27], s81 offen offset:1024 sc1
    v_lshlrev_b32 v5, 6, v5
    v_and_b32 v6, 3, v1
    v_lshl_add_u32 v5, v6, 3, v5
    v_xor_b32 v6, s96, v3
    v_and_b32 v6, 1, v6
    v_lshl_add_u32 v5, v6, 5, v5
    v_xor_b32 v6, 32, v5
    s_xor_b32 s46, s32, 0
    s_lshl_b32 s46, s46, 11
    v_add_u32 v8, s46, v5
    v_add_u32 v12, s46, v6
    s_xor_b32 s46, s32, 1
    s_lshl_b32 s46, s46, 11
    v_add_u32 v9, s46, v5
    v_add_u32 v13, s46, v6
    s_xor_b32 s46, s32, 2
    s_lshl_b32 s46, s46, 11
    v_add_u32 v10, s46, v5
    buffer_load_dwordx4 a[20:23], v4, s[24:27], s81 offen offset:2048 sc1
    s_add_u32 s81, s81, 12288
    v_add_u32 v14, s46, v6
    s_xor_b32 s46, s32, 3
    s_lshl_b32 s46, s46, 11
    v_add_u32 v11, s46, v5
    v_add_u32 v15, s46, v6
    v_lshlrev_b32 v19, 28, v2
    v_lshl_or_b32 v19, v3, 28, v19
    s_mov_b32 s66, 0x00f0000f
    s_mov_b32 s67, 0xf0000f00
    s_cmp_eq_u32 s32, 0
    s_cselect_b32 s64, 0xffff, 0
    s_mov_b32 s65, 0
    v_mov_b32 v5, 0xffff0000
    v_cndmask_b32 v21, -1, v5, s[64:65]
    s_lshl_b32 s46, s35, 3
    s_add_u32 s46, s46, s96
    s_lshl_b32 s46, s46, 6
    s_add_u32 s93, s46, 73728
    s_mul_i32 s47, s95, 40
    buffer_load_dwordx4 a[24:27], v4, s[24:27], s82 offen offset:0 sc1
    s_lshl1_add_u32 s47, s32, s47
    s_cmp_eq_u32 s47, 0
    s_cselect_b32 s64, 0xffff, 0
    s_mul_i32 s92, s47, 8320
    s_add_u32 s92, s92, s46
    s_add_u32 s92, s92, 2744320
    v_lshlrev_b32 v5, 2, v2
    v_mul_u32_u24 v22, 66560, v3
    v_add_u32 v22, v22, v5
    v_lshl_add_u32 v23, v3, 7, v5
    s_lshl_b32 s48, s96, 5
    v_and_b32 v5, 4, v1
    v_lshlrev_b32 v5, 8, v5
    v_and_b32 v6, 3, v1
    v_lshl_add_u32 v5, v6, 3, v5
    v_bfe_u32 v6, v1, 3, 1
    v_lshl_add_u32 v6, v3, 3, v6
    v_add_u32 v6, s47, v6
    v_and_b32 v7, -16, v6
    buffer_load_dwordx4 a[28:31], v4, s[24:27], s82 offen offset:1024 sc1
    v_add_u32 v7, v7, v6
    v_lshl_add_u32 v7, v7, 6, v5
    v_lshlrev_b32 v6, 3, v6
    v_and_b32 v6, 32, v6
    v_xad_u32 v146, v6, s48, v7
    v_bfe_u32 v6, v1, 3, 1
    v_add3_u32 v6, v6, s47, 32
    v_and_b32 v7, -16, v6
    v_add_u32 v7, v7, v6
    v_lshl_add_u32 v7, v7, 6, v5
    v_lshlrev_b32 v6, 3, v6
    v_and_b32 v6, 32, v6
    v_xad_u32 v147, v6, s48, v7
    v_mul_u32_u24 v6, 40960, v3
    v_cmp_eq_u32 vcc, 3, v3
    s_nop 1
    v_cndmask_b32 v6, v6, 0, vcc
    v_add_u32 v147, v147, v6
    v_mul_u32_u24 v104, 512, v2
    s_cmp_eq_u32 s32, 0
    s_cselect_b32 s46, 0xff, 0
    s_mov_b32 s47, 0
    v_mov_b32 v108, 25706496
    v_cndmask_b32 v107, -2.0, v104, s[46:47]
    v_cndmask_b32 v108, 0, v108, s[46:47]
    s_waitcnt vmcnt(8)
    s_barrier
    s_cmp_lg_u32 s32, 0
    s_cbranch_scc1 L_sg_52
    s_mov_b64 exec, 0xffff
    buffer_atomic_add v241, v240, s[24:27], s43 offen offset:0 sc1
    s_mov_b64 exec, -1
L_sg_52:
    buffer_load_dwordx4 a[32:35], v4, s[24:27], s82 offen offset:2048 sc1
    s_add_u32 s82, s82, 12288
    buffer_load_dwordx4 a[36:39], v4, s[24:27], s83 offen offset:0 sc1
    buffer_load_dwordx4 a[40:43], v4, s[24:27], s83 offen offset:1024 sc1
    buffer_load_dwordx4 a[44:47], v4, s[24:27], s83 offen offset:2048 sc1
    s_add_u32 s83, s83, 12288
    buffer_load_dwordx4 a[48:51], v4, s[24:27], s80 offen offset:0 sc1
    buffer_load_dwordx4 a[52:55], v4, s[24:27], s80 offen offset:1024 sc1
    buffer_load_dwordx4 a[56:59], v4, s[24:27], s80 offen offset:2048 sc1
    s_add_u32 s80, s80, 12288
    buffer_load_dwordx4 a[60:63], v4, s[24:27], s81 offen offset:0 sc1
    buffer_load_dwordx4 a[64:67], v4, s[24:27], s81 offen offset:1024 sc1
    buffer_load_dwordx4 a[68:71], v4, s[24:27], s81 offen offset:2048 sc1
    s_add_u32 s81, s81, 12288
    buffer_load_dwordx4 a[72:75], v4, s[24:27], s82 offen offset:0 sc1
    buffer_load_dwordx4 a[76:79], v4, s[24:27], s82 offen offset:1024 sc1
    s_cmp_lg_u32 s32, 0
    s_cbranch_scc1 L_sm_53
    v_mov_b32 v106, 0
    s_mov_b64 exec, 0xff
    buffer_atomic_add v106, v104, s[24:27], s97 offen offset:0 sc0 sc1
    s_mov_b64 exec, -1
L_sm_53:
    buffer_load_dwordx4 a[80:83], v4, s[24:27], s82 offen offset:2048 sc1
    s_add_u32 s82, s82, 12288
    buffer_load_dwordx4 a[84:87], v4, s[24:27], s83 offen offset:0 sc1
    buffer_load_dwordx4 a[88:91], v4, s[24:27], s83 offen offset:1024 sc1
    buffer_load_dwordx4 a[92:95], v4, s[24:27], s83 offen offset:2048 sc1
    s_add_u32 s83, s83, 12288
    buffer_load_dwordx4 a[96:99], v4, s[24:27], s80 offen offset:0 sc1
    buffer_load_dwordx4 a[100:103], v4, s[24:27], s80 offen offset:1024 sc1
    buffer_load_dwordx4 a[104:107], v4, s[24:27], s80 offen offset:2048 sc1
    s_add_u32 s80, s80, 12288
    buffer_load_dwordx4 a[108:111], v4, s[24:27], s81 offen offset:0 sc1
    buffer_load_dwordx4 a[112:115], v4, s[24:27], s81 offen offset:1024 sc1
    buffer_load_dwordx4 a[116:119], v4, s[24:27], s81 offen offset:2048 sc1
    s_add_u32 s81, s81, 12288
    buffer_load_dwordx4 a[120:123], v4, s[24:27], s82 offen offset:0 sc1
    buffer_load_dwordx4 a[124:127], v4, s[24:27], s82 offen offset:1024 sc1
L_c0:
    s_cmp_lg_u32 s32, 0
    s_cbranch_scc1 L_pe_57
    s_mov_b32 s42, 65536
    s_mov_b64 exec, 0xff
    s_waitcnt vmcnt(12)
    s_branch L_pc_55
L_pl_54:
    v_mov_b32 v106, 0
    buffer_atomic_add v106, v104, s[24:27], s97 offen offset:0 sc0 sc1
    s_waitcnt vmcnt(0)
L_pc_55:
    v_and_b32 v105, 25165824, v106
    v_cmp_ne_u32 vcc, 25165824, v105
    s_cbranch_vccz L_pd_56
    s_sub_u32 s42, s42, 1
    s_cbranch_scc0 L_pl_54
L_pd_56:
    s_mov_b64 exec, -1
L_pe_57:
    s_barrier
    s_add_u32 m0, s85, 0
    s_nop 0
    buffer_load_dwordx4 v133, s[24:27], m0 offen offset:0 sc1 lds
    buffer_load_dwordx4 v133, s[24:27], m0 offen offset:1024 sc1 lds
    s_add_u32 m0, s85, 40960
    s_nop 0
    buffer_load_dwordx4 v133, s[24:27], m0 offen offset:0 sc1 lds
    buffer_load_dwordx4 v133, s[24:27], m0 offen offset:1024 sc1 lds
    s_add_u32 m0, s85, 8192
    s_nop 0
    buffer_load_dwordx4 v133, s[24:27], m0 offen offset:0 sc1 lds
    buffer_load_dwordx4 v133, s[24:27], m0 offen offset:1024 sc1 lds
    s_add_u32 m0, s85, 49152
    s_nop 0
    buffer_load_dwordx4 v133, s[24:27], m0 offen offset:0 sc1 lds
    buffer_load_dwordx4 v133, s[24:27], m0 offen offset:1024 sc1 lds
    s_add_u32 m0, s85, 16384
    s_nop 0
    buffer_load_dwordx4 v133, s[24:27], m0 offen offset:0 sc1 lds
    buffer_load_dwordx4 v133, s[24:27], m0 offen offset:1024 sc1 lds
    s_add_u32 m0, s85, 57344
    s_nop 0
    buffer_load_dwordx4 v133, s[24:27], m0 offen offset:0 sc1 lds
    s_waitcnt vmcnt(9)
    s_waitcnt vmcnt(7)
    s_barrier
    ds_read_b64_tr_b16 v[24:25], v8 offset:0
    ds_read_b64_tr_b16 v[26:27], v8 offset:1024
    ds_read_b64_tr_b16 v[28:29], v9 offset:0
    ds_read_b64_tr_b16 v[30:31], v9 offset:1024
    ds_read_b64_tr_b16 v[32:33], v12 offset:0
    ds_read_b64_tr_b16 v[34:35], v12 offset:1024
    ds_read_b64_tr_b16 v[36:37], v13 offset:0
    ds_read_b64_tr_b16 v[38:39], v13 offset:1024
    ds_read_b64_tr_b16 v[40:41], v8 offset:40960
    ds_read_b64_tr_b16 v[42:43], v8 offset:41984
    ds_read_b64_tr_b16 v[44:45], v9 offset:40960
    ds_read_b64_tr_b16 v[46:47], v9 offset:41984
    s_waitcnt lgkmcnt(8)
    v_mfma_f32_16x16x32_bf16 v[56:59], a[0:3], v[24:27], 0
    ds_read_b64_tr_b16 v[48:49], v12 offset:40960
    v_mfma_f32_16x16x32_bf16 v[56:59], a[12:15], v[28:31], v[56:59]
    ds_read_b64_tr_b16 v[50:51], v12 offset:41984
    v_mfma_f32_16x16x32_bf16 v[60:63], a[4:7], v[24:27], 0
    ds_read_b64_tr_b16 v[52:53], v13 offset:40960
    v_mfma_f32_16x16x32_bf16 v[60:63], a[16:19], v[28:31], v[60:63]
    ds_read_b64_tr_b16 v[54:55], v13 offset:41984
    v_mfma_f32_16x16x32_bf16 v[64:67], a[8:11], v[24:27], 0
    v_and_b32 v26, v21, v26
    v_mfma_f32_16x16x32_bf16 v[64:67], a[20:23], v[28:31], v[64:67]
    buffer_load_dwordx4 v133, s[24:27], m0 offen offset:1024 sc1 lds
    v_mfma_f32_16x16x32_bf16 a[240:243], v[24:27], v[24:27], 0
    s_waitcnt lgkmcnt(8)
    v_mfma_f32_16x16x32_bf16 v[68:71], a[0:3], v[32:35], 0
    ds_read_b64_tr_b16 v[24:25], v10 offset:0
    v_mfma_f32_16x16x32_bf16 v[68:71], a[12:15], v[36:39], v[68:71]
    ds_read_b64_tr_b16 v[26:27], v10 offset:1024
    v_mfma_f32_16x16x32_bf16 v[72:75], a[4:7], v[32:35], 0
    ds_read_b64_tr_b16 v[28:29], v11 offset:0
    v_mfma_f32_16x16x32_bf16 v[72:75], a[16:19], v[36:39], v[72:75]
    ds_read_b64_tr_b16 v[30:31], v11 offset:1024
    buffer_load_dwordx4 a[128:131], v4, s[24:27], s82 offen offset:2048 sc1
    s_add_u32 s82, s82, 12288
    v_mfma_f32_16x16x32_bf16 v[76:79], a[8:11], v[32:35], 0
    v_mfma_f32_16x16x32_bf16 v[76:79], a[20:23], v[36:39], v[76:79]
    s_waitcnt lgkmcnt(8)
    v_mfma_f32_16x16x32_bf16 v[80:83], a[0:3], v[40:43], 0
    ds_read_b64_tr_b16 v[32:33], v14 offset:0
    v_mfma_f32_16x16x32_bf16 v[80:83], a[12:15], v[44:47], v[80:83]
    ds_read_b64_tr_b16 v[34:35], v14 offset:1024
    buffer_load_dwordx4 a[132:135], v4, s[24:27], s83 offen offset:0 sc1
    v_mfma_f32_16x16x32_bf16 v[84:87], a[4:7], v[40:43], 0
    ds_read_b64_tr_b16 v[36:37], v15 offset:0
    v_mfma_f32_16x16x32_bf16 v[84:87], a[16:19], v[44:47], v[84:87]
    ds_read_b64_tr_b16 v[38:39], v15 offset:1024
    v_mfma_f32_16x16x32_bf16 v[88:91], a[8:11], v[40:43], 0
    v_and_b32 v42, v21, v42
    v_mfma_f32_16x16x32_bf16 v[88:91], a[20:23], v[44:47], v[88:91]
    buffer_load_dwordx4 a[136:139], v4, s[24:27], s83 offen offset:1024 sc1
    v_mfma_f32_16x16x32_bf16 a[244:247], v[40:43], v[40:43], 0
    s_waitcnt lgkmcnt(8)
    v_mfma_f32_16x16x32_bf16 v[92:95], a[0:3], v[48:51], 0
    ds_read_b64_tr_b16 v[40:41], v10 offset:40960
    v_mfma_f32_16x16x32_bf16 v[92:95], a[12:15], v[52:55], v[92:95]
    ds_read_b64_tr_b16 v[42:43], v10 offset:41984
    v_mfma_f32_16x16x32_bf16 v[96:99], a[4:7], v[48:51], 0
    ds_read_b64_tr_b16 v[44:45], v11 offset:40960
    v_mfma_f32_16x16x32_bf16 v[96:99], a[16:19], v[52:55], v[96:99]
    ds_read_b64_tr_b16 v[46:47], v11 offset:41984
    v_mfma_f32_16x16x32_bf16 v[100:103], a[8:11], v[48:51], 0
    buffer_load_dwordx4 a[140:143], v4, s[24:27], s83 offen offset:2048 sc1
    s_add_u32 s83, s83, 12288
    v_mfma_f32_16x16x32_bf16 v[100:103], a[20:23], v[52:55], v[100:103]
    s_waitcnt lgkmcnt(8)
    v_mfma_f32_16x16x32_bf16 v[56:59], a[24:27], v[24:27], v[56:59]
    ds_read_b64_tr_b16 v[48:49], v14 offset:40960
    v_mov_b32 v18, 0
    v_mfma_f32_16x16x32_bf16 v[56:59], a[36:39], v[28:31], v[56:59]
    ds_read_b64_tr_b16 v[50:51], v14 offset:41984
    buffer_atomic_add v18, v107, s[24:27], s97 offen offset:0 sc0 sc1
    v_mfma_f32_16x16x32_bf16 v[60:63], a[28:31], v[24:27], v[60:63]
    ds_read_b64_tr_b16 v[52:53], v15 offset:40960
    buffer_load_dwordx4 a[144:147], v4, s[24:27], s80 offen offset:0 sc1
    v_mfma_f32_16x16x32_bf16 v[60:63], a[40:43], v[28:31], v[60:63]
    ds_read_b64_tr_b16 v[54:55], v15 offset:41984
    v_mfma_f32_16x16x32_bf16 v[64:67], a[32:35], v[24:27], v[64:67]
    v_mfma_f32_16x16x32_bf16 v[64:67], a[44:47], v[28:31], v[64:67]
    buffer_load_dwordx4 a[148:151], v4, s[24:27], s80 offen offset:1024 sc1
    s_waitcnt lgkmcnt(8)
    v_mfma_f32_16x16x32_bf16 v[68:71], a[24:27], v[32:35], v[68:71]
    s_waitcnt vmcnt(11)
    s_barrier
    v_mfma_f32_16x16x32_bf16 v[68:71], a[36:39], v[36:39], v[68:71]
    ds_read_b64_tr_b16 v[24:25], v8 offset:8192
    v_mfma_f32_16x16x32_bf16 v[72:75], a[28:31], v[32:35], v[72:75]
    ds_read_b64_tr_b16 v[26:27], v8 offset:9216
    v_mfma_f32_16x16x32_bf16 v[72:75], a[40:43], v[36:39], v[72:75]
    ds_read_b64_tr_b16 v[28:29], v9 offset:8192
    v_mfma_f32_16x16x32_bf16 v[76:79], a[32:35], v[32:35], v[76:79]
    ds_read_b64_tr_b16 v[30:31], v9 offset:9216
    buffer_load_dwordx4 a[152:155], v4, s[24:27], s80 offen offset:2048 sc1
    s_add_u32 s80, s80, 12288
    v_mfma_f32_16x16x32_bf16 v[76:79], a[44:47], v[36:39], v[76:79]
    s_waitcnt lgkmcnt(8)
    v_mfma_f32_16x16x32_bf16 v[80:83], a[24:27], v[40:43], v[80:83]
    ds_read_b64_tr_b16 v[32:33], v12 offset:8192
    v_mfma_f32_16x16x32_bf16 v[80:83], a[36:39], v[44:47], v[80:83]
    ds_read_b64_tr_b16 v[34:35], v12 offset:9216
    v_mfma_f32_16x16x32_bf16 v[84:87], a[28:31], v[40:43], v[84:87]
    ds_read_b64_tr_b16 v[36:37], v13 offset:8192
    buffer_load_dwordx4 a[156:159], v4, s[24:27], s81 offen offset:0 sc1
    v_mfma_f32_16x16x32_bf16 v[84:87], a[40:43], v[44:47], v[84:87]
    ds_read_b64_tr_b16 v[38:39], v13 offset:9216
    v_mfma_f32_16x16x32_bf16 v[88:91], a[32:35], v[40:43], v[88:91]
    v_mfma_f32_16x16x32_bf16 v[88:91], a[44:47], v[44:47], v[88:91]
    buffer_load_dwordx4 a[160:163], v4, s[24:27], s81 offen offset:1024 sc1
    s_waitcnt lgkmcnt(8)
    v_mfma_f32_16x16x32_bf16 v[92:95], a[24:27], v[48:51], v[92:95]
    ds_read_b64_tr_b16 v[40:41], v8 offset:49152
    v_mfma_f32_16x16x32_bf16 v[92:95], a[36:39], v[52:55], v[92:95]
    ds_read_b64_tr_b16 v[42:43], v8 offset:50176
    v_mfma_f32_16x16x32_bf16 v[96:99], a[28:31], v[48:51], v[96:99]
    ds_read_b64_tr_b16 v[44:45], v9 offset:49152
    v_mfma_f32_16x16x32_bf16 v[96:99], a[40:43], v[52:55], v[96:99]
    ds_read_b64_tr_b16 v[46:47], v9 offset:50176
    v_mfma_f32_16x16x32_bf16 v[100:103], a[32:35], v[48:51], v[100:103]
    buffer_load_dwordx4 a[164:167], v4, s[24:27], s81 offen offset:2048 sc1
    s_add_u32 s81, s81, 12288
    v_mfma_f32_16x16x32_bf16 v[100:103], a[44:47], v[52:55], v[100:103]
    s_waitcnt lgkmcnt(8)
    v_mfma_f32_16x16x32_bf16 v[56:59], a[48:51], v[24:27], v[56:59]
    ds_read_b64_tr_b16 v[48:49], v12 offset:49152
    v_mfma_f32_16x16x32_bf16 v[56:59], a[60:63], v[28:31], v[56:59]
    ds_read_b64_tr_b16 v[50:51], v12 offset:50176
    v_mfma_f32_16x16x32_bf16 v[60:63], a[52:55], v[24:27], v[60:63]
    ds_read_b64_tr_b16 v[52:53], v13 offset:49152
    v_mfma_f32_16x16x32_bf16 v[60:63], a[64:67], v[28:31], v[60:63]
    ds_read_b64_tr_b16 v[54:55], v13 offset:50176
    v_mfma_f32_16x16x32_bf16 v[64:67], a[56:59], v[24:27], v[64:67]
    buffer_load_dwordx4 a[168:171], v4, s[24:27], s82 offen offset:0 sc1
    v_mfma_f32_16x16x32_bf16 v[64:67], a[68:71], v[28:31], v[64:67]
    v_mfma_f32_16x16x32_bf16 a[240:243], v[24:27], v[24:27], a[240:243]
    s_waitcnt lgkmcnt(8)
    v_mfma_f32_16x16x32_bf16 v[68:71], a[48:51], v[32:35], v[68:71]
    ds_read_b64_tr_b16 v[24:25], v10 offset:8192
    v_mfma_f32_16x16x32_bf16 v[68:71], a[60:63], v[36:39], v[68:71]
    ds_read_b64_tr_b16 v[26:27], v10 offset:9216
    buffer_load_dwordx4 a[172:175], v4, s[24:27], s82 offen offset:1024 sc1
    v_mfma_f32_16x16x32_bf16 v[72:75], a[52:55], v[32:35], v[72:75]
    ds_read_b64_tr_b16 v[28:29], v11 offset:8192
    v_mfma_f32_16x16x32_bf16 v[72:75], a[64:67], v[36:39], v[72:75]
    ds_read_b64_tr_b16 v[30:31], v11 offset:9216
    v_mfma_f32_16x16x32_bf16 v[76:79], a[56:59], v[32:35], v[76:79]
    v_mfma_f32_16x16x32_bf16 v[76:79], a[68:71], v[36:39], v[76:79]
    buffer_load_dwordx4 a[176:179], v4, s[24:27], s82 offen offset:2048 sc1
    s_add_u32 s82, s82, 12288
    s_waitcnt lgkmcnt(8)
    v_mfma_f32_16x16x32_bf16 v[80:83], a[48:51], v[40:43], v[80:83]
    ds_read_b64_tr_b16 v[32:33], v14 offset:8192
    v_mfma_f32_16x16x32_bf16 v[80:83], a[60:63], v[44:47], v[80:83]
    ds_read_b64_tr_b16 v[34:35], v14 offset:9216
    v_mfma_f32_16x16x32_bf16 v[84:87], a[52:55], v[40:43], v[84:87]
    ds_read_b64_tr_b16 v[36:37], v15 offset:8192
    v_mfma_f32_16x16x32_bf16 v[84:87], a[64:67], v[44:47], v[84:87]
    ds_read_b64_tr_b16 v[38:39], v15 offset:9216
    v_mfma_f32_16x16x32_bf16 v[88:91], a[56:59], v[40:43], v[88:91]
    buffer_load_dwordx4 a[180:183], v4, s[24:27], s83 offen offset:0 sc1
    v_mfma_f32_16x16x32_bf16 v[88:91], a[68:71], v[44:47], v[88:91]
    v_mfma_f32_16x16x32_bf16 a[244:247], v[40:43], v[40:43], a[244:247]
    s_waitcnt lgkmcnt(8)
    v_mfma_f32_16x16x32_bf16 v[92:95], a[48:51], v[48:51], v[92:95]
    ds_read_b64_tr_b16 v[40:41], v10 offset:49152
    v_mfma_f32_16x16x32_bf16 v[92:95], a[60:63], v[52:55], v[92:95]
    ds_read_b64_tr_b16 v[42:43], v10 offset:50176
    v_mfma_f32_16x16x32_bf16 v[96:99], a[52:55], v[48:51], v[96:99]
    ds_read_b64_tr_b16 v[44:45], v11 offset:49152
    buffer_load_dwordx4 a[184:187], v4, s[24:27], s83 offen offset:1024 sc1
    v_mfma_f32_16x16x32_bf16 v[96:99], a[64:67], v[52:55], v[96:99]
    ds_read_b64_tr_b16 v[46:47], v11 offset:50176
    v_mfma_f32_16x16x32_bf16 v[100:103], a[56:59], v[48:51], v[100:103]
    v_mfma_f32_16x16x32_bf16 v[100:103], a[68:71], v[52:55], v[100:103]
    buffer_load_dwordx4 a[188:191], v4, s[24:27], s83 offen offset:2048 sc1
    s_add_u32 s83, s83, 12288
    s_waitcnt lgkmcnt(8)
    v_mfma_f32_16x16x32_bf16 v[56:59], a[72:75], v[24:27], v[56:59]
    ds_read_b64_tr_b16 v[48:49], v14 offset:49152
    v_mfma_f32_16x16x32_bf16 v[56:59], a[84:87], v[28:31], v[56:59]
    ds_read_b64_tr_b16 v[50:51], v14 offset:50176
    v_mfma_f32_16x16x32_bf16 v[60:63], a[76:79], v[24:27], v[60:63]
    ds_read_b64_tr_b16 v[52:53], v15 offset:49152
    v_mfma_f32_16x16x32_bf16 v[60:63], a[88:91], v[28:31], v[60:63]
    ds_read_b64_tr_b16 v[54:55], v15 offset:50176
    s_add_u32 m0, s85, 81920
    v_mfma_f32_16x16x32_bf16 v[64:67], a[80:83], v[24:27], v[64:67]
    s_waitcnt vmcnt(12)
    v_cmp_gt_u32 vcc, v108, v18
    s_cbranch_vccnz L_fw_58
L_fd_60:
    v_mfma_f32_16x16x32_bf16 v[64:67], a[92:95], v[28:31], v[64:67]
    buffer_load_dwordx4 v133, s[24:27], m0 offen offset:0 sc1 lds
    s_waitcnt lgkmcnt(8)
    v_mfma_f32_16x16x32_bf16 v[68:71], a[72:75], v[32:35], v[68:71]
    s_barrier
    s_add_u32 m0, s85, 24576
    v_mfma_f32_16x16x32_bf16 v[68:71], a[84:87], v[36:39], v[68:71]
    ds_read_b64_tr_b16 v[24:25], v8 offset:16384
    buffer_load_dwordx4 v133, s[24:27], m0 offen offset:0 sc1 lds
    v_mfma_f32_16x16x32_bf16 v[72:75], a[76:79], v[32:35], v[72:75]
    ds_read_b64_tr_b16 v[26:27], v8 offset:17408
    buffer_load_dwordx4 v133, s[24:27], m0 offen offset:1024 sc1 lds
    v_mfma_f32_16x16x32_bf16 v[72:75], a[88:91], v[36:39], v[72:75]
    ds_read_b64_tr_b16 v[28:29], v9 offset:16384
    s_add_u32 m0, s85, 65536
    v_mfma_f32_16x16x32_bf16 v[76:79], a[80:83], v[32:35], v[76:79]
    ds_read_b64_tr_b16 v[30:31], v9 offset:17408
    buffer_load_dwordx4 v133, s[24:27], m0 offen offset:0 sc1 lds
    v_mfma_f32_16x16x32_bf16 v[76:79], a[92:95], v[36:39], v[76:79]
    s_waitcnt lgkmcnt(8)
    v_mfma_f32_16x16x32_bf16 v[80:83], a[72:75], v[40:43], v[80:83]
    ds_read_b64_tr_b16 v[32:33], v12 offset:16384
    buffer_load_dwordx4 v133, s[24:27], m0 offen offset:1024 sc1 lds
    v_mfma_f32_16x16x32_bf16 v[80:83], a[84:87], v[44:47], v[80:83]
    ds_read_b64_tr_b16 v[34:35], v12 offset:17408
    v_mfma_f32_16x16x32_bf16 v[84:87], a[76:79], v[40:43], v[84:87]
    ds_read_b64_tr_b16 v[36:37], v13 offset:16384
    v_mfma_f32_16x16x32_bf16 v[84:87], a[88:91], v[44:47], v[84:87]
    ds_read_b64_tr_b16 v[38:39], v13 offset:17408
    v_mfma_f32_16x16x32_bf16 v[88:91], a[80:83], v[40:43], v[88:91]
    s_add_u32 m0, s85, 32768
    v_mfma_f32_16x16x32_bf16 v[88:91], a[92:95], v[44:47], v[88:91]
    buffer_load_dwordx4 v133, s[24:27], m0 offen offset:0 sc1 lds
    s_waitcnt lgkmcnt(8)
    v_mfma_f32_16x16x32_bf16 v[92:95], a[72:75], v[48:51], v[92:95]
    ds_read_b64_tr_b16 v[40:41], v8 offset:57344
    v_mfma_f32_16x16x32_bf16 v[92:95], a[84:87], v[52:55], v[92:95]
    ds_read_b64_tr_b16 v[42:43], v8 offset:58368
    v_mfma_f32_16x16x32_bf16 v[96:99], a[76:79], v[48:51], v[96:99]
    ds_read_b64_tr_b16 v[44:45], v9 offset:57344
    v_mfma_f32_16x16x32_bf16 v[96:99], a[88:91], v[52:55], v[96:99]
    ds_read_b64_tr_b16 v[46:47], v9 offset:58368
    v_mfma_f32_16x16x32_bf16 v[100:103], a[80:83], v[48:51], v[100:103]
    buffer_load_dwordx4 v133, s[24:27], m0 offen offset:1024 sc1 lds
    v_mfma_f32_16x16x32_bf16 v[100:103], a[92:95], v[52:55], v[100:103]
    s_waitcnt lgkmcnt(8)
    v_mfma_f32_16x16x32_bf16 v[56:59], a[96:99], v[24:27], v[56:59]
    ds_read_b64_tr_b16 v[48:49], v12 offset:57344
    v_mfma_f32_16x16x32_bf16 v[56:59], a[108:111], v[28:31], v[56:59]
    ds_read_b64_tr_b16 v[50:51], v12 offset:58368
    s_add_u32 m0, s85, 73728
    v_mfma_f32_16x16x32_bf16 v[60:63], a[100:103], v[24:27], v[60:63]
    ds_read_b64_tr_b16 v[52:53], v13 offset:57344
    v_mfma_f32_16x16x32_bf16 v[60:63], a[112:115], v[28:31], v[60:63]
    ds_read_b64_tr_b16 v[54:55], v13 offset:58368
    v_mfma_f32_16x16x32_bf16 v[64:67], a[104:107], v[24:27], v[64:67]
    buffer_load_dwordx4 v133, s[24:27], m0 offen offset:0 sc1 lds
    v_mfma_f32_16x16x32_bf16 v[64:67], a[116:119], v[28:31], v[64:67]
    v_mfma_f32_16x16x32_bf16 a[240:243], v[24:27], v[24:27], a[240:243]
    s_waitcnt lgkmcnt(8)
    v_mfma_f32_16x16x32_bf16 v[68:71], a[96:99], v[32:35], v[68:71]
    ds_read_b64_tr_b16 v[24:25], v10 offset:16384
    v_mfma_f32_16x16x32_bf16 v[68:71], a[108:111], v[36:39], v[68:71]
    ds_read_b64_tr_b16 v[26:27], v10 offset:17408
    buffer_load_dwordx4 v133, s[24:27], m0 offen offset:1024 sc1 lds
    v_mfma_f32_16x16x32_bf16 v[72:75], a[100:103], v[32:35], v[72:75]
    ds_read_b64_tr_b16 v[28:29], v11 offset:16384
    v_mfma_f32_16x16x32_bf16 v[72:75], a[112:115], v[36:39], v[72:75]
    ds_read_b64_tr_b16 v[30:31], v11 offset:17408
    s_add_u32 m0, s85, 81920
    v_mfma_f32_16x16x32_bf16 v[76:79], a[104:107], v[32:35], v[76:79]
    buffer_load_dwordx4 v133, s[24:27], m0 offen offset:1024 sc1 lds
    v_mfma_f32_16x16x32_bf16 v[76:79], a[116:119], v[36:39], v[76:79]
    s_waitcnt lgkmcnt(8)
    v_mfma_f32_16x16x32_bf16 v[80:83], a[96:99], v[40:43], v[80:83]
    ds_read_b64_tr_b16 v[32:33], v14 offset:16384
    v_mfma_f32_16x16x32_bf16 v[80:83], a[108:111], v[44:47], v[80:83]
    ds_read_b64_tr_b16 v[34:35], v14 offset:17408
    v_mfma_f32_16x16x32_bf16 v[84:87], a[100:103], v[40:43], v[84:87]
    ds_read_b64_tr_b16 v[36:37], v15 offset:16384
    s_add_u32 m0, s85, 90112
    v_mfma_f32_16x16x32_bf16 v[84:87], a[112:115], v[44:47], v[84:87]
    ds_read_b64_tr_b16 v[38:39], v15 offset:17408
    v_mfma_f32_16x16x32_bf16 v[88:91], a[104:107], v[40:43], v[88:91]
    buffer_load_dwordx4 v133, s[24:27], m0 offen offset:0 sc1 lds
    v_mfma_f32_16x16x32_bf16 v[88:91], a[116:119], v[44:47], v[88:91]
    v_mfma_f32_16x16x32_bf16 a[244:247], v[40:43], v[40:43], a[244:247]
    s_waitcnt lgkmcnt(8)
    v_mfma_f32_16x16x32_bf16 v[92:95], a[96:99], v[48:51], v[92:95]
    ds_read_b64_tr_b16 v[40:41], v10 offset:57344
    v_mfma_f32_16x16x32_bf16 v[92:95], a[108:111], v[52:55], v[92:95]
    ds_read_b64_tr_b16 v[42:43], v10 offset:58368
    v_mfma_f32_16x16x32_bf16 v[96:99], a[100:103], v[48:51], v[96:99]
    ds_read_b64_tr_b16 v[44:45], v11 offset:57344
    buffer_load_dwordx4 v133, s[24:27], m0 offen offset:1024 sc1 lds
    v_mfma_f32_16x16x32_bf16 v[96:99], a[112:115], v[52:55], v[96:99]
    ds_read_b64_tr_b16 v[46:47], v11 offset:58368
    v_mfma_f32_16x16x32_bf16 v[100:103], a[104:107], v[48:51], v[100:103]
    v_mfma_f32_16x16x32_bf16 v[100:103], a[116:119], v[52:55], v[100:103]
    buffer_load_dwordx4 a[192:195], v4, s[24:27], s80 offen offset:0 sc1
    s_waitcnt lgkmcnt(8)
    v_mfma_f32_16x16x32_bf16 v[56:59], a[120:123], v[24:27], v[56:59]
    ds_read_b64_tr_b16 v[48:49], v14 offset:57344
    v_mfma_f32_16x16x32_bf16 v[56:59], a[132:135], v[28:31], v[56:59]
    ds_read_b64_tr_b16 v[50:51], v14 offset:58368
    v_mfma_f32_16x16x32_bf16 v[60:63], a[124:127], v[24:27], v[60:63]
    ds_read_b64_tr_b16 v[52:53], v15 offset:57344
    v_mfma_f32_16x16x32_bf16 v[60:63], a[136:139], v[28:31], v[60:63]
    ds_read_b64_tr_b16 v[54:55], v15 offset:58368
    v_mfma_f32_16x16x32_bf16 v[64:67], a[128:131], v[24:27], v[64:67]
    buffer_load_dwordx4 a[196:199], v4, s[24:27], s80 offen offset:1024 sc1
    v_mfma_f32_16x16x32_bf16 v[64:67], a[140:143], v[28:31], v[64:67]
    s_waitcnt lgkmcnt(8)
    v_mfma_f32_16x16x32_bf16 v[68:71], a[120:123], v[32:35], v[68:71]
    s_waitcnt vmcnt(9)
    s_barrier
    v_mfma_f32_16x16x32_bf16 v[68:71], a[132:135], v[36:39], v[68:71]
    ds_read_b64_tr_b16 v[24:25], v8 offset:24576
    v_mfma_f32_16x16x32_bf16 v[72:75], a[124:127], v[32:35], v[72:75]
    ds_read_b64_tr_b16 v[26:27], v8 offset:25600
    v_mfma_f32_16x16x32_bf16 v[72:75], a[136:139], v[36:39], v[72:75]
    s_branch L_pgx5
L_pg5:
    s_setpc_b64 s[40:41]
L_pgx5:
    ds_read_b64_tr_b16 v[28:29], v9 offset:24576
    buffer_load_dwordx4 a[200:203], v4, s[24:27], s80 offen offset:2048 sc1
    v_mfma_f32_16x16x32_bf16 v[76:79], a[128:131], v[32:35], v[76:79]
    ds_read_b64_tr_b16 v[30:31], v9 offset:25600
    v_add_u32 v8, 0x6000, v8
    v_mfma_f32_16x16x32_bf16 v[76:79], a[140:143], v[36:39], v[76:79]
    v_add_u32 v9, 0x6000, v9
    s_waitcnt lgkmcnt(8)
    v_mfma_f32_16x16x32_bf16 v[80:83], a[120:123], v[40:43], v[80:83]
    ds_read_b64_tr_b16 v[32:33], v12 offset:24576
    v_mfma_f32_16x16x32_bf16 v[80:83], a[132:135], v[44:47], v[80:83]
    ds_read_b64_tr_b16 v[34:35], v12 offset:25600
    buffer_load_dwordx4 a[204:207], v4, s[24:27], s81 offen offset:0 sc1
    v_mfma_f32_16x16x32_bf16 v[84:87], a[124:127], v[40:43], v[84:87]
    ds_read_b64_tr_b16 v[36:37], v13 offset:24576
    v_add_u32 v12, 0x6000, v12
    v_mfma_f32_16x16x32_bf16 v[84:87], a[136:139], v[44:47], v[84:87]
    ds_read_b64_tr_b16 v[38:39], v13 offset:25600
    v_mfma_f32_16x16x32_bf16 v[88:91], a[128:131], v[40:43], v[88:91]
    buffer_load_dwordx4 a[208:211], v4, s[24:27], s81 offen offset:1024 sc1
    v_add_u32 v13, 0x6000, v13
    v_mfma_f32_16x16x32_bf16 v[88:91], a[140:143], v[44:47], v[88:91]
    s_waitcnt lgkmcnt(8)
    v_mfma_f32_16x16x32_bf16 v[92:95], a[120:123], v[48:51], v[92:95]
    ds_read_b64_tr_b16 v[40:41], v8 offset:40960
    v_mfma_f32_16x16x32_bf16 v[92:95], a[132:135], v[52:55], v[92:95]
    ds_read_b64_tr_b16 v[42:43], v8 offset:41984
    v_mfma_f32_16x16x32_bf16 v[96:99], a[124:127], v[48:51], v[96:99]
    ds_read_b64_tr_b16 v[44:45], v9 offset:40960
    v_mfma_f32_16x16x32_bf16 v[96:99], a[136:139], v[52:55], v[96:99]
    ds_read_b64_tr_b16 v[46:47], v9 offset:41984
    v_mfma_f32_16x16x32_bf16 v[100:103], a[128:131], v[48:51], v[100:103]
    buffer_load_dwordx4 a[212:215], v4, s[24:27], s81 offen offset:2048 sc1
    v_mfma_f32_16x16x32_bf16 v[100:103], a[140:143], v[52:55], v[100:103]
    s_waitcnt lgkmcnt(8)
    v_mfma_f32_16x16x32_bf16 v[56:59], a[144:147], v[24:27], v[56:59]
    ds_read_b64_tr_b16 v[48:49], v12 offset:40960
    v_mfma_f32_16x16x32_bf16 v[56:59], a[156:159], v[28:31], v[56:59]
    ds_read_b64_tr_b16 v[50:51], v12 offset:41984
    v_mfma_f32_16x16x32_bf16 v[60:63], a[148:151], v[24:27], v[60:63]
    ds_read_b64_tr_b16 v[52:53], v13 offset:40960
    v_mfma_f32_16x16x32_bf16 v[60:63], a[160:163], v[28:31], v[60:63]
    ds_read_b64_tr_b16 v[54:55], v13 offset:41984
    buffer_load_dwordx4 a[216:219], v4, s[24:27], s82 offen offset:0 sc1
    v_mfma_f32_16x16x32_bf16 v[64:67], a[152:155], v[24:27], v[64:67]
    v_mfma_f32_16x16x32_bf16 v[64:67], a[164:167], v[28:31], v[64:67]
    v_mfma_f32_16x16x32_bf16 a[240:243], v[24:27], v[24:27], a[240:243]
    buffer_load_dwordx4 a[220:223], v4, s[24:27], s82 offen offset:1024 sc1
    s_waitcnt lgkmcnt(8)
    v_mfma_f32_16x16x32_bf16 v[68:71], a[144:147], v[32:35], v[68:71]
    ds_read_b64_tr_b16 v[24:25], v10 offset:24576
    v_mfma_f32_16x16x32_bf16 v[68:71], a[156:159], v[36:39], v[68:71]
    ds_read_b64_tr_b16 v[26:27], v10 offset:25600
    v_mfma_f32_16x16x32_bf16 v[72:75], a[148:151], v[32:35], v[72:75]
    ds_read_b64_tr_b16 v[28:29], v11 offset:24576
    v_add_u32 v10, 0x6000, v10
    v_mfma_f32_16x16x32_bf16 v[72:75], a[160:163], v[36:39], v[72:75]
    ds_read_b64_tr_b16 v[30:31], v11 offset:25600
    v_mfma_f32_16x16x32_bf16 v[76:79], a[152:155], v[32:35], v[76:79]
    buffer_load_dwordx4 a[224:227], v4, s[24:27], s82 offen offset:2048 sc1
    v_add_u32 v11, 0x6000, v11
    v_mfma_f32_16x16x32_bf16 v[76:79], a[164:167], v[36:39], v[76:79]
    s_waitcnt lgkmcnt(8)
    v_mfma_f32_16x16x32_bf16 v[80:83], a[144:147], v[40:43], v[80:83]
    ds_read_b64_tr_b16 v[32:33], v14 offset:24576
    buffer_load_dwordx4 a[228:231], v4, s[24:27], s83 offen offset:0 sc1
    v_mfma_f32_16x16x32_bf16 v[80:83], a[156:159], v[44:47], v[80:83]
    ds_read_b64_tr_b16 v[34:35], v14 offset:25600
    v_mfma_f32_16x16x32_bf16 v[84:87], a[148:151], v[40:43], v[84:87]
    ds_read_b64_tr_b16 v[36:37], v15 offset:24576
    buffer_load_dwordx4 a[232:235], v4, s[24:27], s83 offen offset:1024 sc1
    v_mfma_f32_16x16x32_bf16 v[84:87], a[160:163], v[44:47], v[84:87]
    ds_read_b64_tr_b16 v[38:39], v15 offset:25600
    v_add_u32 v14, 0x6000, v14
    v_mfma_f32_16x16x32_bf16 v[88:91], a[152:155], v[40:43], v[88:91]
    buffer_load_dwordx4 a[236:239], v4, s[24:27], s83 offen offset:2048 sc1
    v_add_u32 v15, 0x6000, v15
    v_mfma_f32_16x16x32_bf16 v[88:91], a[164:167], v[44:47], v[88:91]
    s_add_u32 m0, s85, 98304
    v_mfma_f32_16x16x32_bf16 a[244:247], v[40:43], v[40:43], a[244:247]
    buffer_load_dwordx4 v133, s[24:27], m0 offen offset:0 sc1 lds
    s_waitcnt lgkmcnt(8)
    v_mfma_f32_16x16x32_bf16 v[92:95], a[144:147], v[48:51], v[92:95]
    ds_read_b64_tr_b16 v[40:41], v10 offset:40960
    v_mfma_f32_16x16x32_bf16 v[92:95], a[156:159], v[52:55], v[92:95]
    ds_read_b64_tr_b16 v[42:43], v10 offset:41984
    buffer_load_dwordx4 v133, s[24:27], m0 offen offset:1024 sc1 lds
    v_mfma_f32_16x16x32_bf16 v[96:99], a[148:151], v[48:51], v[96:99]
    ds_read_b64_tr_b16 v[44:45], v11 offset:40960
    s_add_u32 m0, s85, 106496
    v_mfma_f32_16x16x32_bf16 v[96:99], a[160:163], v[52:55], v[96:99]
    ds_read_b64_tr_b16 v[46:47], v11 offset:41984
    buffer_load_dwordx4 v133, s[24:27], m0 offen offset:0 sc1 lds
    v_mfma_f32_16x16x32_bf16 v[100:103], a[152:155], v[48:51], v[100:103]
    v_mfma_f32_16x16x32_bf16 v[100:103], a[164:167], v[52:55], v[100:103]
    buffer_load_dwordx4 v133, s[24:27], m0 offen offset:1024 sc1 lds
    s_waitcnt lgkmcnt(8)
    v_mfma_f32_16x16x32_bf16 v[56:59], a[168:171], v[24:27], v[56:59]
    ds_read_b64_tr_b16 v[48:49], v14 offset:40960
    v_mfma_f32_16x16x32_bf16 v[56:59], a[180:183], v[28:31], v[56:59]
    ds_read_b64_tr_b16 v[50:51], v14 offset:41984
    v_mfma_f32_16x16x32_bf16 v[60:63], a[172:175], v[24:27], v[60:63]
    ds_read_b64_tr_b16 v[52:53], v15 offset:40960
    s_add_u32 m0, s85, 114688
    v_mfma_f32_16x16x32_bf16 v[60:63], a[184:187], v[28:31], v[60:63]
    ds_read_b64_tr_b16 v[54:55], v15 offset:41984
    buffer_load_dwordx4 v133, s[24:27], m0 offen offset:0 sc1 lds
    v_mfma_f32_16x16x32_bf16 v[64:67], a[176:179], v[24:27], v[64:67]
    v_mfma_f32_16x16x32_bf16 v[64:67], a[188:191], v[28:31], v[64:67]
    buffer_load_dwordx4 v133, s[24:27], m0 offen offset:1024 sc1 lds
    s_waitcnt lgkmcnt(8)
    v_mfma_f32_16x16x32_bf16 v[68:71], a[168:171], v[32:35], v[68:71]
    s_waitcnt vmcnt(21)
    s_barrier
    v_mfma_f32_16x16x32_bf16 v[68:71], a[180:183], v[36:39], v[68:71]
    ds_read_b64_tr_b16 v[24:25], v8 offset:8192
    v_mfma_f32_16x16x32_bf16 v[72:75], a[172:175], v[32:35], v[72:75]
    ds_read_b64_tr_b16 v[26:27], v8 offset:9216
    s_add_u32 m0, s85, 120832
    s_add_u32 s68, s88, 16384
    v_mfma_f32_16x16x32_bf16 v[72:75], a[184:187], v[36:39], v[72:75]
    ds_read_b64_tr_b16 v[28:29], v9 offset:8192
    v_mfma_f32_16x16x32_bf16 v[76:79], a[176:179], v[32:35], v[76:79]
    ds_read_b64_tr_b16 v[30:31], v9 offset:9216
    buffer_load_dwordx4 v4, s[24:27], s68 offen offset:2048 sc1 lds
    v_mfma_f32_16x16x32_bf16 v[76:79], a[188:191], v[36:39], v[76:79]
    s_waitcnt lgkmcnt(8)
    v_mfma_f32_16x16x32_bf16 v[80:83], a[168:171], v[40:43], v[80:83]
    ds_read_b64_tr_b16 v[32:33], v10 offset:8192
    v_mfma_f32_16x16x32_bf16 v[80:83], a[180:183], v[44:47], v[80:83]
    ds_read_b64_tr_b16 v[34:35], v10 offset:9216
    v_mfma_f32_16x16x32_bf16 v[84:87], a[172:175], v[40:43], v[84:87]
    ds_read_b64_tr_b16 v[36:37], v11 offset:8192
    v_mfma_f32_16x16x32_bf16 v[84:87], a[184:187], v[44:47], v[84:87]
    ds_read_b64_tr_b16 v[38:39], v11 offset:9216
    buffer_load_dwordx4 v4, s[24:27], s68 offen offset:3072 sc1 lds
    v_mfma_f32_16x16x32_bf16 v[88:91], a[176:179], v[40:43], v[88:91]
    v_mfma_f32_16x16x32_bf16 v[88:91], a[188:191], v[44:47], v[88:91]
    s_waitcnt lgkmcnt(8)
    v_mfma_f32_16x16x32_bf16 v[92:95], a[168:171], v[48:51], v[92:95]
    ds_read_b64_tr_b16 v[40:41], v12 offset:8192
    ds_read_b64_tr_b16 v[134:135], v146 offset:0
    v_mfma_f32_16x16x32_bf16 v[92:95], a[180:183], v[52:55], v[92:95]
    ds_read_b64_tr_b16 v[42:43], v12 offset:9216
    buffer_load_dwordx4 v[152:155], v4, s[24:27], s88 offen offset:0 sc1
    v_mfma_f32_16x16x32_bf16 v[96:99], a[172:175], v[48:51], v[96:99]
    ds_read_b64_tr_b16 v[44:45], v13 offset:8192
    ds_read_b64_tr_b16 v[144:145], v147
    v_mfma_f32_16x16x32_bf16 v[96:99], a[184:187], v[52:55], v[96:99]
    ds_read_b64_tr_b16 v[46:47], v13 offset:9216
    ds_read_b64_tr_b16 v[136:137], v146 offset:40960
    v_mfma_f32_16x16x32_bf16 v[100:103], a[176:179], v[48:51], v[100:103]
    buffer_load_dwordx4 v[156:159], v4, s[24:27], s88 offen offset:1024 sc1
    v_mfma_f32_16x16x32_bf16 v[100:103], a[188:191], v[52:55], v[100:103]
    s_waitcnt lgkmcnt(11)
    s_waitcnt vmcnt(21)
    v_mfma_f32_16x16x32_bf16 v[56:59], a[192:195], v[24:27], v[56:59]
    ds_read_b64_tr_b16 v[48:49], v14 offset:8192
    s_waitcnt vmcnt(18)
    v_mfma_f32_16x16x32_bf16 v[56:59], a[204:207], v[28:31], v[56:59]
    ds_read_b64_tr_b16 v[50:51], v14 offset:9216
    v_mfma_f32_16x16x32_bf16 v[60:63], a[196:199], v[24:27], v[60:63]
    ds_read_b64_tr_b16 v[52:53], v15 offset:8192
    s_waitcnt vmcnt(17)
    v_mfma_f32_16x16x32_bf16 v[60:63], a[208:211], v[28:31], v[60:63]
    ds_read_b64_tr_b16 v[54:55], v15 offset:9216
    v_mfma_f32_16x16x32_bf16 v[64:67], a[200:203], v[24:27], v[64:67]
    buffer_load_dwordx4 v[160:163], v4, s[24:27], s88 offen offset:2048 sc1
    s_waitcnt vmcnt(17)
    v_mfma_f32_16x16x32_bf16 v[64:67], a[212:215], v[28:31], v[64:67]
    v_mfma_f32_16x16x32_bf16 a[240:243], v[24:27], v[24:27], a[240:243]
    s_waitcnt lgkmcnt(11)
    s_waitcnt vmcnt(16)
    v_mfma_f32_16x16x32_bf16 v[56:59], a[216:219], v[32:35], v[56:59]
    ds_read_b64_tr_b16 v[24:25], v8 offset:49152
    s_lshl_b32 s52, s32, 8
    s_waitcnt vmcnt(13)
    v_mfma_f32_16x16x32_bf16 v[56:59], a[228:231], v[36:39], v[56:59]
    ds_read_b64_tr_b16 v[26:27], v8 offset:50176
    s_add_u32 s52, s52, 158720
    v_mfma_f32_16x16x32_bf16 v[60:63], a[220:223], v[32:35], v[60:63]
    ds_read_b64_tr_b16 v[28:29], v9 offset:49152
    buffer_load_dwordx4 v[164:167], v4, s[24:27], s88 offen offset:3072 sc1
    s_waitcnt vmcnt(13)
    v_mfma_f32_16x16x32_bf16 v[60:63], a[232:235], v[36:39], v[60:63]
    ds_read_b64_tr_b16 v[30:31], v9 offset:50176
    v_lshl_add_u32 v5, v2, 4, s52
    v_mfma_f32_16x16x32_bf16 v[64:67], a[224:227], v[32:35], v[64:67]
    s_add_u32 s73, s88, 4096
    s_waitcnt vmcnt(12)
    v_mfma_f32_16x16x32_bf16 v[64:67], a[236:239], v[36:39], v[64:67]
    buffer_load_dwordx4 v[168:171], v4, s[24:27], s73 offen offset:0 sc1
    s_waitcnt lgkmcnt(9)
    v_mfma_f32_16x16x32_bf16 v[68:71], a[192:195], v[40:43], v[68:71]
    ds_read_b64_tr_b16 v[32:33], v10 offset:49152
    v_max_f32 v56, 0, v56
    v_mfma_f32_16x16x32_bf16 v[68:71], a[204:207], v[44:47], v[68:71]
    ds_read_b64_tr_b16 v[34:35], v10 offset:50176
    v_max_f32 v57, 0, v57
    v_mfma_f32_16x16x32_bf16 v[72:75], a[196:199], v[40:43], v[72:75]
    ds_read_b64_tr_b16 v[36:37], v11 offset:49152
    v_mul_f32 v56, v56, v60
    v_mfma_f32_16x16x32_bf16 v[72:75], a[208:211], v[44:47], v[72:75]
    ds_read_b64_tr_b16 v[38:39], v11 offset:50176
    v_mul_f32 v57, v57, v61
    v_mfma_f32_16x16x32_bf16 v[76:79], a[200:203], v[40:43], v[76:79]
    buffer_load_dwordx4 v[172:175], v4, s[24:27], s73 offen offset:1024 sc1
    v_cvt_pk_bf16_f32 v56, v56, v57
    v_mfma_f32_16x16x32_bf16 v[76:79], a[212:215], v[44:47], v[76:79]
    v_max_f32 v58, 0, v58
    s_waitcnt lgkmcnt(8)
    v_mfma_f32_16x16x32_bf16 v[68:71], a[216:219], v[48:51], v[68:71]
    ds_read_b64_tr_b16 v[40:41], v12 offset:49152
    v_max_f32 v59, 0, v59
    v_mfma_f32_16x16x32_bf16 v[68:71], a[228:231], v[52:55], v[68:71]
    ds_read_b64_tr_b16 v[42:43], v12 offset:50176
    v_mul_f32 v58, v58, v62
    v_mfma_f32_16x16x32_bf16 v[72:75], a[220:223], v[48:51], v[72:75]
    ds_read_b64_tr_b16 v[44:45], v13 offset:49152
    v_mul_f32 v59, v59, v63
    v_mfma_f32_16x16x32_bf16 v[72:75], a[232:235], v[52:55], v[72:75]
    ds_read_b64_tr_b16 v[46:47], v13 offset:50176
    buffer_load_dwordx4 v[176:179], v4, s[24:27], s73 offen offset:2048 sc1
    v_mfma_f32_16x16x32_bf16 v[76:79], a[224:227], v[48:51], v[76:79]
    s_mov_b64 exec, s[66:67]
    ds_write_b128 v5, a[240:243]
    s_mov_b64 exec, -1
    v_mfma_f32_16x16x32_bf16 v[76:79], a[236:239], v[52:55], v[76:79]
    buffer_load_dwordx4 v[180:183], v4, s[24:27], s73 offen offset:3072 sc1
    s_waitcnt lgkmcnt(9)
    v_mfma_f32_16x16x32_bf16 v[80:83], a[192:195], v[24:27], v[80:83]
    ds_read_b64_tr_b16 v[48:49], v14 offset:49152
    v_cvt_pk_bf16_f32 v60, v58, v59
    v_mfma_f32_16x16x32_bf16 v[80:83], a[204:207], v[28:31], v[80:83]
    ds_read_b64_tr_b16 v[50:51], v14 offset:50176
    v_permlane32_swap_b32 v64, v66
    v_mfma_f32_16x16x32_bf16 v[84:87], a[196:199], v[24:27], v[84:87]
    ds_read_b64_tr_b16 v[52:53], v15 offset:49152
    s_add_u32 s73, s88, 8192
    v_mfma_f32_16x16x32_bf16 v[84:87], a[208:211], v[28:31], v[84:87]
    ds_read_b64_tr_b16 v[54:55], v15 offset:50176
    v_permlane32_swap_b32 v65, v67
    v_mfma_f32_16x16x32_bf16 v[88:91], a[200:203], v[24:27], v[88:91]
    buffer_load_dwordx4 v[184:187], v4, s[24:27], s73 offen offset:0 sc1
    v_max_f32 v64, 0, v64
    v_mfma_f32_16x16x32_bf16 v[88:91], a[212:215], v[28:31], v[88:91]
    v_max_f32 v65, 0, v65
    v_mul_f32 v64, v64, v66
    v_mfma_f32_16x16x32_bf16 a[244:247], v[24:27], v[24:27], a[244:247]
    v_mul_f32 v65, v65, v67
    s_waitcnt lgkmcnt(9)
    v_mfma_f32_16x16x32_bf16 v[80:83], a[216:219], v[32:35], v[80:83]
    s_waitcnt vmcnt(11)
    s_barrier
    v_mfma_f32_16x16x32_bf16 v[80:83], a[228:231], v[36:39], v[80:83]
    ds_read_b64_tr_b16 v[24:25], v8 offset:57344
    v_add_u32 v133, 122880, v133
    s_add_u32 m0, s85, 0
    v_mfma_f32_16x16x32_bf16 v[84:87], a[220:223], v[32:35], v[84:87]
    ds_read_b64_tr_b16 v[26:27], v8 offset:58368
    buffer_load_dwordx4 v133, s[24:27], m0 offen offset:0 sc1 lds
    v_mfma_f32_16x16x32_bf16 v[84:87], a[232:235], v[36:39], v[84:87]
    ds_read_b64_tr_b16 v[28:29], v9 offset:57344
    v_add_u32 v8, 0x10000, v8
    v_mfma_f32_16x16x32_bf16 v[88:91], a[224:227], v[32:35], v[88:91]
    ds_read_b64_tr_b16 v[30:31], v9 offset:58368
    v_cvt_pk_bf16_f32 v64, v64, v65
    v_mfma_f32_16x16x32_bf16 v[88:91], a[236:239], v[36:39], v[88:91]
    buffer_load_dwordx4 v133, s[24:27], m0 offen offset:1024 sc1 lds
    s_waitcnt lgkmcnt(9)
    v_mfma_f32_16x16x32_bf16 v[92:95], a[192:195], v[40:43], v[92:95]
    ds_read_b64_tr_b16 v[32:33], v12 offset:57344
    v_add_u32 v9, 0x10000, v9
    v_mfma_f32_16x16x32_bf16 v[92:95], a[204:207], v[44:47], v[92:95]
    ds_read_b64_tr_b16 v[34:35], v12 offset:58368
    s_add_u32 m0, s85, 8192
    v_mfma_f32_16x16x32_bf16 v[96:99], a[196:199], v[40:43], v[96:99]
    ds_read_b64_tr_b16 v[36:37], v13 offset:57344
    v_add_u32 v12, 0x10000, v12
    v_mfma_f32_16x16x32_bf16 v[96:99], a[208:211], v[44:47], v[96:99]
    ds_read_b64_tr_b16 v[38:39], v13 offset:58368
    v_max_f32 v68, 0, v68
    v_mfma_f32_16x16x32_bf16 v[100:103], a[200:203], v[40:43], v[100:103]
    buffer_load_dwordx4 v133, s[24:27], m0 offen offset:0 sc1 lds
    v_add_u32 v13, 0x10000, v13
    v_mfma_f32_16x16x32_bf16 v[100:103], a[212:215], v[44:47], v[100:103]
    v_max_f32 v69, 0, v69
    s_waitcnt lgkmcnt(8)
    v_mfma_f32_16x16x32_bf16 v[92:95], a[216:219], v[48:51], v[92:95]
    ds_read_b64_tr_b16 v[40:41], v10 offset:57344
    v_mul_f32 v68, v68, v72
    v_mfma_f32_16x16x32_bf16 v[92:95], a[228:231], v[52:55], v[92:95]
    ds_read_b64_tr_b16 v[42:43], v10 offset:58368
    v_mul_f32 v69, v69, v73
    v_mfma_f32_16x16x32_bf16 v[96:99], a[220:223], v[48:51], v[96:99]
    ds_read_b64_tr_b16 v[44:45], v11 offset:57344
    buffer_load_dwordx4 v133, s[24:27], m0 offen offset:1024 sc1 lds
    v_mfma_f32_16x16x32_bf16 v[96:99], a[232:235], v[52:55], v[96:99]
    ds_read_b64_tr_b16 v[46:47], v11 offset:58368
    v_add_u32 v10, 0x10000, v10
    v_mfma_f32_16x16x32_bf16 v[100:103], a[224:227], v[48:51], v[100:103]
    s_add_u32 m0, s85, 16384
    v_add_u32 v11, 0x10000, v11
    v_mfma_f32_16x16x32_bf16 v[100:103], a[236:239], v[52:55], v[100:103]
    buffer_load_dwordx4 v133, s[24:27], m0 offen offset:0 sc1 lds
    s_waitcnt lgkmcnt(8)
    v_mfma_f32_16x16x32_bf16 v[104:107], a[0:3], v[24:27], 0
    ds_read_b64_tr_b16 v[48:49], v14 offset:57344
    v_cvt_pk_bf16_f32 v57, v68, v69
    v_mfma_f32_16x16x32_bf16 v[104:107], a[12:15], v[28:31], v[104:107]
    ds_read_b64_tr_b16 v[50:51], v14 offset:58368
    v_max_f32 v70, 0, v70
    v_mfma_f32_16x16x32_bf16 v[108:111], a[4:7], v[24:27], 0
    ds_read_b64_tr_b16 v[52:53], v15 offset:57344
    v_add_u32 v14, 0x10000, v14
    v_mfma_f32_16x16x32_bf16 v[108:111], a[16:19], v[28:31], v[108:111]
    ds_read_b64_tr_b16 v[54:55], v15 offset:58368
    v_max_f32 v71, 0, v71
    v_mfma_f32_16x16x32_bf16 v[112:115], a[8:11], v[24:27], 0
    v_and_b32 v26, v21, v26
    v_add_u32 v15, 0x10000, v15
    v_mfma_f32_16x16x32_bf16 v[112:115], a[20:23], v[28:31], v[112:115]
    buffer_load_dwordx4 v133, s[24:27], m0 offen offset:1024 sc1 lds
    v_mul_f32 v70, v70, v74
    v_mfma_f32_16x16x32_bf16 a[240:243], v[24:27], v[24:27], 0
    v_mul_f32 v71, v71, v75
    s_waitcnt lgkmcnt(8)
    v_mfma_f32_16x16x32_bf16 v[116:119], a[0:3], v[32:35], 0
    ds_read_b64_tr_b16 v[24:25], v8 offset:0
    v_cvt_pk_bf16_f32 v61, v70, v71
    v_mfma_f32_16x16x32_bf16 v[116:119], a[12:15], v[36:39], v[116:119]
    ds_read_b64_tr_b16 v[26:27], v8 offset:1024
    s_add_u32 m0, s85, 24576
    v_mfma_f32_16x16x32_bf16 v[120:123], a[4:7], v[32:35], 0
    ds_read_b64_tr_b16 v[28:29], v9 offset:0
    v_permlane32_swap_b32 v76, v78
    v_mfma_f32_16x16x32_bf16 v[120:123], a[16:19], v[36:39], v[120:123]
    ds_read_b64_tr_b16 v[30:31], v9 offset:1024
    buffer_load_dwordx4 v133, s[24:27], m0 offen offset:0 sc1 lds
    v_mfma_f32_16x16x32_bf16 v[124:127], a[8:11], v[32:35], 0
    v_permlane32_swap_b32 v77, v79
    v_max_f32 v76, 0, v76
    v_mfma_f32_16x16x32_bf16 v[124:127], a[20:23], v[36:39], v[124:127]
    v_max_f32 v77, 0, v77
    s_waitcnt lgkmcnt(8)
    v_mfma_f32_16x16x32_bf16 v[104:107], a[24:27], v[40:43], v[104:107]
    ds_read_b64_tr_b16 v[32:33], v12 offset:0
    v_mul_f32 v76, v76, v78
    v_mfma_f32_16x16x32_bf16 v[104:107], a[36:39], v[44:47], v[104:107]
    ds_read_b64_tr_b16 v[34:35], v12 offset:1024
    v_mul_f32 v77, v77, v79
    v_mfma_f32_16x16x32_bf16 v[108:111], a[28:31], v[40:43], v[108:111]
    ds_read_b64_tr_b16 v[36:37], v13 offset:0
    buffer_load_dwordx4 v133, s[24:27], m0 offen offset:1024 sc1 lds
    v_mfma_f32_16x16x32_bf16 v[108:111], a[40:43], v[44:47], v[108:111]
    ds_read_b64_tr_b16 v[38:39], v13 offset:1024
    v_cvt_pk_bf16_f32 v65, v76, v77
    v_mfma_f32_16x16x32_bf16 v[112:115], a[32:35], v[40:43], v[112:115]
    s_add_u32 m0, s85, 32768
    v_max_f32 v80, 0, v80
    v_mfma_f32_16x16x32_bf16 v[112:115], a[44:47], v[44:47], v[112:115]
    buffer_load_dwordx4 v133, s[24:27], m0 offen offset:0 sc1 lds
    s_waitcnt lgkmcnt(8)
    v_mfma_f32_16x16x32_bf16 v[116:119], a[24:27], v[48:51], v[116:119]
    ds_read_b64_tr_b16 v[40:41], v10 offset:0
    v_max_f32 v81, 0, v81
    v_mfma_f32_16x16x32_bf16 v[116:119], a[36:39], v[52:55], v[116:119]
    ds_read_b64_tr_b16 v[42:43], v10 offset:1024
    v_mul_f32 v80, v80, v84
    v_mfma_f32_16x16x32_bf16 v[120:123], a[28:31], v[48:51], v[120:123]
    ds_read_b64_tr_b16 v[44:45], v11 offset:0
    v_mul_f32 v81, v81, v85
    v_mfma_f32_16x16x32_bf16 v[120:123], a[40:43], v[52:55], v[120:123]
    ds_read_b64_tr_b16 v[46:47], v11 offset:1024
    v_cvt_pk_bf16_f32 v58, v80, v81
    v_mfma_f32_16x16x32_bf16 v[124:127], a[32:35], v[48:51], v[124:127]
    buffer_load_dwordx4 v133, s[24:27], m0 offen offset:1024 sc1 lds
    v_max_f32 v82, 0, v82
    v_mfma_f32_16x16x32_bf16 v[124:127], a[44:47], v[52:55], v[124:127]
    v_max_f32 v83, 0, v83
    s_waitcnt lgkmcnt(8)
    v_mfma_f32_16x16x32_bf16 v[104:107], a[48:51], v[24:27], v[104:107]
    ds_read_b64_tr_b16 v[48:49], v14 offset:0
    v_mul_f32 v82, v82, v86
    v_mfma_f32_16x16x32_bf16 v[104:107], a[60:63], v[28:31], v[104:107]
    ds_read_b64_tr_b16 v[50:51], v14 offset:1024
    s_add_u32 m0, s85, 38912
    s_add_u32 s68, s88, 8192
    v_mfma_f32_16x16x32_bf16 v[108:111], a[52:55], v[24:27], v[108:111]
    ds_read_b64_tr_b16 v[52:53], v15 offset:0
    v_mul_f32 v83, v83, v87
    v_mfma_f32_16x16x32_bf16 v[108:111], a[64:67], v[28:31], v[108:111]
    ds_read_b64_tr_b16 v[54:55], v15 offset:1024
    buffer_load_dwordx4 v4, s[24:27], s68 offen offset:2048 sc1 lds
    v_mfma_f32_16x16x32_bf16 v[112:115], a[56:59], v[24:27], v[112:115]
    v_cvt_pk_bf16_f32 v62, v82, v83
    v_permlane32_swap_b32 v88, v90
    v_mfma_f32_16x16x32_bf16 v[112:115], a[68:71], v[28:31], v[112:115]
    v_permlane32_swap_b32 v89, v91
    v_max_f32 v88, 0, v88
    v_mfma_f32_16x16x32_bf16 a[240:243], v[24:27], v[24:27], a[240:243]
    buffer_load_dwordx4 v4, s[24:27], s68 offen offset:3072 sc1 lds
    s_waitcnt lgkmcnt(8)
    v_mfma_f32_16x16x32_bf16 v[116:119], a[48:51], v[32:35], v[116:119]
    ds_read_b64_tr_b16 v[24:25], v8 offset:8192
    v_max_f32 v89, 0, v89
    v_mfma_f32_16x16x32_bf16 v[116:119], a[60:63], v[36:39], v[116:119]
    ds_read_b64_tr_b16 v[26:27], v8 offset:9216
    v_mul_f32 v88, v88, v90
    v_mfma_f32_16x16x32_bf16 v[120:123], a[52:55], v[32:35], v[120:123]
    ds_read_b64_tr_b16 v[28:29], v9 offset:8192
    v_mul_f32 v89, v89, v91
    v_mfma_f32_16x16x32_bf16 v[120:123], a[64:67], v[36:39], v[120:123]
    ds_read_b64_tr_b16 v[30:31], v9 offset:9216
    s_add_u32 m0, s85, 49152
    s_add_u32 s68, s88, 12288
    v_mfma_f32_16x16x32_bf16 v[124:127], a[56:59], v[32:35], v[124:127]
    buffer_load_dwordx4 v4, s[24:27], s68 offen offset:0 sc1 lds
    v_cvt_pk_bf16_f32 v66, v88, v89
    v_mfma_f32_16x16x32_bf16 v[124:127], a[68:71], v[36:39], v[124:127]
    v_max_f32 v92, 0, v92
    s_waitcnt lgkmcnt(8)
    v_mfma_f32_16x16x32_bf16 v[104:107], a[72:75], v[40:43], v[104:107]
    ds_read_b64_tr_b16 v[32:33], v12 offset:8192
    v_max_f32 v93, 0, v93
    v_mfma_f32_16x16x32_bf16 v[104:107], a[84:87], v[44:47], v[104:107]
    ds_read_b64_tr_b16 v[34:35], v12 offset:9216
    v_mul_f32 v92, v92, v96
    v_mfma_f32_16x16x32_bf16 v[108:111], a[76:79], v[40:43], v[108:111]
    ds_read_b64_tr_b16 v[36:37], v13 offset:8192
    v_mul_f32 v93, v93, v97
    v_mfma_f32_16x16x32_bf16 v[108:111], a[88:91], v[44:47], v[108:111]
    ds_read_b64_tr_b16 v[38:39], v13 offset:9216
    v_cvt_pk_bf16_f32 v59, v92, v93
    v_mfma_f32_16x16x32_bf16 v[112:115], a[80:83], v[40:43], v[112:115]
    buffer_load_dwordx4 v4, s[24:27], s68 offen offset:1024 sc1 lds
    v_max_f32 v94, 0, v94
    v_mfma_f32_16x16x32_bf16 v[112:115], a[92:95], v[44:47], v[112:115]
    v_max_f32 v95, 0, v95
    s_waitcnt lgkmcnt(8)
    v_mfma_f32_16x16x32_bf16 v[116:119], a[72:75], v[48:51], v[116:119]
    ds_read_b64_tr_b16 v[40:41], v10 offset:8192
    s_add_u32 m0, s85, 55296
    v_mfma_f32_16x16x32_bf16 v[116:119], a[84:87], v[52:55], v[116:119]
    ds_read_b64_tr_b16 v[42:43], v10 offset:9216
    v_permlane32_swap_b32 v56, v58
    v_mfma_f32_16x16x32_bf16 v[120:123], a[76:79], v[48:51], v[120:123]
    ds_read_b64_tr_b16 v[44:45], v11 offset:8192
    buffer_load_dwordx4 v4, s[24:27], s68 offen offset:2048 sc1 lds
    v_mfma_f32_16x16x32_bf16 v[120:123], a[88:91], v[52:55], v[120:123]
    ds_read_b64_tr_b16 v[46:47], v11 offset:9216
    v_permlane32_swap_b32 v57, v59
    v_mfma_f32_16x16x32_bf16 v[124:127], a[80:83], v[48:51], v[124:127]
    s_nop 0
    v_permlane16_swap_b32 v56, v57
    v_permlane16_swap_b32 v58, v59
    v_mfma_f32_16x16x32_bf16 v[124:127], a[92:95], v[52:55], v[124:127]
    buffer_store_dwordx4 v[56:59], v16, s[24:27], s86 offen offset:0 sc1
    s_waitcnt lgkmcnt(8)
    v_mfma_f32_16x16x32_bf16 v[104:107], a[96:99], v[24:27], v[104:107]
    ds_read_b64_tr_b16 v[48:49], v14 offset:8192
    v_mul_f32 v94, v94, v98
    v_mfma_f32_16x16x32_bf16 v[104:107], a[108:111], v[28:31], v[104:107]
    ds_read_b64_tr_b16 v[50:51], v14 offset:9216
    v_mul_f32 v95, v95, v99
    v_mfma_f32_16x16x32_bf16 v[108:111], a[100:103], v[24:27], v[108:111]
    ds_read_b64_tr_b16 v[52:53], v15 offset:8192
    v_cvt_pk_bf16_f32 v63, v94, v95
    v_mfma_f32_16x16x32_bf16 v[108:111], a[112:115], v[28:31], v[108:111]
    ds_read_b64_tr_b16 v[54:55], v15 offset:9216
    v_permlane32_swap_b32 v100, v102
    v_mfma_f32_16x16x32_bf16 v[112:115], a[104:107], v[24:27], v[112:115]
    buffer_load_dwordx4 v4, s[24:27], s68 offen offset:3072 sc1 lds
    v_permlane32_swap_b32 v101, v103
    v_mfma_f32_16x16x32_bf16 v[112:115], a[116:119], v[28:31], v[112:115]
    v_permlane32_swap_b32 v60, v62
    v_permlane32_swap_b32 v61, v63
    v_mfma_f32_16x16x32_bf16 a[240:243], v[24:27], v[24:27], a[240:243]
    s_add_u32 m0, s85, 65536
    s_add_u32 s68, s88, 16384
    s_waitcnt lgkmcnt(8)
    v_mfma_f32_16x16x32_bf16 v[116:119], a[96:99], v[32:35], v[116:119]
    ds_read_b64_tr_b16 v[24:25], v8 offset:16384
    v_permlane16_swap_b32 v60, v61
    v_mfma_f32_16x16x32_bf16 v[116:119], a[108:111], v[36:39], v[116:119]
    ds_read_b64_tr_b16 v[26:27], v8 offset:17408
    buffer_load_dwordx4 v4, s[24:27], s68 offen offset:0 sc1 lds
    v_mfma_f32_16x16x32_bf16 v[120:123], a[100:103], v[32:35], v[120:123]
    ds_read_b64_tr_b16 v[28:29], v9 offset:16384
    v_permlane16_swap_b32 v62, v63
    v_mfma_f32_16x16x32_bf16 v[120:123], a[112:115], v[36:39], v[120:123]
    ds_read_b64_tr_b16 v[30:31], v9 offset:17408
    buffer_store_dwordx4 v[60:63], v16, s[24:27], s86 offen offset:256 sc1
    v_mfma_f32_16x16x32_bf16 v[124:127], a[104:107], v[32:35], v[124:127]
    v_max_f32 v100, 0, v100
    v_max_f32 v101, 0, v101
    v_mfma_f32_16x16x32_bf16 v[124:127], a[116:119], v[36:39], v[124:127]
    v_mul_f32 v100, v100, v102
    s_waitcnt lgkmcnt(8)
    v_mfma_f32_16x16x32_bf16 v[104:107], a[120:123], v[40:43], v[104:107]
    ds_read_b64_tr_b16 v[32:33], v10 offset:16384
    v_mul_f32 v101, v101, v103
    v_mfma_f32_16x16x32_bf16 v[104:107], a[132:135], v[44:47], v[104:107]
    ds_read_b64_tr_b16 v[34:35], v10 offset:17408
    v_cvt_pk_bf16_f32 v67, v100, v101
    v_mfma_f32_16x16x32_bf16 v[108:111], a[124:127], v[40:43], v[108:111]
    ds_read_b64_tr_b16 v[36:37], v11 offset:16384
    buffer_load_dwordx4 v4, s[24:27], s68 offen offset:1024 sc1 lds
    v_mfma_f32_16x16x32_bf16 v[108:111], a[136:139], v[44:47], v[108:111]
    ds_read_b64_tr_b16 v[38:39], v11 offset:17408
    v_permlane32_swap_b32 v64, v66
    v_mfma_f32_16x16x32_bf16 v[112:115], a[128:131], v[40:43], v[112:115]
    v_permlane32_swap_b32 v65, v67
    s_lshl_b32 s52, s32, 8
    v_mfma_f32_16x16x32_bf16 v[112:115], a[140:143], v[44:47], v[112:115]
    v_permlane16_swap_b32 v64, v65
    s_waitcnt lgkmcnt(8)
    v_mfma_f32_16x16x32_bf16 v[116:119], a[120:123], v[48:51], v[116:119]
    ds_read_b64_tr_b16 v[40:41], v8 offset:24576
    v_permlane16_swap_b32 v66, v67
    v_mfma_f32_16x16x32_bf16 v[116:119], a[132:135], v[52:55], v[116:119]
    ds_read_b64_tr_b16 v[42:43], v8 offset:25600
    buffer_load_dwordx4 v[188:191], v4, s[24:27], s73 offen offset:1024 sc1
    v_mfma_f32_16x16x32_bf16 v[120:123], a[124:127], v[48:51], v[120:123]
    ds_read_b64_tr_b16 v[44:45], v9 offset:24576
    v_add_u32 v8, 0xfffea000, v8
    v_mfma_f32_16x16x32_bf16 v[120:123], a[136:139], v[52:55], v[120:123]
    ds_read_b64_tr_b16 v[46:47], v9 offset:25600
    s_add_u32 s73, s88, 20480
    v_mfma_f32_16x16x32_bf16 v[124:127], a[128:131], v[48:51], v[124:127]
    buffer_load_dwordx4 v[192:195], v4, s[24:27], s73 offen offset:0 sc1
    v_add_u32 v9, 0xfffea000, v9
    v_mfma_f32_16x16x32_bf16 v[124:127], a[140:143], v[52:55], v[124:127]
    buffer_store_dwordx4 v[64:67], v16, s[24:27], s86 offen offset:512 sc1
    s_waitcnt lgkmcnt(8)
    v_mfma_f32_16x16x32_bf16 v[104:107], a[144:147], v[24:27], v[104:107]
    ds_read_b64_tr_b16 v[48:49], v10 offset:24576
    v_mov_b32 v20, 33554432
    v_mfma_f32_16x16x32_bf16 v[104:107], a[156:159], v[28:31], v[104:107]
    ds_read_b64_tr_b16 v[50:51], v10 offset:25600
    s_add_u32 s52, s52, 159744
    v_mfma_f32_16x16x32_bf16 v[108:111], a[148:151], v[24:27], v[108:111]
    ds_read_b64_tr_b16 v[52:53], v11 offset:24576
    v_add_u32 v10, 0xfffea000, v10
    v_mfma_f32_16x16x32_bf16 v[108:111], a[160:163], v[28:31], v[108:111]
    ds_read_b64_tr_b16 v[54:55], v11 offset:25600
    v_lshl_add_u32 v5, v2, 4, s52
    v_mfma_f32_16x16x32_bf16 v[112:115], a[152:155], v[24:27], v[112:115]
    v_add_u32 v11, 0xfffea000, v11
    v_add_u32 v146, 0x14000, v146
    ds_read_b64_tr_b16 v[138:139], v146 offset:0
    v_mfma_f32_16x16x32_bf16 v[112:115], a[164:167], v[28:31], v[112:115]
    buffer_load_dwordx4 v[196:199], v4, s[24:27], s73 offen offset:1024 sc1
    v_mfma_f32_16x16x32_bf16 a[240:243], v[24:27], v[24:27], a[240:243]
    s_waitcnt lgkmcnt(9)
    v_mfma_f32_16x16x32_bf16 v[104:107], a[168:171], v[32:35], v[104:107]
    ds_read_b64_tr_b16 v[24:25], v12 offset:16384
    v_mfma_f32_16x16x32_bf16 v[104:107], a[180:183], v[36:39], v[104:107]
    ds_read_b64_tr_b16 v[26:27], v12 offset:17408
    v_mfma_f32_16x16x32_bf16 v[108:111], a[172:175], v[32:35], v[108:111]
    ds_read_b64_tr_b16 v[28:29], v13 offset:16384
    v_mfma_f32_16x16x32_bf16 v[108:111], a[184:187], v[36:39], v[108:111]
    ds_read_b64_tr_b16 v[30:31], v13 offset:17408
    v_mfma_f32_16x16x32_bf16 v[112:115], a[176:179], v[32:35], v[112:115]
    buffer_load_dwordx4 v[200:203], v4, s[24:27], s73 offen offset:2048 sc1
    v_mfma_f32_16x16x32_bf16 v[112:115], a[188:191], v[36:39], v[112:115]
    s_waitcnt lgkmcnt(9)
    v_mfma_f32_16x16x32_bf16 v[104:107], a[192:195], v[40:43], v[104:107]
    ds_read_b64_tr_b16 v[32:33], v14 offset:16384
    v_mfma_f32_16x16x32_bf16 v[104:107], a[204:207], v[44:47], v[104:107]
    s_branch L_pgx6
L_pg6:
    s_setpc_b64 s[40:41]
L_pgx6:
    ds_read_b64_tr_b16 v[34:35], v14 offset:17408
    v_mfma_f32_16x16x32_bf16 v[108:111], a[196:199], v[40:43], v[108:111]
    ds_read_b64_tr_b16 v[36:37], v15 offset:16384
    v_mfma_f32_16x16x32_bf16 v[108:111], a[208:211], v[44:47], v[108:111]
    ds_read_b64_tr_b16 v[38:39], v15 offset:17408
    buffer_load_dwordx4 v[204:207], v4, s[24:27], s73 offen offset:3072 sc1
    v_mfma_f32_16x16x32_bf16 v[112:115], a[200:203], v[40:43], v[112:115]
    s_mov_b64 exec, s[66:67]
    ds_write_b128 v5, a[244:247]
    s_mov_b64 exec, -1
    v_mfma_f32_16x16x32_bf16 v[112:115], a[212:215], v[44:47], v[112:115]
    s_add_u32 s73, s88, 24576
    v_mfma_f32_16x16x32_bf16 a[240:243], v[40:43], v[40:43], a[240:243]
    buffer_load_dwordx4 v[208:211], v4, s[24:27], s73 offen offset:0 sc1
    s_waitcnt lgkmcnt(10)
    v_mfma_f32_16x16x32_bf16 v[104:107], a[216:219], v[48:51], v[104:107]
    ds_read_b64_tr_b16 v[40:41], v12 offset:24576
    s_lshl_b32 s52, s32, 8
    v_mfma_f32_16x16x32_bf16 v[104:107], a[228:231], v[52:55], v[104:107]
    ds_read_b64_tr_b16 v[42:43], v12 offset:25600
    s_add_u32 s52, s52, 160768
    v_mfma_f32_16x16x32_bf16 v[108:111], a[220:223], v[48:51], v[108:111]
    ds_read_b64_tr_b16 v[44:45], v13 offset:24576
    v_add_u32 v12, 0xfffea000, v12
    v_mfma_f32_16x16x32_bf16 v[108:111], a[232:235], v[52:55], v[108:111]
    ds_read_b64_tr_b16 v[46:47], v13 offset:25600
    buffer_load_dwordx4 v[212:215], v4, s[24:27], s73 offen offset:1024 sc1
    v_mfma_f32_16x16x32_bf16 v[112:115], a[224:227], v[48:51], v[112:115]
    v_add_u32 v13, 0xfffea000, v13
    v_lshl_add_u32 v5, v2, 4, s52
    v_mfma_f32_16x16x32_bf16 v[112:115], a[236:239], v[52:55], v[112:115]
    s_waitcnt lgkmcnt(9)
    v_mfma_f32_16x16x32_bf16 v[116:119], a[144:147], v[24:27], v[116:119]
    ds_read_b64_tr_b16 v[48:49], v14 offset:24576
    v_max_f32 v104, 0, v104
    v_mfma_f32_16x16x32_bf16 v[116:119], a[156:159], v[28:31], v[116:119]
    ds_read_b64_tr_b16 v[50:51], v14 offset:25600
    v_max_f32 v105, 0, v105
    v_mfma_f32_16x16x32_bf16 v[120:123], a[148:151], v[24:27], v[120:123]
    ds_read_b64_tr_b16 v[52:53], v15 offset:24576
    buffer_load_dwordx4 v[216:219], v4, s[24:27], s73 offen offset:2048 sc1
    v_mfma_f32_16x16x32_bf16 v[120:123], a[160:163], v[28:31], v[120:123]
    ds_read_b64_tr_b16 v[54:55], v15 offset:25600
    v_add_u32 v14, 0xfffea000, v14
    v_mfma_f32_16x16x32_bf16 v[124:127], a[152:155], v[24:27], v[124:127]
    v_add_u32 v15, 0xfffea000, v15
    v_mul_f32 v104, v104, v108
    v_mfma_f32_16x16x32_bf16 v[124:127], a[164:167], v[28:31], v[124:127]
    buffer_load_dwordx4 v[220:223], v4, s[24:27], s73 offen offset:3072 sc1
    s_waitcnt lgkmcnt(9)
    v_mfma_f32_16x16x32_bf16 v[116:119], a[168:171], v[32:35], v[116:119]
    s_waitcnt vmcnt(20)
    s_barrier
    v_mfma_f32_16x16x32_bf16 v[116:119], a[180:183], v[36:39], v[116:119]
    ds_read_b64_tr_b16 v[24:25], v8 offset:0
    s_add_u32 s73, s88, 28672
    v_mfma_f32_16x16x32_bf16 v[120:123], a[172:175], v[32:35], v[120:123]
    ds_read_b64_tr_b16 v[26:27], v8 offset:1024
    v_mul_f32 v105, v105, v109
    v_mfma_f32_16x16x32_bf16 v[120:123], a[184:187], v[36:39], v[120:123]
    ds_read_b64_tr_b16 v[28:29], v9 offset:0
    buffer_load_dwordx4 v[224:227], v4, s[24:27], s73 offen offset:0 sc1
    v_mfma_f32_16x16x32_bf16 v[124:127], a[176:179], v[32:35], v[124:127]
    ds_read_b64_tr_b16 v[30:31], v9 offset:1024
    v_cvt_pk_bf16_f32 v104, v104, v105
    v_mfma_f32_16x16x32_bf16 v[124:127], a[188:191], v[36:39], v[124:127]
    v_max_f32 v106, 0, v106
    s_waitcnt lgkmcnt(8)
    v_mfma_f32_16x16x32_bf16 v[116:119], a[192:195], v[40:43], v[116:119]
    ds_read_b64_tr_b16 v[32:33], v12 offset:0
    v_max_f32 v107, 0, v107
    v_mfma_f32_16x16x32_bf16 v[116:119], a[204:207], v[44:47], v[116:119]
    ds_read_b64_tr_b16 v[34:35], v12 offset:1024
    v_mul_f32 v106, v106, v110
    v_mfma_f32_16x16x32_bf16 v[120:123], a[196:199], v[40:43], v[120:123]
    ds_read_b64_tr_b16 v[36:37], v13 offset:0
    buffer_load_dwordx4 v[228:231], v4, s[24:27], s73 offen offset:1024 sc1
    v_mfma_f32_16x16x32_bf16 v[120:123], a[208:211], v[44:47], v[120:123]
    ds_read_b64_tr_b16 v[38:39], v13 offset:1024
    v_mul_f32 v107, v107, v111
    v_mfma_f32_16x16x32_bf16 v[124:127], a[200:203], v[40:43], v[124:127]
    s_waitcnt vmcnt(9)
    buffer_atomic_add v20, v19, s[24:27], s90 offen sc1
    v_mfma_f32_16x16x32_bf16 v[124:127], a[212:215], v[44:47], v[124:127]
    buffer_load_dwordx4 v[232:235], v4, s[24:27], s73 offen offset:2048 sc1
    s_waitcnt lgkmcnt(8)
    v_mfma_f32_16x16x32_bf16 v[116:119], a[216:219], v[48:51], v[116:119]
    ds_read_b64_tr_b16 v[40:41], v10 offset:0
    v_cvt_pk_bf16_f32 v106, v106, v107
    v_mfma_f32_16x16x32_bf16 v[116:119], a[228:231], v[52:55], v[116:119]
    ds_read_b64_tr_b16 v[42:43], v10 offset:1024
    v_permlane32_swap_b32 v112, v114
    v_mfma_f32_16x16x32_bf16 v[120:123], a[220:223], v[48:51], v[120:123]
    ds_read_b64_tr_b16 v[44:45], v11 offset:0
    v_permlane32_swap_b32 v113, v115
    v_mfma_f32_16x16x32_bf16 v[120:123], a[232:235], v[52:55], v[120:123]
    ds_read_b64_tr_b16 v[46:47], v11 offset:1024
    v_max_f32 v112, 0, v112
    v_mfma_f32_16x16x32_bf16 v[124:127], a[224:227], v[48:51], v[124:127]
    buffer_load_dwordx4 v[236:239], v4, s[24:27], s73 offen offset:3072 sc1
    v_max_f32 v113, 0, v113
    v_mfma_f32_16x16x32_bf16 v[124:127], a[236:239], v[52:55], v[124:127]
    v_mul_f32 v112, v112, v114
    s_waitcnt lgkmcnt(8)
    s_mov_b64 exec, s[66:67]
    ds_write_b128 v5, a[240:243]
    s_mov_b64 exec, -1
    v_mfma_f32_16x16x32_bf16 v[56:59], a[0:3], v[24:27], 0
    ds_read_b64_tr_b16 v[48:49], v14 offset:0
    s_add_u32 s73, s88, 32768
    v_mfma_f32_16x16x32_bf16 v[56:59], a[12:15], v[28:31], v[56:59]
    ds_read_b64_tr_b16 v[50:51], v14 offset:1024
    buffer_load_dwordx4 v[240:243], v4, s[24:27], s73 offen offset:0 sc1
    v_mfma_f32_16x16x32_bf16 v[60:63], a[4:7], v[24:27], 0
    ds_read_b64_tr_b16 v[52:53], v15 offset:0
    v_mul_f32 v113, v113, v115
    v_mfma_f32_16x16x32_bf16 v[60:63], a[16:19], v[28:31], v[60:63]
    ds_read_b64_tr_b16 v[54:55], v15 offset:1024
    v_cvt_pk_bf16_f32 v108, v112, v113
    v_mfma_f32_16x16x32_bf16 v[64:67], a[8:11], v[24:27], 0
    v_and_b32 v26, v21, v26
    v_max_f32 v116, 0, v116
    v_mfma_f32_16x16x32_bf16 v[64:67], a[20:23], v[28:31], v[64:67]
    buffer_load_dwordx4 v[244:247], v4, s[24:27], s73 offen offset:1024 sc1
    v_max_f32 v117, 0, v117
    v_mfma_f32_16x16x32_bf16 a[240:243], v[24:27], v[24:27], 0
    v_mul_f32 v116, v116, v120
    s_waitcnt lgkmcnt(9)
    v_mfma_f32_16x16x32_bf16 v[68:71], a[0:3], v[32:35], 0
    ds_read_b64_tr_b16 v[24:25], v8 offset:8192
    v_mul_f32 v117, v117, v121
    v_mfma_f32_16x16x32_bf16 v[68:71], a[12:15], v[36:39], v[68:71]
    ds_read_b64_tr_b16 v[26:27], v8 offset:9216
    v_cvt_pk_bf16_f32 v105, v116, v117
    v_mfma_f32_16x16x32_bf16 v[72:75], a[4:7], v[32:35], 0
    ds_read_b64_tr_b16 v[28:29], v9 offset:8192
    v_max_f32 v118, 0, v118
    v_mfma_f32_16x16x32_bf16 v[72:75], a[16:19], v[36:39], v[72:75]
    ds_read_b64_tr_b16 v[30:31], v9 offset:9216
    buffer_load_dwordx4 v[248:251], v4, s[24:27], s73 offen offset:2048 sc1
    v_mfma_f32_16x16x32_bf16 v[76:79], a[8:11], v[32:35], 0
    v_max_f32 v119, 0, v119
    v_mul_f32 v118, v118, v122
    v_mfma_f32_16x16x32_bf16 v[76:79], a[20:23], v[36:39], v[76:79]
    v_mul_f32 v119, v119, v123
    s_waitcnt lgkmcnt(9)
    v_mfma_f32_16x16x32_bf16 v[56:59], a[24:27], v[40:43], v[56:59]
    ds_read_b64_tr_b16 v[32:33], v12 offset:8192
    v_cvt_pk_bf16_f32 v107, v118, v119
    v_mfma_f32_16x16x32_bf16 v[56:59], a[36:39], v[44:47], v[56:59]
    ds_read_b64_tr_b16 v[34:35], v12 offset:9216
    v_permlane32_swap_b32 v124, v126
    v_mfma_f32_16x16x32_bf16 v[60:63], a[28:31], v[40:43], v[60:63]
    ds_read_b64_tr_b16 v[36:37], v13 offset:8192
    buffer_load_dwordx4 a[248:251], v4, s[24:27], s73 offen offset:3072 sc1
    v_mfma_f32_16x16x32_bf16 v[60:63], a[40:43], v[44:47], v[60:63]
    ds_read_b64_tr_b16 v[38:39], v13 offset:9216
    v_permlane32_swap_b32 v125, v127
    v_mfma_f32_16x16x32_bf16 v[64:67], a[32:35], v[40:43], v[64:67]
    s_add_u32 s73, s88, 36864
    v_permlane32_swap_b32 v104, v106
    v_mfma_f32_16x16x32_bf16 v[64:67], a[44:47], v[44:47], v[64:67]
    buffer_load_dwordx4 a[252:255], v4, s[24:27], s73 offen offset:0 sc1
    s_waitcnt lgkmcnt(8)
    v_mfma_f32_16x16x32_bf16 v[68:71], a[24:27], v[48:51], v[68:71]
    ds_read_b64_tr_b16 v[40:41], v10 offset:8192
    v_permlane32_swap_b32 v105, v107
    v_mfma_f32_16x16x32_bf16 v[68:71], a[36:39], v[52:55], v[68:71]
    ds_read_b64_tr_b16 v[42:43], v10 offset:9216
    v_permlane16_swap_b32 v104, v105
    v_mfma_f32_16x16x32_bf16 v[72:75], a[28:31], v[48:51], v[72:75]
    ds_read_b64_tr_b16 v[44:45], v11 offset:8192
    v_permlane16_swap_b32 v106, v107
    v_mfma_f32_16x16x32_bf16 v[72:75], a[40:43], v[52:55], v[72:75]
    ds_read_b64_tr_b16 v[46:47], v11 offset:9216
    buffer_store_dwordx4 v[104:107], v17, s[24:27], s78 offen offset:0 sc1
    v_mfma_f32_16x16x32_bf16 v[76:79], a[32:35], v[48:51], v[76:79]
    v_max_f32 v124, 0, v124
    v_max_f32 v125, 0, v125
    v_mfma_f32_16x16x32_bf16 v[76:79], a[44:47], v[52:55], v[76:79]
    v_mul_f32 v124, v124, v126
    s_waitcnt lgkmcnt(8)
    v_mfma_f32_16x16x32_bf16 v[56:59], a[48:51], v[24:27], v[56:59]
    ds_read_b64_tr_b16 v[48:49], v14 offset:8192
    v_mul_f32 v125, v125, v127
    v_mfma_f32_16x16x32_bf16 v[56:59], a[60:63], v[28:31], v[56:59]
    ds_read_b64_tr_b16 v[50:51], v14 offset:9216
    buffer_load_dwordx4 v[80:83], v4, s[24:27], s73 offen offset:1024 sc1
    v_mfma_f32_16x16x32_bf16 v[60:63], a[52:55], v[24:27], v[60:63]
    ds_read_b64_tr_b16 v[52:53], v15 offset:8192
    v_cvt_pk_bf16_f32 v109, v124, v125
    v_mfma_f32_16x16x32_bf16 v[60:63], a[64:67], v[28:31], v[60:63]
    ds_read_b64_tr_b16 v[54:55], v15 offset:9216
    v_permlane32_swap_b32 v108, v110
    v_mfma_f32_16x16x32_bf16 v[64:67], a[56:59], v[24:27], v[64:67]
    v_permlane32_swap_b32 v109, v111
    v_mfma_f32_16x16x32_bf16 v[64:67], a[68:71], v[28:31], v[64:67]
    buffer_load_dwordx4 v[84:87], v4, s[24:27], s73 offen offset:2048 sc1
    v_permlane16_swap_b32 v108, v109
    v_mfma_f32_16x16x32_bf16 a[240:243], v[24:27], v[24:27], a[240:243]
    v_permlane16_swap_b32 v110, v111
    s_waitcnt lgkmcnt(8)
    v_mfma_f32_16x16x32_bf16 v[68:71], a[48:51], v[32:35], v[68:71]
    ds_read_b64_tr_b16 v[24:25], v8 offset:16384
    v_mfma_f32_16x16x32_bf16 v[68:71], a[60:63], v[36:39], v[68:71]
    ds_read_b64_tr_b16 v[26:27], v8 offset:17408
    v_mfma_f32_16x16x32_bf16 v[72:75], a[52:55], v[32:35], v[72:75]
    ds_read_b64_tr_b16 v[28:29], v9 offset:16384
    v_mfma_f32_16x16x32_bf16 v[72:75], a[64:67], v[36:39], v[72:75]
    ds_read_b64_tr_b16 v[30:31], v9 offset:17408
    v_mfma_f32_16x16x32_bf16 v[76:79], a[56:59], v[32:35], v[76:79]
    buffer_load_dwordx4 v[88:91], v4, s[24:27], s73 offen offset:3072 sc1
    v_mfma_f32_16x16x32_bf16 v[76:79], a[68:71], v[36:39], v[76:79]
    s_waitcnt lgkmcnt(8)
    v_mfma_f32_16x16x32_bf16 v[56:59], a[72:75], v[40:43], v[56:59]
    ds_read_b64_tr_b16 v[32:33], v12 offset:16384
    s_add_u32 s73, s88, 40960
    v_mfma_f32_16x16x32_bf16 v[56:59], a[84:87], v[44:47], v[56:59]
    ds_read_b64_tr_b16 v[34:35], v12 offset:17408
    v_mfma_f32_16x16x32_bf16 v[60:63], a[76:79], v[40:43], v[60:63]
    ds_read_b64_tr_b16 v[36:37], v13 offset:16384
    buffer_load_dwordx4 v[92:95], v4, s[24:27], s73 offen offset:0 sc1
    v_mfma_f32_16x16x32_bf16 v[60:63], a[88:91], v[44:47], v[60:63]
    ds_read_b64_tr_b16 v[38:39], v13 offset:17408
    v_mfma_f32_16x16x32_bf16 v[64:67], a[80:83], v[40:43], v[64:67]
    s_mov_b32 exec_hi, 0
    buffer_store_dwordx4 v[108:111], v17, s[24:27], s78 offen offset:512 sc1
    s_mov_b32 exec_hi, -1
    v_mfma_f32_16x16x32_bf16 v[64:67], a[92:95], v[44:47], v[64:67]
    v_mov_b32 v20, 1048576
    s_waitcnt lgkmcnt(8)
    v_mfma_f32_16x16x32_bf16 v[68:71], a[72:75], v[48:51], v[68:71]
    ds_read_b64_tr_b16 v[40:41], v10 offset:16384
    v_mov_b32 v18, 0
    v_mfma_f32_16x16x32_bf16 v[68:71], a[84:87], v[52:55], v[68:71]
    ds_read_b64_tr_b16 v[42:43], v10 offset:17408
    buffer_atomic_add v18, v19, s[24:27], s91 offen sc0 sc1
    v_mfma_f32_16x16x32_bf16 v[72:75], a[76:79], v[48:51], v[72:75]
    ds_read_b64_tr_b16 v[44:45], v11 offset:16384
    v_mfma_f32_16x16x32_bf16 v[72:75], a[88:91], v[52:55], v[72:75]
    ds_read_b64_tr_b16 v[46:47], v11 offset:17408
    buffer_load_dwordx4 v[96:99], v4, s[24:27], s73 offen offset:1024 sc1
    v_mfma_f32_16x16x32_bf16 v[76:79], a[80:83], v[48:51], v[76:79]
    v_mfma_f32_16x16x32_bf16 v[76:79], a[92:95], v[52:55], v[76:79]
    s_waitcnt lgkmcnt(8)
    v_mfma_f32_16x16x32_bf16 v[56:59], a[96:99], v[24:27], v[56:59]
    ds_read_b64_tr_b16 v[48:49], v14 offset:16384
    v_add_u32 v146, 0xfffec000, v146
    ds_read_b64_tr_b16 v[140:141], v146 offset:0
    v_mfma_f32_16x16x32_bf16 v[56:59], a[108:111], v[28:31], v[56:59]
    ds_read_b64_tr_b16 v[50:51], v14 offset:17408
    buffer_load_dwordx4 v[100:103], v4, s[24:27], s73 offen offset:2048 sc1
    v_mfma_f32_16x16x32_bf16 v[60:63], a[100:103], v[24:27], v[60:63]
    ds_read_b64_tr_b16 v[52:53], v15 offset:16384
    ds_read_b64_tr_b16 v[142:143], v147
    v_mfma_f32_16x16x32_bf16 v[60:63], a[112:115], v[28:31], v[60:63]
    ds_read_b64_tr_b16 v[54:55], v15 offset:17408
    v_mfma_f32_16x16x32_bf16 v[64:67], a[104:107], v[24:27], v[64:67]
    buffer_load_dwordx4 a[244:247], v4, s[24:27], s73 offen offset:3072 sc1
    v_mfma_f32_16x16x32_bf16 v[64:67], a[116:119], v[28:31], v[64:67]
    v_mfma_f32_16x16x32_bf16 a[240:243], v[24:27], v[24:27], a[240:243]
    s_waitcnt lgkmcnt(10)
    v_mfma_f32_16x16x32_bf16 v[68:71], a[96:99], v[32:35], v[68:71]
    ds_read_b64_tr_b16 v[24:25], v8 offset:24576
    v_mfma_f32_16x16x32_bf16 v[68:71], a[108:111], v[36:39], v[68:71]
    ds_read_b64_tr_b16 v[26:27], v8 offset:25600
    s_add_u32 s73, s88, 45056
    v_mfma_f32_16x16x32_bf16 v[72:75], a[100:103], v[32:35], v[72:75]
    ds_read_b64_tr_b16 v[28:29], v9 offset:24576
    v_mfma_f32_16x16x32_bf16 v[72:75], a[112:115], v[36:39], v[72:75]
    ds_read_b64_tr_b16 v[30:31], v9 offset:25600
    buffer_load_dwordx4 a[0:3], v4, s[24:27], s73 offen offset:0 sc1
    v_mfma_f32_16x16x32_bf16 v[76:79], a[104:107], v[32:35], v[76:79]
    v_mfma_f32_16x16x32_bf16 v[76:79], a[116:119], v[36:39], v[76:79]
    s_waitcnt lgkmcnt(10)
    v_mfma_f32_16x16x32_bf16 v[56:59], a[120:123], v[40:43], v[56:59]
    ds_read_b64_tr_b16 v[32:33], v12 offset:24576
    v_mfma_f32_16x16x32_bf16 v[56:59], a[132:135], v[44:47], v[56:59]
    ds_read_b64_tr_b16 v[34:35], v12 offset:25600
    v_mfma_f32_16x16x32_bf16 v[60:63], a[124:127], v[40:43], v[60:63]
    ds_read_b64_tr_b16 v[36:37], v13 offset:24576
    buffer_load_dwordx4 a[4:7], v4, s[24:27], s73 offen offset:1024 sc1
    v_mfma_f32_16x16x32_bf16 v[60:63], a[136:139], v[44:47], v[60:63]
    ds_read_b64_tr_b16 v[38:39], v13 offset:25600
    v_mfma_f32_16x16x32_bf16 v[64:67], a[128:131], v[40:43], v[64:67]
    v_mfma_f32_16x16x32_bf16 v[64:67], a[140:143], v[44:47], v[64:67]
    buffer_load_dwordx4 a[8:11], v4, s[24:27], s73 offen offset:2048 sc1
    s_waitcnt lgkmcnt(8)
    v_mfma_f32_16x16x32_bf16 v[68:71], a[120:123], v[48:51], v[68:71]
    ds_read_b64_tr_b16 v[40:41], v10 offset:24576
    v_mfma_f32_16x16x32_bf16 v[68:71], a[132:135], v[52:55], v[68:71]
    ds_read_b64_tr_b16 v[42:43], v10 offset:25600
    v_mfma_f32_16x16x32_bf16 v[72:75], a[124:127], v[48:51], v[72:75]
    ds_read_b64_tr_b16 v[44:45], v11 offset:24576
    v_mfma_f32_16x16x32_bf16 v[72:75], a[136:139], v[52:55], v[72:75]
    ds_read_b64_tr_b16 v[46:47], v11 offset:25600
    v_mfma_f32_16x16x32_bf16 v[76:79], a[128:131], v[48:51], v[76:79]
    buffer_load_dwordx4 a[12:15], v4, s[24:27], s73 offen offset:3072 sc1
    v_mfma_f32_16x16x32_bf16 v[76:79], a[140:143], v[52:55], v[76:79]
    s_waitcnt lgkmcnt(8)
    v_mfma_f32_16x16x32_bf16 v[56:59], a[144:147], v[24:27], v[56:59]
    ds_read_b64_tr_b16 v[48:49], v8 offset:32768
    v_mfma_f32_16x16x32_bf16 v[56:59], a[156:159], v[28:31], v[56:59]
    ds_read_b64_tr_b16 v[50:51], v8 offset:33792
    s_add_u32 s73, s88, 49152
    v_mfma_f32_16x16x32_bf16 v[60:63], a[148:151], v[24:27], v[60:63]
    ds_read_b64_tr_b16 v[52:53], v9 offset:32768
    v_mfma_f32_16x16x32_bf16 v[60:63], a[160:163], v[28:31], v[60:63]
    ds_read_b64_tr_b16 v[54:55], v9 offset:33792
    v_mfma_f32_16x16x32_bf16 v[64:67], a[152:155], v[24:27], v[64:67]
    buffer_load_dwordx4 a[16:19], v4, s[24:27], s73 offen offset:0 sc1
    v_mfma_f32_16x16x32_bf16 v[64:67], a[164:167], v[28:31], v[64:67]
    v_mfma_f32_16x16x32_bf16 a[240:243], v[24:27], v[24:27], a[240:243]
    s_waitcnt lgkmcnt(8)
    v_mfma_f32_16x16x32_bf16 v[68:71], a[144:147], v[32:35], v[68:71]
    ds_read_b64_tr_b16 v[24:25], v10 offset:32768
    v_add_u32 v133, s85, v4
    v_add_u32 v133, 0xa000, v133
    v_mfma_f32_16x16x32_bf16 v[68:71], a[156:159], v[36:39], v[68:71]
    ds_read_b64_tr_b16 v[26:27], v10 offset:33792
    buffer_load_dwordx4 a[20:23], v4, s[24:27], s73 offen offset:1024 sc1
    v_mfma_f32_16x16x32_bf16 v[72:75], a[148:151], v[32:35], v[72:75]
    ds_read_b64_tr_b16 v[28:29], v11 offset:32768
    ds_read_b128 a[24:27], v133 offset:0
    v_mfma_f32_16x16x32_bf16 v[72:75], a[160:163], v[36:39], v[72:75]
    ds_read_b64_tr_b16 v[30:31], v11 offset:33792
    ds_read_b128 a[28:31], v133 offset:1024
    v_mfma_f32_16x16x32_bf16 v[76:79], a[152:155], v[32:35], v[76:79]
    buffer_load_dwordx4 a[32:35], v4, s[24:27], s73 offen offset:2048 sc1
    ds_read_b128 a[36:39], v133 offset:8192
    v_mfma_f32_16x16x32_bf16 v[76:79], a[164:167], v[36:39], v[76:79]
    s_waitcnt lgkmcnt(11)
    ds_read_b128 a[40:43], v133 offset:9216
    v_mfma_f32_16x16x32_bf16 v[56:59], a[168:171], v[40:43], v[56:59]
    s_waitcnt vmcnt(10)
    v_cmp_le_u32 vcc, 536870912, v18
    s_cbranch_vccz L_fw_61
L_fd_63:
    v_mfma_f32_16x16x32_bf16 v[56:59], a[180:183], v[44:47], v[56:59]
    ds_read_b64_tr_b16 v[32:33], v14 offset:24576
    buffer_load_dwordx4 a[44:47], v4, s[24:27], s87 offen offset:0 sc1
    v_mfma_f32_16x16x32_bf16 v[60:63], a[172:175], v[40:43], v[60:63]
    ds_read_b64_tr_b16 v[34:35], v14 offset:25600
    ds_read_b128 a[48:51], v133 offset:16384
    v_mfma_f32_16x16x32_bf16 v[60:63], a[184:187], v[44:47], v[60:63]
    s_waitcnt lgkmcnt(11)
    ds_read_b64_tr_b16 v[36:37], v15 offset:24576
    v_mfma_f32_16x16x32_bf16 v[64:67], a[176:179], v[40:43], v[64:67]
    ds_read_b64_tr_b16 v[38:39], v15 offset:25600
    buffer_load_dwordx4 a[52:55], v4, s[24:27], s87 offen offset:1024 sc1
    v_mfma_f32_16x16x32_bf16 v[64:67], a[188:191], v[44:47], v[64:67]
    s_add_u32 s70, s87, 98304
    v_mfma_f32_16x16x32_bf16 v[56:59], a[192:195], v[48:51], v[56:59]
    ds_read_b64_tr_b16 v[40:41], v12 offset:32768
    buffer_load_dwordx4 a[56:59], v4, s[24:27], s70 offen offset:0 sc1
    v_mfma_f32_16x16x32_bf16 v[56:59], a[204:207], v[52:55], v[56:59]
    ds_read_b64_tr_b16 v[42:43], v12 offset:33792
    s_waitcnt lgkmcnt(11)
    ds_read_b128 a[60:63], v133 offset:17408
    v_mfma_f32_16x16x32_bf16 v[60:63], a[196:199], v[48:51], v[60:63]
    ds_read_b64_tr_b16 v[44:45], v13 offset:32768
    buffer_load_dwordx4 a[64:67], v4, s[24:27], s70 offen offset:1024 sc1
    v_mfma_f32_16x16x32_bf16 v[60:63], a[208:211], v[52:55], v[60:63]
    ds_read_b64_tr_b16 v[46:47], v13 offset:33792
    ds_read_b128 a[68:71], v133 offset:24576
    v_mfma_f32_16x16x32_bf16 v[64:67], a[200:203], v[48:51], v[64:67]
    buffer_load_dwordx4 v[124:127], v4, s[24:27], s87 offen offset:2048 sc1
    s_waitcnt lgkmcnt(11)
    ds_read_b128 a[72:75], v133 offset:25600
    v_add_u32 v133, 0x14000, v133
    v_mfma_f32_16x16x32_bf16 v[64:67], a[212:215], v[52:55], v[64:67]
    ds_read_b128 a[76:79], v133 offset:0
    ds_read_b128 a[80:83], v133 offset:1024
    v_mfma_f32_16x16x32_bf16 a[240:243], v[48:51], v[48:51], a[240:243]
    buffer_load_dwordx4 a[84:87], v4, s[24:27], s87 offen offset:3072 sc1
    v_mfma_f32_16x16x32_bf16 v[56:59], a[216:219], v[24:27], v[56:59]
    ds_read_b64_tr_b16 v[48:49], v14 offset:32768
    s_lshl_b32 s52, s32, 8
    v_mfma_f32_16x16x32_bf16 v[56:59], a[228:231], v[28:31], v[56:59]
    s_waitcnt lgkmcnt(11)
    ds_read_b64_tr_b16 v[50:51], v14 offset:33792
    v_mfma_f32_16x16x32_bf16 v[60:63], a[220:223], v[24:27], v[60:63]
    ds_read_b64_tr_b16 v[52:53], v15 offset:32768
    s_add_u32 s52, s52, 161792
    v_mfma_f32_16x16x32_bf16 v[60:63], a[232:235], v[28:31], v[60:63]
    ds_read_b64_tr_b16 v[54:55], v15 offset:33792
    v_lshl_add_u32 v5, v2, 4, s52
    v_mfma_f32_16x16x32_bf16 v[64:67], a[224:227], v[24:27], v[64:67]
    buffer_load_dwordx4 a[88:91], v4, s[24:27], s70 offen offset:2048 sc1
    v_mfma_f32_16x16x32_bf16 v[64:67], a[236:239], v[28:31], v[64:67]
    s_waitcnt lgkmcnt(13)
    v_mfma_f32_16x16x32_bf16 v[68:71], a[168:171], v[32:35], v[68:71]
    s_mov_b64 exec, s[66:67]
    ds_write_b128 v5, a[240:243]
    s_mov_b64 exec, -1
    v_mfma_f32_16x16x32_bf16 v[68:71], a[180:183], v[36:39], v[68:71]
    buffer_load_dwordx4 a[92:95], v4, s[24:27], s70 offen offset:3072 sc1
    v_max_f32 v56, 0, v56
    v_mfma_f32_16x16x32_bf16 v[72:75], a[172:175], v[32:35], v[72:75]
    v_max_f32 v57, 0, v57
    v_mul_f32 v56, v56, v60
    v_mfma_f32_16x16x32_bf16 v[72:75], a[184:187], v[36:39], v[72:75]
    v_mul_f32 v57, v57, v61
    v_cvt_pk_bf16_f32 v56, v56, v57
    v_mfma_f32_16x16x32_bf16 v[76:79], a[176:179], v[32:35], v[76:79]
    s_add_u32 s69, s87, 4096
    v_max_f32 v58, 0, v58
    v_mfma_f32_16x16x32_bf16 v[76:79], a[188:191], v[36:39], v[76:79]
    buffer_load_dwordx4 a[96:99], v4, s[24:27], s69 offen offset:0 sc1
    s_waitcnt lgkmcnt(9)
    v_mfma_f32_16x16x32_bf16 v[68:71], a[192:195], v[40:43], v[68:71]
    buffer_atomic_add v20, v19, s[24:27], s90 offen sc1
    v_max_f32 v59, 0, v59
    v_mfma_f32_16x16x32_bf16 v[68:71], a[204:207], v[44:47], v[68:71]
    v_mul_f32 v58, v58, v62
    v_mul_f32 v59, v59, v63
    v_mfma_f32_16x16x32_bf16 v[72:75], a[196:199], v[40:43], v[72:75]
    v_cvt_pk_bf16_f32 v58, v58, v59
    v_permlane32_swap_b32 v64, v66
    v_mfma_f32_16x16x32_bf16 v[72:75], a[208:211], v[44:47], v[72:75]
    buffer_load_dwordx4 a[100:103], v4, s[24:27], s69 offen offset:1024 sc1
    v_permlane32_swap_b32 v65, v67
    v_mfma_f32_16x16x32_bf16 v[76:79], a[200:203], v[40:43], v[76:79]
    v_max_f32 v64, 0, v64
    v_max_f32 v65, 0, v65
    v_mfma_f32_16x16x32_bf16 v[76:79], a[212:215], v[44:47], v[76:79]
    v_mul_f32 v64, v64, v66
    s_waitcnt lgkmcnt(1)
    v_mfma_f32_16x16x32_bf16 v[68:71], a[216:219], v[48:51], v[68:71]
    v_mul_f32 v65, v65, v67
    v_cvt_pk_bf16_f32 v60, v64, v65
    v_mfma_f32_16x16x32_bf16 v[68:71], a[228:231], v[52:55], v[68:71]
    s_add_u32 s70, s87, 102400
    v_mfma_f32_16x16x32_bf16 v[72:75], a[220:223], v[48:51], v[72:75]
    buffer_load_dwordx4 a[104:107], v4, s[24:27], s70 offen offset:0 sc1
    v_mfma_f32_16x16x32_bf16 v[72:75], a[232:235], v[52:55], v[72:75]
    v_mfma_f32_16x16x32_bf16 v[76:79], a[224:227], v[48:51], v[76:79]
    v_mfma_f32_16x16x32_bf16 v[76:79], a[236:239], v[52:55], v[76:79]
    s_nop 1
    v_max_f32 v68, 0, v68
    v_max_f32 v69, 0, v69
    s_nop 1
    v_mul_f32 v68, v68, v72
    v_mul_f32 v69, v69, v73
    v_cvt_pk_bf16_f32 v57, v68, v69
    v_max_f32 v70, 0, v70
    v_max_f32 v71, 0, v71
    v_mul_f32 v70, v70, v74
    v_mul_f32 v71, v71, v75
    v_cvt_pk_bf16_f32 v59, v70, v71
    v_permlane32_swap_b32 v76, v78
    v_permlane32_swap_b32 v77, v79
    v_permlane32_swap_b32 v56, v58
    v_permlane32_swap_b32 v57, v59
    s_nop 1
    v_permlane16_swap_b32 v56, v57
    v_permlane16_swap_b32 v58, v59
    buffer_store_dwordx4 v[56:59], v17, s[24:27], s79 offen offset:0 sc1
    v_max_f32 v76, 0, v76
    v_max_f32 v77, 0, v77
    v_mul_f32 v76, v76, v78
    v_mul_f32 v77, v77, v79
    v_cvt_pk_bf16_f32 v61, v76, v77
    v_permlane32_swap_b32 v60, v62
    s_nop 0
    v_permlane32_swap_b32 v61, v63
    s_nop 1
    v_permlane16_swap_b32 v60, v61
    v_permlane16_swap_b32 v62, v63
    s_mov_b32 exec_hi, 0
    buffer_store_dwordx4 v[60:63], v17, s[24:27], s79 offen offset:512 sc1
    s_mov_b32 exec_hi, -1
    v_mov_b32 v20, 32768
    s_waitcnt vmcnt(13)
    v_mfma_f32_16x16x32_bf16 a[192:195], v[152:155], a[44:47], 0
    buffer_load_dwordx4 a[108:111], v4, s[24:27], s70 offen offset:1024 sc1
    s_mul_i32 s50, s32, 5120
    s_waitcnt vmcnt(13)
    v_mfma_f32_16x16x32_bf16 a[192:195], v[172:175], a[52:55], a[192:195]
    v_add_u32 v8, s50, v4
    s_lshl_b32 s50, s32, 8
    v_mfma_f32_16x16x32_bf16 a[196:199], v[156:159], a[44:47], 0
    v_lshl_add_u32 v10, v2, 4, s50
    v_lshl_add_u32 v9, v3, 10, v10
    v_mfma_f32_16x16x32_bf16 a[196:199], v[176:179], a[52:55], a[196:199]
    buffer_load_dwordx4 a[112:115], v4, s[24:27], s69 offen offset:2048 sc1
    v_mul_u32_u24 v7, 20480, v3
    v_mfma_f32_16x16x32_bf16 a[200:203], v[160:163], a[44:47], 0
    v_add_u32 v10, v10, v7
    v_and_b32 v7, 3, v2
    v_mfma_f32_16x16x32_bf16 a[200:203], v[180:183], a[52:55], a[200:203]
    v_lshl_add_u32 v7, v2, 2, v7
    v_lshlrev_b32 v7, 2, v7
    v_mfma_f32_16x16x32_bf16 a[204:207], v[164:167], a[44:47], 0
    v_add_u32 v11, 158720, v7
    v_lshl_add_u32 v12, v3, 10, v11
    v_mfma_f32_16x16x32_bf16 a[204:207], v[184:187], a[52:55], a[204:207]
    s_mov_b32 s51, 0x3acccccd
    v_mov_b32 v7, 0x3727c5ac
    v_mfma_f32_16x16x32_bf16 a[208:211], v[168:171], a[44:47], 0
    buffer_load_dwordx4 a[116:119], v4, s[24:27], s69 offen offset:3072 sc1
    v_mfma_f32_16x16x32_bf16 a[208:211], v[188:191], a[52:55], a[208:211]
    s_waitcnt vmcnt(14)
    v_mfma_f32_16x16x32_bf16 a[212:215], v[152:155], a[56:59], 0
    s_waitcnt vmcnt(13)
    v_mfma_f32_16x16x32_bf16 a[212:215], v[172:175], a[64:67], a[212:215]
    v_mfma_f32_16x16x32_bf16 a[216:219], v[156:159], a[56:59], 0
    buffer_load_dwordx4 a[120:123], v4, s[24:27], s70 offen offset:2048 sc1
    v_mfma_f32_16x16x32_bf16 a[216:219], v[176:179], a[64:67], a[216:219]
    v_mfma_f32_16x16x32_bf16 a[220:223], v[160:163], a[56:59], 0
    v_mfma_f32_16x16x32_bf16 a[220:223], v[180:183], a[64:67], a[220:223]
    v_mfma_f32_16x16x32_bf16 a[224:227], v[164:167], a[56:59], 0
    v_mfma_f32_16x16x32_bf16 a[224:227], v[184:187], a[64:67], a[224:227]
    buffer_load_dwordx4 a[124:127], v4, s[24:27], s70 offen offset:3072 sc1
    v_mfma_f32_16x16x32_bf16 a[228:231], v[168:171], a[56:59], 0
    v_mfma_f32_16x16x32_bf16 a[228:231], v[188:191], a[64:67], a[228:231]
    s_waitcnt vmcnt(14)
    v_mfma_f32_16x16x32_bf16 a[192:195], a[24:27], v[124:127], a[192:195]
    s_waitcnt lgkmcnt(0)
    s_barrier
    s_waitcnt vmcnt(13)
    v_mfma_f32_16x16x32_bf16 a[192:195], a[60:63], a[84:87], a[192:195]
    s_add_u32 s69, s87, 8192
    ds_read2st64_b32 v[24:25], v11 offset0:0 offset1:1
    v_mfma_f32_16x16x32_bf16 a[196:199], a[28:31], v[124:127], a[196:199]
    buffer_load_dwordx4 a[128:131], v4, s[24:27], s69 offen offset:0 sc1
    ds_read2st64_b32 v[26:27], v11 offset0:2 offset1:3
    v_mfma_f32_16x16x32_bf16 a[196:199], a[68:71], a[84:87], a[196:199]
    ds_read2st64_b32 v[28:29], v11 offset0:4 offset1:5
    ds_read2st64_b32 v[30:31], v11 offset0:6 offset1:7
    v_mfma_f32_16x16x32_bf16 a[200:203], a[36:39], v[124:127], a[200:203]
    ds_read2st64_b32 v[32:33], v11 offset0:8 offset1:9
    ds_read2st64_b32 v[34:35], v11 offset0:10 offset1:11
    v_mfma_f32_16x16x32_bf16 a[200:203], a[72:75], a[84:87], a[200:203]
    buffer_load_dwordx4 a[132:135], v4, s[24:27], s69 offen offset:1024 sc1
    ds_read2st64_b32 v[36:37], v11 offset0:12 offset1:13
    v_mfma_f32_16x16x32_bf16 a[204:207], a[40:43], v[124:127], a[204:207]
    ds_read2st64_b32 v[38:39], v11 offset0:14 offset1:15
    ds_read2st64_b32 v[40:41], v12 offset0:0 offset1:1
    v_mfma_f32_16x16x32_bf16 a[204:207], a[76:79], a[84:87], a[204:207]
    ds_read2st64_b32 v[42:43], v12 offset0:2 offset1:3
    v_mfma_f32_16x16x32_bf16 a[208:211], a[48:51], v[124:127], a[208:211]
    s_add_u32 s70, s87, 106496
    v_mfma_f32_16x16x32_bf16 a[208:211], a[80:83], a[84:87], a[208:211]
    buffer_load_dwordx4 a[136:139], v4, s[24:27], s70 offen offset:0 sc1
    s_waitcnt vmcnt(15)
    v_mfma_f32_16x16x32_bf16 a[212:215], a[24:27], a[88:91], a[212:215]
    v_mov_b32 v18, 0
    s_waitcnt vmcnt(14)
    v_mfma_f32_16x16x32_bf16 a[212:215], a[60:63], a[92:95], a[212:215]
    buffer_atomic_add v18, v19, s[24:27], s91 offen sc0 sc1
    v_mfma_f32_16x16x32_bf16 a[216:219], a[28:31], a[88:91], a[216:219]
    s_waitcnt vmcnt(9)
    buffer_atomic_add v20, v19, s[24:27], s90 offen sc1
    v_mfma_f32_16x16x32_bf16 a[216:219], a[68:71], a[92:95], a[216:219]
    buffer_load_dwordx4 a[140:143], v4, s[24:27], s70 offen offset:1024 sc1
    s_waitcnt lgkmcnt(0)
    v_mfma_f32_16x16x32_bf16 a[220:223], a[36:39], a[88:91], a[220:223]
    v_add_f32 v24, v24, v25
    v_add_f32 v26, v26, v27
    v_mfma_f32_16x16x32_bf16 a[220:223], a[72:75], a[92:95], a[220:223]
    v_add_f32 v24, v24, v26
    v_fma_f32 v24, v24, s51, v7
    v_mfma_f32_16x16x32_bf16 a[224:227], a[40:43], a[88:91], a[224:227]
    v_rcp_f32 v128, v24
    v_add_f32 v28, v28, v29
    v_mfma_f32_16x16x32_bf16 a[224:227], a[76:79], a[92:95], a[224:227]
    v_add_f32 v30, v30, v31
    v_add_f32 v28, v28, v30
    v_mfma_f32_16x16x32_bf16 a[228:231], a[48:51], a[88:91], a[228:231]
    buffer_load_dwordx4 a[144:147], v4, s[24:27], s69 offen offset:2048 sc1
    v_fma_f32 v28, v28, s51, v7
    v_mfma_f32_16x16x32_bf16 a[228:231], a[80:83], a[92:95], a[228:231]
    v_rcp_f32 v129, v28
    v_add_f32 v32, v32, v33
    v_mfma_f32_16x16x32_bf16 a[192:195], v[192:195], a[96:99], a[192:195]
    v_add_f32 v34, v34, v35
    v_add_f32 v32, v32, v34
    v_mfma_f32_16x16x32_bf16 a[192:195], v[212:215], a[100:103], a[192:195]
    v_fma_f32 v32, v32, s51, v7
    v_rcp_f32 v130, v32
    v_mfma_f32_16x16x32_bf16 a[196:199], v[196:199], a[96:99], a[196:199]
    buffer_load_dwordx4 a[148:151], v4, s[24:27], s69 offen offset:3072 sc1
    v_add_f32 v36, v36, v37
    v_mfma_f32_16x16x32_bf16 a[196:199], v[216:219], a[100:103], a[196:199]
    v_add_f32 v38, v38, v39
    v_add_f32 v36, v36, v38
    v_mfma_f32_16x16x32_bf16 a[200:203], v[200:203], a[96:99], a[200:203]
    v_fma_f32 v36, v36, s51, v7
    v_rcp_f32 v131, v36
    v_mfma_f32_16x16x32_bf16 a[200:203], v[220:223], a[100:103], a[200:203]
    s_branch L_pgx7
L_pg7:
    s_setpc_b64 s[40:41]
L_pgx7:
    v_add_f32 v40, v40, v41
    v_add_f32 v42, v42, v43
    v_mfma_f32_16x16x32_bf16 a[204:207], v[204:207], a[96:99], a[204:207]
    v_add_f32 v40, v40, v42
    v_fma_f32 v40, v40, s51, v7
    v_mfma_f32_16x16x32_bf16 a[204:207], v[224:227], a[100:103], a[204:207]
    buffer_load_dwordx4 a[152:155], v4, s[24:27], s73 offen offset:3072 sc1
    v_rcp_f32 v132, v40
    v_mfma_f32_16x16x32_bf16 a[208:211], v[208:211], a[96:99], a[208:211]
    v_cmp_gt_u32 vcc, 32, v1
    s_nop 1
    v_cndmask_b32 v142, v142, v144, vcc
    v_cndmask_b32 v143, v143, v145, vcc
    v_mfma_f32_16x16x32_bf16 a[208:211], v[228:231], a[100:103], a[208:211]
    v_lshlrev_b32 v104, 16, v134
    v_and_b32 v105, 0xffff0000, v134
    v_mfma_f32_16x16x32_bf16 a[212:215], v[192:195], a[104:107], a[212:215]
    s_add_u32 s73, s88, 53248
    v_lshlrev_b32 v106, 16, v135
    s_waitcnt vmcnt(13)
    v_mfma_f32_16x16x32_bf16 a[212:215], v[212:215], a[108:111], a[212:215]
    buffer_load_dwordx4 a[156:159], v4, s[24:27], s73 offen offset:0 sc1
    v_and_b32 v107, 0xffff0000, v135
    v_mfma_f32_16x16x32_bf16 a[216:219], v[196:199], a[104:107], a[216:219]
    v_lshlrev_b32 v108, 16, v136
    v_and_b32 v109, 0xffff0000, v136
    v_mfma_f32_16x16x32_bf16 a[216:219], v[216:219], a[108:111], a[216:219]
    v_lshlrev_b32 v110, 16, v137
    v_and_b32 v111, 0xffff0000, v137
    v_mfma_f32_16x16x32_bf16 a[220:223], v[200:203], a[104:107], a[220:223]
    v_lshlrev_b32 v112, 16, v138
    v_and_b32 v113, 0xffff0000, v138
    v_mfma_f32_16x16x32_bf16 a[220:223], v[220:223], a[108:111], a[220:223]
    buffer_load_dwordx4 a[160:163], v4, s[24:27], s73 offen offset:1024 sc1
    v_lshlrev_b32 v114, 16, v139
    v_mfma_f32_16x16x32_bf16 a[224:227], v[204:207], a[104:107], a[224:227]
    v_and_b32 v115, 0xffff0000, v139
    v_lshlrev_b32 v116, 16, v140
    v_mfma_f32_16x16x32_bf16 a[224:227], v[224:227], a[108:111], a[224:227]
    buffer_load_dwordx4 a[164:167], v4, s[24:27], s73 offen offset:2048 sc1
    v_and_b32 v117, 0xffff0000, v140
    v_mfma_f32_16x16x32_bf16 a[228:231], v[208:211], a[104:107], a[228:231]
    v_lshlrev_b32 v118, 16, v141
    v_and_b32 v119, 0xffff0000, v141
    v_mfma_f32_16x16x32_bf16 a[228:231], v[228:231], a[108:111], a[228:231]
    buffer_load_dwordx4 a[240:243], v4, s[24:27], s73 offen offset:3072 sc1
    v_lshlrev_b32 v120, 16, v142
    s_waitcnt vmcnt(16)
    v_mfma_f32_16x16x32_bf16 a[192:195], v[232:235], a[112:115], a[192:195]
    s_waitcnt vmcnt(9)
    v_cmp_le_u32 vcc, 553648128, v18
    s_cbranch_vccz L_fw_64
L_fd_66:
    v_mfma_f32_16x16x32_bf16 a[192:195], a[248:251], a[116:119], a[192:195]
    s_add_u32 s73, s88, 57344
    v_and_b32 v121, 0xffff0000, v142
    v_mfma_f32_16x16x32_bf16 a[196:199], v[236:239], a[112:115], a[196:199]
    buffer_load_dwordx4 a[168:171], v4, s[24:27], s73 offen offset:0 sc1
    v_lshlrev_b32 v122, 16, v143
    v_mfma_f32_16x16x32_bf16 a[196:199], a[252:255], a[116:119], a[196:199]
    v_and_b32 v123, 0xffff0000, v143
    v_mfma_f32_16x16x32_bf16 a[200:203], v[240:243], a[112:115], a[200:203]
    buffer_load_dwordx4 a[172:175], v4, s[24:27], s73 offen offset:1024 sc1
    v_mfma_f32_16x16x32_bf16 a[200:203], v[80:83], a[116:119], a[200:203]
    v_mfma_f32_16x16x32_bf16 a[204:207], v[244:247], a[112:115], a[204:207]
    buffer_load_dwordx4 a[176:179], v4, s[24:27], s73 offen offset:2048 sc1
    v_mfma_f32_16x16x32_bf16 a[204:207], v[84:87], a[116:119], a[204:207]
    v_mfma_f32_16x16x32_bf16 a[208:211], v[248:251], a[112:115], a[208:211]
    buffer_load_dwordx4 a[180:183], v4, s[24:27], s73 offen offset:3072 sc1
    v_mfma_f32_16x16x32_bf16 a[208:211], v[88:91], a[116:119], a[208:211]
    v_mfma_f32_16x16x32_bf16 a[212:215], v[232:235], a[120:123], a[212:215]
    buffer_load_dwordx4 a[184:187], v4, s[24:27], s70 offen offset:2048 sc1
    v_mfma_f32_16x16x32_bf16 a[212:215], a[248:251], a[124:127], a[212:215]
    v_mfma_f32_16x16x32_bf16 a[216:219], v[236:239], a[120:123], a[216:219]
    buffer_load_dwordx4 a[188:191], v4, s[24:27], s70 offen offset:3072 sc1
    v_mfma_f32_16x16x32_bf16 a[216:219], a[252:255], a[124:127], a[216:219]
    s_add_u32 s71, s87, 196608
    v_mfma_f32_16x16x32_bf16 a[220:223], v[240:243], a[120:123], a[220:223]
    buffer_load_dwordx4 a[232:235], v4, s[24:27], s71 offen offset:0 sc1
    v_mfma_f32_16x16x32_bf16 a[220:223], v[80:83], a[124:127], a[220:223]
    v_mfma_f32_16x16x32_bf16 a[224:227], v[244:247], a[120:123], a[224:227]
    buffer_load_dwordx4 a[236:239], v4, s[24:27], s71 offen offset:1024 sc1
    v_mfma_f32_16x16x32_bf16 a[224:227], v[84:87], a[124:127], a[224:227]
    v_mfma_f32_16x16x32_bf16 a[228:231], v[248:251], a[120:123], a[228:231]
    v_mfma_f32_16x16x32_bf16 a[228:231], v[88:91], a[124:127], a[228:231]
    v_mfma_f32_16x16x32_bf16 a[192:195], v[92:95], a[128:131], a[192:195]
    v_mov_b32 v18, 0
    v_mfma_f32_16x16x32_bf16 a[192:195], a[4:7], a[132:135], a[192:195]
    buffer_load_dwordx4 a[44:47], v4, s[24:27], s71 offen offset:2048 sc1
    buffer_atomic_add v18, v19, s[24:27], s91 offen sc0 sc1
    v_mfma_f32_16x16x32_bf16 a[196:199], v[96:99], a[128:131], a[196:199]
    v_mfma_f32_16x16x32_bf16 a[196:199], a[8:11], a[132:135], a[196:199]
    v_mfma_f32_16x16x32_bf16 a[200:203], v[100:103], a[128:131], a[200:203]
    buffer_load_dwordx4 a[52:55], v4, s[24:27], s71 offen offset:3072 sc1
    v_mfma_f32_16x16x32_bf16 a[200:203], a[12:15], a[132:135], a[200:203]
    v_mfma_f32_16x16x32_bf16 a[204:207], a[244:247], a[128:131], a[204:207]
    v_mfma_f32_16x16x32_bf16 a[204:207], a[16:19], a[132:135], a[204:207]
    v_mfma_f32_16x16x32_bf16 a[208:211], a[0:3], a[128:131], a[208:211]
    s_add_u32 s71, s87, 200704
    v_mfma_f32_16x16x32_bf16 a[208:211], a[20:23], a[132:135], a[208:211]
    buffer_load_dwordx4 a[56:59], v4, s[24:27], s71 offen offset:0 sc1
    v_mfma_f32_16x16x32_bf16 a[212:215], v[92:95], a[136:139], a[212:215]
    s_waitcnt vmcnt(19)
    v_mfma_f32_16x16x32_bf16 a[212:215], a[4:7], a[140:143], a[212:215]
    v_mfma_f32_16x16x32_bf16 a[216:219], v[96:99], a[136:139], a[216:219]
    v_mfma_f32_16x16x32_bf16 a[216:219], a[8:11], a[140:143], a[216:219]
    v_mfma_f32_16x16x32_bf16 a[220:223], v[100:103], a[136:139], a[220:223]
    buffer_load_dwordx4 a[64:67], v4, s[24:27], s71 offen offset:1024 sc1
    v_mfma_f32_16x16x32_bf16 a[220:223], a[12:15], a[140:143], a[220:223]
    v_mfma_f32_16x16x32_bf16 a[224:227], a[244:247], a[136:139], a[224:227]
    v_mfma_f32_16x16x32_bf16 a[224:227], a[16:19], a[140:143], a[224:227]
    v_mfma_f32_16x16x32_bf16 a[228:231], a[0:3], a[136:139], a[228:231]
    buffer_load_dwordx4 v[124:127], v4, s[24:27], s71 offen offset:2048 sc1
    v_mfma_f32_16x16x32_bf16 a[228:231], a[20:23], a[140:143], a[228:231]
    s_waitcnt vmcnt(20)
    v_mfma_f32_16x16x32_bf16 a[192:195], a[32:35], a[144:147], a[192:195]
    s_waitcnt vmcnt(14)
    v_mfma_f32_16x16x32_bf16 a[192:195], a[240:243], a[148:151], a[192:195]
    v_mfma_f32_16x16x32_bf16 a[196:199], a[152:155], a[144:147], a[196:199]
    s_waitcnt vmcnt(13)
    v_mfma_f32_16x16x32_bf16 a[196:199], a[168:171], a[148:151], a[196:199]
    buffer_load_dwordx4 a[84:87], v4, s[24:27], s71 offen offset:3072 sc1
    v_mfma_f32_16x16x32_bf16 a[200:203], a[156:159], a[144:147], a[200:203]
    s_nop 2
    ds_write_b128 v8, a[192:195] offset:0
    s_waitcnt vmcnt(13)
    v_mfma_f32_16x16x32_bf16 a[200:203], a[172:175], a[148:151], a[200:203]
    s_add_u32 s71, s87, 204800
    v_mfma_f32_16x16x32_bf16 a[204:207], a[160:163], a[144:147], a[204:207]
    buffer_load_dwordx4 a[88:91], v4, s[24:27], s71 offen offset:0 sc1
    ds_write_b128 v8, a[196:199] offset:1024
    s_waitcnt vmcnt(13)
    v_mfma_f32_16x16x32_bf16 a[204:207], a[176:179], a[148:151], a[204:207]
    v_mfma_f32_16x16x32_bf16 a[208:211], a[164:167], a[144:147], a[208:211]
    buffer_load_dwordx4 a[92:95], v4, s[24:27], s71 offen offset:1024 sc1
    ds_write_b128 v8, a[200:203] offset:2048
    s_waitcnt vmcnt(13)
    v_mfma_f32_16x16x32_bf16 a[208:211], a[180:183], a[148:151], a[208:211]
    s_waitcnt vmcnt(12)
    v_mfma_f32_16x16x32_bf16 a[212:215], a[32:35], a[184:187], a[212:215]
    s_nop 0
    ds_write_b128 v8, a[204:207] offset:3072
    s_waitcnt vmcnt(11)
    v_mfma_f32_16x16x32_bf16 a[212:215], a[240:243], a[188:191], a[212:215]
    buffer_load_dwordx4 a[96:99], v4, s[24:27], s71 offen offset:2048 sc1
    v_mfma_f32_16x16x32_bf16 a[216:219], a[152:155], a[184:187], a[216:219]
    ds_write_b128 v8, a[208:211] offset:4096
    v_mfma_f32_16x16x32_bf16 a[216:219], a[168:171], a[188:191], a[216:219]
    buffer_load_dwordx4 a[100:103], v4, s[24:27], s71 offen offset:3072 sc1
    v_mfma_f32_16x16x32_bf16 a[220:223], a[156:159], a[184:187], a[220:223]
    s_nop 1
    ds_write_b128 v8, a[212:215] offset:20480
    v_mfma_f32_16x16x32_bf16 a[220:223], a[172:175], a[188:191], a[220:223]
    v_mfma_f32_16x16x32_bf16 a[224:227], a[160:163], a[184:187], a[224:227]
    s_nop 0
    ds_write_b128 v8, a[216:219] offset:21504
    v_mfma_f32_16x16x32_bf16 a[224:227], a[176:179], a[188:191], a[224:227]
    v_mfma_f32_16x16x32_bf16 a[228:231], a[164:167], a[184:187], a[228:231]
    s_nop 2
    ds_write_b128 v8, a[220:223] offset:22528
    v_mfma_f32_16x16x32_bf16 a[228:231], a[180:183], a[188:191], a[228:231]
    s_waitcnt vmcnt(12)
    v_mfma_f32_16x16x32_bf16 v[56:59], v[152:155], a[232:235], 0
    ds_write_b128 v8, a[224:227] offset:23552
    s_waitcnt vmcnt(11)
    v_mfma_f32_16x16x32_bf16 v[56:59], v[172:175], a[236:239], v[56:59]
    v_mfma_f32_16x16x32_bf16 v[60:63], v[156:159], a[232:235], 0
    s_nop 1
    ds_write_b128 v8, a[228:231] offset:24576
    v_mfma_f32_16x16x32_bf16 v[60:63], v[176:179], a[236:239], v[60:63]
    v_mfma_f32_16x16x32_bf16 v[64:67], v[160:163], a[232:235], 0
    v_mfma_f32_16x16x32_bf16 v[64:67], v[180:183], a[236:239], v[64:67]
    v_mfma_f32_16x16x32_bf16 v[68:71], v[164:167], a[232:235], 0
    v_mfma_f32_16x16x32_bf16 v[68:71], v[184:187], a[236:239], v[68:71]
    v_mfma_f32_16x16x32_bf16 v[72:75], v[168:171], a[232:235], 0
    v_mfma_f32_16x16x32_bf16 v[72:75], v[188:191], a[236:239], v[72:75]
    s_waitcnt vmcnt(10)
    v_mfma_f32_16x16x32_bf16 v[56:59], a[24:27], a[44:47], v[56:59]
    s_waitcnt vmcnt(9)
    v_cmp_le_u32 vcc, 554172416, v18
    s_cbranch_vccz L_fw_67
L_fd_69:
    s_waitcnt vmcnt(8)
    v_mfma_f32_16x16x32_bf16 v[56:59], a[60:63], a[52:55], v[56:59]
    s_add_u32 s72, s87, 294912
    v_mfma_f32_16x16x32_bf16 v[60:63], a[28:31], a[44:47], v[60:63]
    buffer_load_dwordx4 a[104:107], v4, s[24:27], s72 offen offset:0 sc1
    v_mfma_f32_16x16x32_bf16 v[60:63], a[68:71], a[52:55], v[60:63]
    buffer_load_dwordx4 a[108:111], v4, s[24:27], s72 offen offset:1024 sc1
    v_mfma_f32_16x16x32_bf16 v[64:67], a[36:39], a[44:47], v[64:67]
    v_mfma_f32_16x16x32_bf16 v[64:67], a[72:75], a[52:55], v[64:67]
    v_mfma_f32_16x16x32_bf16 v[68:71], a[40:43], a[44:47], v[68:71]
    v_mfma_f32_16x16x32_bf16 v[68:71], a[76:79], a[52:55], v[68:71]
    buffer_load_dwordx4 a[112:115], v4, s[24:27], s72 offen offset:2048 sc1
    v_mfma_f32_16x16x32_bf16 v[72:75], a[48:51], a[44:47], v[72:75]
    v_mfma_f32_16x16x32_bf16 v[72:75], a[80:83], a[52:55], v[72:75]
    s_waitcnt vmcnt(10)
    v_mfma_f32_16x16x32_bf16 v[56:59], v[192:195], a[56:59], v[56:59]
    s_waitcnt lgkmcnt(0)
    s_barrier
    s_waitcnt vmcnt(9)
    v_mfma_f32_16x16x32_bf16 v[56:59], v[212:215], a[64:67], v[56:59]
    buffer_load_dwordx4 a[116:119], v4, s[24:27], s72 offen offset:3072 sc1
    ds_read_b128 v[24:27], v9 offset:0
    v_mfma_f32_16x16x32_bf16 v[60:63], v[196:199], a[56:59], v[60:63]
    ds_read_b128 v[28:31], v9 offset:5120
    ds_read_b128 v[32:35], v9 offset:10240
    v_mfma_f32_16x16x32_bf16 v[60:63], v[216:219], a[64:67], v[60:63]
    ds_read_b128 v[36:39], v9 offset:15360
    ds_read_b128 v[40:43], v9 offset:20480
    v_mfma_f32_16x16x32_bf16 v[64:67], v[200:203], a[56:59], v[64:67]
    s_add_u32 s72, s87, 299008
    ds_read_b128 v[44:47], v9 offset:25600
    v_mfma_f32_16x16x32_bf16 v[64:67], v[220:223], a[64:67], v[64:67]
    buffer_load_dwordx4 a[120:123], v4, s[24:27], s72 offen offset:0 sc1
    ds_read_b128 v[48:51], v9 offset:30720
    v_mfma_f32_16x16x32_bf16 v[68:71], v[204:207], a[56:59], v[68:71]
    ds_read_b128 v[52:55], v9 offset:35840
    v_mfma_f32_16x16x32_bf16 v[68:71], v[224:227], a[64:67], v[68:71]
    v_mfma_f32_16x16x32_bf16 v[72:75], v[208:211], a[56:59], v[72:75]
    v_mfma_f32_16x16x32_bf16 v[72:75], v[228:231], a[64:67], v[72:75]
    buffer_load_dwordx4 a[124:127], v4, s[24:27], s72 offen offset:1024 sc1
    s_waitcnt vmcnt(11)
    v_mfma_f32_16x16x32_bf16 v[56:59], v[232:235], v[124:127], v[56:59]
    s_waitcnt vmcnt(10)
    v_mfma_f32_16x16x32_bf16 v[56:59], a[248:251], a[84:87], v[56:59]
    v_mfma_f32_16x16x32_bf16 v[60:63], v[236:239], v[124:127], v[60:63]
    s_waitcnt lgkmcnt(0)
    v_add_f32 v24, v24, v28
    v_mfma_f32_16x16x32_bf16 v[60:63], a[252:255], a[84:87], v[60:63]
    v_add_f32 v25, v25, v29
    v_add_f32 v26, v26, v30
    v_mfma_f32_16x16x32_bf16 v[64:67], v[240:243], v[124:127], v[64:67]
    buffer_load_dwordx4 a[128:131], v4, s[24:27], s72 offen offset:2048 sc1
    v_add_f32 v27, v27, v31
    v_mfma_f32_16x16x32_bf16 v[64:67], v[80:83], a[84:87], v[64:67]
    v_add_f32 v32, v32, v36
    v_add_f32 v33, v33, v37
    v_mfma_f32_16x16x32_bf16 v[68:71], v[244:247], v[124:127], v[68:71]
    v_add_f32 v34, v34, v38
    v_add_f32 v35, v35, v39
    v_mfma_f32_16x16x32_bf16 v[68:71], v[84:87], a[84:87], v[68:71]
    v_add_f32 v24, v24, v32
    v_add_f32 v25, v25, v33
    v_mfma_f32_16x16x32_bf16 v[72:75], v[248:251], v[124:127], v[72:75]
    v_add_f32 v26, v26, v34
    v_add_f32 v27, v27, v35
    v_mfma_f32_16x16x32_bf16 v[72:75], v[88:91], a[84:87], v[72:75]
    buffer_load_dwordx4 a[132:135], v4, s[24:27], s72 offen offset:3072 sc1
    v_fmac_f32 v104, v24, v128
    s_waitcnt vmcnt(11)
    v_mfma_f32_16x16x32_bf16 v[56:59], v[92:95], a[88:91], v[56:59]
    v_fmac_f32 v105, v25, v128
    v_fmac_f32 v106, v26, v128
    s_waitcnt vmcnt(10)
    v_mfma_f32_16x16x32_bf16 v[56:59], a[4:7], a[92:95], v[56:59]
    v_fmac_f32 v107, v27, v128
    v_cvt_pk_bf16_f32 v134, v104, v105
    v_mfma_f32_16x16x32_bf16 v[60:63], v[96:99], a[88:91], v[60:63]
    s_add_u32 s72, s87, 303104
    v_cvt_pk_bf16_f32 v135, v106, v107
    v_mfma_f32_16x16x32_bf16 v[60:63], a[8:11], a[92:95], v[60:63]
    buffer_load_dwordx4 a[136:139], v4, s[24:27], s72 offen offset:0 sc1
    v_add_f32 v40, v40, v44
    v_mfma_f32_16x16x32_bf16 v[64:67], v[100:103], a[88:91], v[64:67]
    v_add_f32 v41, v41, v45
    v_add_f32 v42, v42, v46
    v_mfma_f32_16x16x32_bf16 v[64:67], a[12:15], a[92:95], v[64:67]
    v_add_f32 v43, v43, v47
    v_add_f32 v48, v48, v52
    v_mfma_f32_16x16x32_bf16 v[68:71], a[244:247], a[88:91], v[68:71]
    v_add_f32 v49, v49, v53
    v_add_f32 v50, v50, v54
    v_mfma_f32_16x16x32_bf16 v[68:71], a[16:19], a[92:95], v[68:71]
    buffer_load_dwordx4 a[140:143], v4, s[24:27], s72 offen offset:1024 sc1
    v_add_f32 v51, v51, v55
    v_mfma_f32_16x16x32_bf16 v[72:75], a[0:3], a[88:91], v[72:75]
    v_add_f32 v40, v40, v48
    v_add_f32 v41, v41, v49
    v_mfma_f32_16x16x32_bf16 v[72:75], a[20:23], a[92:95], v[72:75]
    v_add_f32 v42, v42, v50
    v_add_f32 v43, v43, v51
    s_waitcnt vmcnt(11)
    v_mfma_f32_16x16x32_bf16 v[56:59], a[32:35], a[96:99], v[56:59]
    v_fmac_f32 v108, v40, v129
    v_fmac_f32 v109, v41, v129
    s_waitcnt vmcnt(10)
    v_mfma_f32_16x16x32_bf16 v[56:59], a[240:243], a[100:103], v[56:59]
    buffer_load_dwordx4 a[144:147], v4, s[24:27], s72 offen offset:2048 sc1
    v_fmac_f32 v110, v42, v129
    v_mfma_f32_16x16x32_bf16 v[60:63], a[152:155], a[96:99], v[60:63]
    v_fmac_f32 v111, v43, v129
    v_cvt_pk_bf16_f32 v136, v108, v109
    v_mfma_f32_16x16x32_bf16 v[60:63], a[168:171], a[100:103], v[60:63]
    v_cvt_pk_bf16_f32 v137, v110, v111
    v_cndmask_b32 v105, v105, 0, s[64:65]
    v_mfma_f32_16x16x32_bf16 v[64:67], a[156:159], a[96:99], v[64:67]
    ds_write_b128 v8, v[56:59] offset:40960
    v_mul_f32 v146, v104, v104
    v_mfma_f32_16x16x32_bf16 v[64:67], a[172:175], a[100:103], v[64:67]
    buffer_load_dwordx4 a[148:151], v4, s[24:27], s72 offen offset:3072 sc1
    v_fmac_f32 v146, v106, v106
    v_mfma_f32_16x16x32_bf16 v[68:71], a[160:163], a[96:99], v[68:71]
    ds_write_b128 v8, v[60:63] offset:41984
    v_fmac_f32 v146, v107, v107
    v_mfma_f32_16x16x32_bf16 v[68:71], a[176:179], a[100:103], v[68:71]
    v_fmac_f32 v146, v105, v105
    v_cndmask_b32 v109, v109, 0, s[64:65]
    v_mfma_f32_16x16x32_bf16 v[72:75], a[164:167], a[96:99], v[72:75]
    ds_write_b128 v8, v[64:67] offset:43008
    v_mul_f32 v147, v108, v108
    v_mfma_f32_16x16x32_bf16 v[72:75], a[180:183], a[100:103], v[72:75]
    v_fmac_f32 v147, v110, v110
    v_fmac_f32 v147, v111, v111
    s_waitcnt vmcnt(11)
    v_mfma_f32_16x16x32_bf16 a[192:195], v[152:155], a[104:107], 0
    ds_write_b128 v8, v[68:71] offset:44032
    v_fmac_f32 v147, v109, v109
    s_waitcnt vmcnt(10)
    v_mfma_f32_16x16x32_bf16 a[192:195], v[172:175], a[108:111], a[192:195]
    buffer_store_dword v134, v22, s[24:27], s92 offen offset:0 sc1
    v_mfma_f32_16x16x32_bf16 a[196:199], v[156:159], a[104:107], 0
    ds_write_b128 v8, v[72:75] offset:45056
    v_mfma_f32_16x16x32_bf16 a[196:199], v[176:179], a[108:111], a[196:199]
    s_add_u32 s75, s92, 8192
    buffer_store_dword v135, v22, s[24:27], s75 offen offset:128 sc1
    v_mfma_f32_16x16x32_bf16 a[200:203], v[160:163], a[104:107], 0
    buffer_store_dword v136, v22, s[24:27], s92 offen offset:128 sc1
    v_mfma_f32_16x16x32_bf16 a[200:203], v[180:183], a[108:111], a[200:203]
    buffer_store_dword v137, v22, s[24:27], s75 offen offset:256 sc1
    v_mfma_f32_16x16x32_bf16 a[204:207], v[164:167], a[104:107], 0
    v_mfma_f32_16x16x32_bf16 a[204:207], v[184:187], a[108:111], a[204:207]
    v_mfma_f32_16x16x32_bf16 a[208:211], v[168:171], a[104:107], 0
    v_mfma_f32_16x16x32_bf16 a[208:211], v[188:191], a[108:111], a[208:211]
    s_waitcnt vmcnt(13)
    v_mfma_f32_16x16x32_bf16 a[192:195], a[24:27], a[112:115], a[192:195]
    s_waitcnt lgkmcnt(0)
    s_barrier
    s_waitcnt vmcnt(12)
    v_mfma_f32_16x16x32_bf16 a[192:195], a[60:63], a[116:119], a[192:195]
    ds_read_b128 v[24:27], v9 offset:40960
    ds_read_b128 v[28:31], v9 offset:46080
    v_mfma_f32_16x16x32_bf16 a[196:199], a[28:31], a[112:115], a[196:199]
    ds_read_b128 v[32:35], v9 offset:51200
    ds_read_b128 v[36:39], v9 offset:56320
    v_mfma_f32_16x16x32_bf16 a[196:199], a[68:71], a[116:119], a[196:199]
    v_mfma_f32_16x16x32_bf16 a[200:203], a[36:39], a[112:115], a[200:203]
    v_mfma_f32_16x16x32_bf16 a[200:203], a[72:75], a[116:119], a[200:203]
    v_mfma_f32_16x16x32_bf16 a[204:207], a[40:43], a[112:115], a[204:207]
    v_mfma_f32_16x16x32_bf16 a[204:207], a[76:79], a[116:119], a[204:207]
    v_mfma_f32_16x16x32_bf16 a[208:211], a[48:51], a[112:115], a[208:211]
    s_waitcnt lgkmcnt(0)
    v_add_f32 v24, v24, v28
    v_mfma_f32_16x16x32_bf16 a[208:211], a[80:83], a[116:119], a[208:211]
    v_add_f32 v25, v25, v29
    v_add_f32 v26, v26, v30
    s_waitcnt vmcnt(11)
    v_mfma_f32_16x16x32_bf16 a[192:195], v[192:195], a[120:123], a[192:195]
    v_add_f32 v27, v27, v31
    v_add_f32 v32, v32, v36
    s_waitcnt vmcnt(10)
    v_mfma_f32_16x16x32_bf16 a[192:195], v[212:215], a[124:127], a[192:195]
    v_add_f32 v33, v33, v37
    v_add_f32 v34, v34, v38
    v_mfma_f32_16x16x32_bf16 a[196:199], v[196:199], a[120:123], a[196:199]
    v_add_f32 v35, v35, v39
    v_add_f32 v24, v24, v32
    v_mfma_f32_16x16x32_bf16 a[196:199], v[216:219], a[124:127], a[196:199]
    v_add_f32 v25, v25, v33
    v_add_f32 v26, v26, v34
    v_mfma_f32_16x16x32_bf16 a[200:203], v[200:203], a[120:123], a[200:203]
    v_add_f32 v27, v27, v35
    v_fmac_f32 v112, v24, v130
    v_mfma_f32_16x16x32_bf16 a[200:203], v[220:223], a[124:127], a[200:203]
    v_fmac_f32 v113, v25, v130
    v_fmac_f32 v114, v26, v130
    v_mfma_f32_16x16x32_bf16 a[204:207], v[204:207], a[120:123], a[204:207]
    v_fmac_f32 v115, v27, v130
    v_cvt_pk_bf16_f32 v138, v112, v113
    v_mfma_f32_16x16x32_bf16 a[204:207], v[224:227], a[124:127], a[204:207]
    v_cvt_pk_bf16_f32 v139, v114, v115
    v_mfma_f32_16x16x32_bf16 a[208:211], v[208:211], a[120:123], a[208:211]
    buffer_store_dword v138, v22, s[24:27], s92 offen offset:256 sc1
    v_mfma_f32_16x16x32_bf16 a[208:211], v[228:231], a[124:127], a[208:211]
    buffer_store_dword v139, v22, s[24:27], s75 offen offset:384 sc1
    v_cndmask_b32 v113, v113, 0, s[64:65]
    s_waitcnt vmcnt(11)
    v_mfma_f32_16x16x32_bf16 a[192:195], v[232:235], a[128:131], a[192:195]
    v_mul_f32 v148, v112, v112
    v_fmac_f32 v148, v114, v114
    s_waitcnt vmcnt(10)
    v_mfma_f32_16x16x32_bf16 a[192:195], a[248:251], a[132:135], a[192:195]
    v_fmac_f32 v148, v115, v115
    v_fmac_f32 v148, v113, v113
    v_mfma_f32_16x16x32_bf16 a[196:199], v[236:239], a[128:131], a[196:199]
    v_mfma_f32_16x16x32_bf16 a[196:199], a[252:255], a[132:135], a[196:199]
    v_mfma_f32_16x16x32_bf16 a[200:203], v[240:243], a[128:131], a[200:203]
    v_mfma_f32_16x16x32_bf16 a[200:203], v[80:83], a[132:135], a[200:203]
    v_mfma_f32_16x16x32_bf16 a[204:207], v[244:247], a[128:131], a[204:207]
    v_mfma_f32_16x16x32_bf16 a[204:207], v[84:87], a[132:135], a[204:207]
    v_mfma_f32_16x16x32_bf16 a[208:211], v[248:251], a[128:131], a[208:211]
    v_mfma_f32_16x16x32_bf16 a[208:211], v[88:91], a[132:135], a[208:211]
    s_waitcnt vmcnt(9)
    v_mfma_f32_16x16x32_bf16 a[192:195], v[92:95], a[136:139], a[192:195]
    s_waitcnt vmcnt(8)
    v_mfma_f32_16x16x32_bf16 a[192:195], a[4:7], a[140:143], a[192:195]
    v_mfma_f32_16x16x32_bf16 a[196:199], v[96:99], a[136:139], a[196:199]
    v_mfma_f32_16x16x32_bf16 a[196:199], a[8:11], a[140:143], a[196:199]
    v_mfma_f32_16x16x32_bf16 a[200:203], v[100:103], a[136:139], a[200:203]
    v_mfma_f32_16x16x32_bf16 a[200:203], a[12:15], a[140:143], a[200:203]
    v_mfma_f32_16x16x32_bf16 a[204:207], a[244:247], a[136:139], a[204:207]
    v_mfma_f32_16x16x32_bf16 a[204:207], a[16:19], a[140:143], a[204:207]
    v_mfma_f32_16x16x32_bf16 a[208:211], a[0:3], a[136:139], a[208:211]
    v_mfma_f32_16x16x32_bf16 a[208:211], a[20:23], a[140:143], a[208:211]
    s_waitcnt vmcnt(7)
    v_mfma_f32_16x16x32_bf16 a[192:195], a[32:35], a[144:147], a[192:195]
    s_waitcnt vmcnt(6)
    v_mfma_f32_16x16x32_bf16 a[192:195], a[240:243], a[148:151], a[192:195]
    v_mfma_f32_16x16x32_bf16 a[196:199], a[152:155], a[144:147], a[196:199]
    v_mfma_f32_16x16x32_bf16 a[196:199], a[168:171], a[148:151], a[196:199]
    v_mfma_f32_16x16x32_bf16 a[200:203], a[156:159], a[144:147], a[200:203]
    v_add_u32 v8, 0xf000, v8
    s_nop 3
    ds_write_b128 v8, a[192:195] offset:0
    v_mfma_f32_16x16x32_bf16 a[200:203], a[172:175], a[148:151], a[200:203]
    v_mfma_f32_16x16x32_bf16 a[204:207], a[160:163], a[144:147], a[204:207]
    ds_write_b128 v8, a[196:199] offset:1024
    v_mfma_f32_16x16x32_bf16 a[204:207], a[176:179], a[148:151], a[204:207]
    v_mfma_f32_16x16x32_bf16 a[208:211], a[164:167], a[144:147], a[208:211]
    s_nop 3
    ds_write_b128 v8, a[200:203] offset:2048
    v_mfma_f32_16x16x32_bf16 a[208:211], a[180:183], a[148:151], a[208:211]
    s_nop 0
    ds_write_b128 v8, a[204:207] offset:3072
    s_nop 5
    ds_write_b128 v8, a[208:211] offset:4096
    s_waitcnt lgkmcnt(0)
    s_barrier
    v_add_u32 v9, 0xf000, v9
    ds_read_b128 v[40:43], v9 offset:0
    ds_read_b128 v[44:47], v9 offset:5120
    ds_read_b128 v[48:51], v9 offset:10240
    ds_read_b128 v[52:55], v9 offset:15360
    ds_read_b128 v[24:27], v10 offset:4096
    ds_read_b128 v[28:31], v10 offset:9216
    ds_read_b128 v[32:35], v10 offset:14336
    ds_read_b128 v[36:39], v10 offset:19456
    s_waitcnt lgkmcnt(4)
    v_pk_add_f32 v[40:41], v[40:41], v[44:45]
    v_pk_add_f32 v[42:43], v[42:43], v[46:47]
    v_pk_add_f32 v[48:49], v[48:49], v[52:53]
    v_pk_add_f32 v[50:51], v[50:51], v[54:55]
    v_pk_add_f32 v[40:41], v[40:41], v[48:49]
    v_pk_add_f32 v[42:43], v[42:43], v[50:51]
    v_fmac_f32 v116, v40, v131
    v_fmac_f32 v117, v41, v131
    v_fmac_f32 v118, v42, v131
    v_fmac_f32 v119, v43, v131
    v_cvt_pk_bf16_f32 v140, v116, v117
    v_cvt_pk_bf16_f32 v141, v118, v119
    buffer_store_dword v140, v22, s[24:27], s92 offen offset:384 sc1
    buffer_store_dword v141, v22, s[24:27], s75 offen offset:512 sc1
    v_cndmask_b32 v117, v117, 0, s[64:65]
    v_mul_f32 v149, v116, v116
    v_fmac_f32 v149, v118, v118
    v_fmac_f32 v149, v119, v119
    v_fmac_f32 v149, v117, v117
    s_waitcnt lgkmcnt(0)
    v_pk_add_f32 v[24:25], v[24:25], v[28:29]
    v_pk_add_f32 v[26:27], v[26:27], v[30:31]
    v_pk_add_f32 v[32:33], v[32:33], v[36:37]
    v_pk_add_f32 v[34:35], v[34:35], v[38:39]
    v_pk_add_f32 v[24:25], v[24:25], v[32:33]
    v_pk_add_f32 v[26:27], v[26:27], v[34:35]
    v_fmac_f32 v120, v24, v132
    v_fmac_f32 v121, v25, v132
    v_fmac_f32 v122, v26, v132
    v_fmac_f32 v123, v27, v132
    v_cvt_pk_bf16_f32 v142, v120, v121
    v_cvt_pk_bf16_f32 v143, v122, v123
    v_mul_f32 v150, v120, v120
    v_fmac_f32 v150, v122, v122
    v_fmac_f32 v150, v123, v123
    v_fmac_f32 v150, v121, v121
    v_permlane32_swap_b32 v146, v148
    v_permlane32_swap_b32 v147, v149
    s_lshl_b32 s46, s32, 8
    s_add_u32 s46, s46, 162816
    v_add_f32 v146, v146, v148
    v_add_f32 v147, v147, v149
    v_lshl_add_u32 v5, v1, 2, s46
    s_nop 0
    v_permlane16_swap_b32 v146, v147
    v_add_f32 v146, v146, v147
    v_add_f32 v146, v146, v150
    ds_write_b32 v5, v146
    s_add_u32 s75, s92, 266240
    buffer_store_dword v142, v23, s[24:27], s75 offen offset:0 sc1
    s_add_u32 s75, s92, 274432
    buffer_store_dword v143, v23, s[24:27], s75 offen offset:128 sc1
    s_waitcnt lgkmcnt(0)
    s_barrier
    s_cmp_lg_u32 s32, 0
    s_cbranch_scc1 L_sx_70
    ds_read2st64_b32 v[24:25], v5 offset0:1 offset1:2
    ds_read_b32 v26, v5 offset:768
    s_waitcnt lgkmcnt(0)
    v_add_f32 v146, v146, v24
    v_add_f32 v25, v25, v26
    v_add_f32 v146, v146, v25
    buffer_atomic_add_f32 v146, v23, s[24:27], s93 offen sc1
L_sx_70:
    s_lshl_b32 s46, s36, 2
    s_add_u32 s46, s46, s32
    s_mul_i32 s46, s46, 61440
    s_add_u32 s46, s46, 23650304
    s_xor_b32 s47, s32, 0
    s_mul_i32 s47, s47, 3072
    s_add_u32 s80, s46, s47
    s_xor_b32 s47, s32, 1
    s_mul_i32 s47, s47, 3072
    s_add_u32 s81, s46, s47
    s_add_u32 s5, s81, 49152
    s_xor_b32 s47, s32, 2
    s_mul_i32 s47, s47, 3072
    s_add_u32 s82, s46, s47
    s_add_u32 s6, s82, 49152
    s_xor_b32 s47, s32, 3
    s_mul_i32 s47, s47, 3072
    s_add_u32 s83, s46, s47
    s_add_u32 s7, s83, 49152
    s_sub_u32 s46, s34, 0
    s_cselect_b32 s47, 0, 8
    s_sub_u32 s47, s34, s47
    s_mul_i32 s48, s33, 24
    s_add_u32 s47, s47, s48
    s_lshl3_add_u32 s48, s33, s46
    s_lshl1_add_u32 s48, s48, 192
    s_cmp_lt_u32 s46, 8
    s_cselect_b32 s67, 1, 0
    s_cselect_b32 s38, s48, s47
    s_lshl_b32 s46, s32, 11
    s_add_u32 s60, s46, 73728
    s_lshr_b32 s47, s38, 1
    s_mul_i32 s47, s47, 16512
    s_lshl_b32 s48, s38, 6
    s_add_u32 s47, s47, s48
    s_add_u32 s47, s47, s46
    s_mul_i32 s48, s38, 8320
    s_add_u32 s46, s46, s48
    s_add_u32 s61, s46, 2744320
    s_add_u32 s62, s47, 31514624
    s_add_u32 s63, s46, 2752640
    s_add_u32 s64, s47, 31514688
    v_and_b32 v241, 3, v2
    v_and_or_b32 v248, v2, 12, v3
    v_lshl_add_u32 v249, v248, 2, v241
    v_lshlrev_b32 v249, 5, v249
    v_and_b32 v250, -64, v4
    v_add_u32 v250, v250, v4
    v_add_u32 v251, 8192, v250
    s_and_b32 s46, s38, -16
    s_add_u32 s46, s46, s38
    s_lshl_b32 s58, s46, 6
    s_lshr_b32 s46, s46, 1
    s_and_b32 s46, s46, 2
    s_mul_i32 s47, s32, 657920
    s_add_u32 s58, s58, s47
    s_add_u32 s58, s58, 8380416
    v_xor_b32 v240, s46, v241
    v_mul_u32_u24 v248, 40960, v248
    v_and_b32 v241, 12, v2
    v_mul_u32_u24 v241, 160, v241
    v_add_u32 v248, v248, v241
    v_lshl_add_u32 v248, v240, 4, v248
    s_mov_b32 s55, 0x45cccccd
    buffer_load_dwordx4 v[112:115], v250, s[24:27], s62 offen sc1
    buffer_load_dwordx4 v[116:119], v251, s[24:27], s62 offen sc1
    buffer_load_dwordx4 v[120:123], v250, s[24:27], s64 offen sc1
    buffer_load_dwordx4 v[124:127], v251, s[24:27], s64 offen sc1
    v_mul_u32_u24 v93, 512, v2
    buffer_load_dwordx4 a[0:3], v4, s[24:27], s80 offen offset:0 sc1
    v_lshlrev_b32 v140, 2, v3
    v_cvt_f32_u32 v140, v140
    v_cvt_f32_u32 v142, v2
    s_lshl_b32 s46, s32, 4
    v_add_u32 v136, s46, v2
    v_cvt_f32_u32 v72, v136
    s_mov_b32 s47, 0x80008000
    v_mul_f32 v141, 0x3c800000, v72
    v_mul_f32 v128, v141, v140
    v_add_f32 v129, v128, v141
    v_fma_f32 v130, v141, 2.0, v128
    v_fma_f32 v131, v141, 2.0, v129
    v_mul_f32 v136, 0x41800000, v141
    v_add_f32 v132, v128, v136
    v_add_f32 v133, v129, v136
    v_add_f32 v134, v130, v136
    v_add_f32 v135, v131, v136
    v_cos_f32 v136, v128
    v_cos_f32 v137, v129
    buffer_load_dwordx4 a[4:7], v4, s[24:27], s80 offen offset:1024 sc1
    v_sin_f32 v138, v128
    v_sin_f32 v139, v129
    v_cvt_pk_bf16_f32 v8, v136, v137
    v_cvt_pk_bf16_f32 v16, v138, v139
    v_cos_f32 v136, v130
    v_cos_f32 v137, v131
    v_sin_f32 v138, v130
    v_sin_f32 v139, v131
    s_waitcnt vmcnt(6)
    v_mul_u32_u24 v5, 4096, v1
    v_mov_b32 v6, 1
    s_barrier
    s_cmp_lg_u32 s32, 0
    s_cbranch_scc1 L_sg_71
    s_mov_b64 exec, 0xffff
    buffer_atomic_add v6, v5, s[24:27], s43 offen offset:4 sc1
    s_mov_b64 exec, -1
L_sg_71:
    v_cvt_pk_bf16_f32 v9, v136, v137
    v_cvt_pk_bf16_f32 v17, v138, v139
    v_cos_f32 v136, v132
    v_cos_f32 v137, v133
    v_sin_f32 v138, v132
    v_sin_f32 v139, v133
    v_cvt_pk_bf16_f32 v10, v136, v137
    v_cvt_pk_bf16_f32 v18, v138, v139
    v_cos_f32 v136, v134
    buffer_load_dwordx4 a[8:11], v4, s[24:27], s80 offen offset:2048 sc1
    s_add_u32 s80, s80, 12288
    v_cos_f32 v137, v135
    v_sin_f32 v138, v134
    v_sin_f32 v139, v135
    v_cvt_pk_bf16_f32 v11, v136, v137
    v_cvt_pk_bf16_f32 v19, v138, v139
    s_branch L_pgx8
L_pg8:
    s_setpc_b64 s[40:41]
L_pgx8:
    v_and_b32 v136, 1, v2
    v_mul_lo_u32 v136, v136, s47
    v_xor_b32 v12, v136, v8
    v_xor_b32 v20, v136, v16
    v_xor_b32 v13, v136, v9
    v_xor_b32 v21, v136, v17
    v_xor_b32 v14, v136, v10
    buffer_load_dwordx4 a[12:15], v4, s[24:27], s81 offen offset:0 sc1
    v_xor_b32 v22, v136, v18
    v_xor_b32 v15, v136, v11
    v_xor_b32 v23, v136, v19
    v_xor_b32 v24, s47, v16
    v_xor_b32 v25, s47, v17
    v_xor_b32 v26, s47, v18
    v_xor_b32 v27, s47, v19
    v_xor_b32 v28, s47, v20
    v_xor_b32 v29, s47, v21
    v_xor_b32 v30, s47, v22
    v_xor_b32 v31, s47, v23
    v_mul_f32 v141, 0x3a000000, v72
    v_mul_f32 v128, v141, v140
    v_add_f32 v129, v128, v141
    v_fma_f32 v130, v141, 2.0, v128
    v_fma_f32 v131, v141, 2.0, v129
    v_mul_f32 v136, 0x41800000, v141
    v_add_f32 v132, v128, v136
    v_add_f32 v133, v129, v136
    v_add_f32 v134, v130, v136
    v_add_f32 v135, v131, v136
    v_cos_f32 v56, v128
    buffer_load_dwordx4 a[16:19], v4, s[24:27], s81 offen offset:1024 sc1
    v_sin_f32 v64, v128
    v_cos_f32 v57, v129
    v_sin_f32 v65, v129
    v_cos_f32 v58, v130
    v_sin_f32 v66, v130
    v_cos_f32 v59, v131
    buffer_load_dwordx4 a[20:23], v4, s[24:27], s81 offen offset:2048 sc1
    s_add_u32 s81, s81, 12288
    v_sin_f32 v67, v131
    v_cos_f32 v60, v132
    v_sin_f32 v68, v132
    v_cos_f32 v61, v133
    v_sin_f32 v69, v133
    v_cos_f32 v62, v134
    buffer_load_dwordx4 a[24:27], v4, s[24:27], s82 offen offset:0 sc1
    v_sin_f32 v70, v134
    v_cos_f32 v63, v135
    v_sin_f32 v71, v135
    v_mul_f32 v141, 0x3d000000, v142
    v_mul_f32 v128, v141, v140
    v_add_f32 v129, v128, v141
    v_fma_f32 v130, v141, 2.0, v128
    v_fma_f32 v131, v141, 2.0, v129
    v_mul_f32 v136, 0x41800000, v141
    v_add_f32 v132, v128, v136
    v_add_f32 v133, v129, v136
    v_add_f32 v134, v130, v136
    v_add_f32 v135, v131, v136
    buffer_load_dwordx4 a[28:31], v4, s[24:27], s82 offen offset:1024 sc1
    v_cos_f32 v136, v128
    v_cos_f32 v137, v129
    v_sin_f32 v138, v128
    v_sin_f32 v139, v129
    v_cvt_pk_bf16_f32 v32, v136, v137
    v_cvt_pk_bf16_f32 v40, v138, v139
    v_cos_f32 v136, v130
    v_cos_f32 v137, v131
    buffer_load_dwordx4 a[32:35], v4, s[24:27], s82 offen offset:2048 sc1
    s_add_u32 s82, s82, 12288
    v_sin_f32 v138, v130
    v_sin_f32 v139, v131
    v_cvt_pk_bf16_f32 v33, v136, v137
    v_cvt_pk_bf16_f32 v41, v138, v139
    v_cos_f32 v136, v132
    v_cos_f32 v137, v133
    v_sin_f32 v138, v132
    buffer_load_dwordx4 a[36:39], v4, s[24:27], s83 offen offset:0 sc1
    v_sin_f32 v139, v133
    v_cvt_pk_bf16_f32 v34, v136, v137
    v_cvt_pk_bf16_f32 v42, v138, v139
    v_cos_f32 v136, v134
    v_cos_f32 v137, v135
    v_sin_f32 v138, v134
    v_sin_f32 v139, v135
    v_cvt_pk_bf16_f32 v35, v136, v137
    v_cvt_pk_bf16_f32 v43, v138, v139
    buffer_load_dwordx4 a[40:43], v4, s[24:27], s83 offen offset:1024 sc1
    v_xor_b32 v36, 0x80000000, v32
    v_xor_b32 v44, 0x80000000, v40
    v_xor_b32 v37, 0x80000000, v33
    v_xor_b32 v45, 0x80000000, v41
    v_xor_b32 v38, 0x80000000, v34
    v_xor_b32 v46, 0x80000000, v42
    v_xor_b32 v39, 0x80000000, v35
    v_xor_b32 v47, 0x80000000, v43
    v_xor_b32 v48, s47, v40
    v_xor_b32 v49, s47, v41
    v_xor_b32 v50, s47, v42
    v_xor_b32 v51, s47, v43
    v_xor_b32 v52, s47, v44
    v_xor_b32 v53, s47, v45
    v_xor_b32 v54, s47, v46
    v_xor_b32 v55, s47, v47
    v_cvt_f32_u32 v136, s46
    v_add_f32 v136, v136, v140
    v_mul_f32 v141, 0x3a000000, v142
    v_mul_f32 v128, v141, v136
    v_add_f32 v129, v128, v141
    v_fma_f32 v130, v141, 2.0, v128
    v_fma_f32 v131, v141, 2.0, v129
    v_mul_f32 v141, 0x3a000000, v142
    buffer_load_dwordx4 a[44:47], v4, s[24:27], s83 offen offset:2048 sc1
    s_add_u32 s83, s83, 12288
    v_add_f32 v141, 0x3c000000, v141
    v_mul_f32 v132, v141, v136
    v_add_f32 v133, v132, v141
    v_fma_f32 v134, v141, 2.0, v132
    v_fma_f32 v135, v141, 2.0, v133
    v_cos_f32 v72, v128
    v_sin_f32 v80, v128
    v_cos_f32 v73, v129
    v_sin_f32 v81, v129
    v_cos_f32 v74, v130
    buffer_load_dwordx4 a[48:51], v4, s[24:27], s80 offen offset:0 sc1
    v_sin_f32 v82, v130
    v_cos_f32 v75, v131
    v_sin_f32 v83, v131
    v_cos_f32 v76, v132
    v_sin_f32 v84, v132
    v_cos_f32 v77, v133
    buffer_load_dwordx4 a[52:55], v4, s[24:27], s80 offen offset:1024 sc1
    v_sin_f32 v85, v133
    v_cos_f32 v78, v134
    v_sin_f32 v86, v134
    v_cos_f32 v79, v135
    v_sin_f32 v87, v135
    s_lshl_b32 s48, s32, 10
    v_lshrrev_b32 v136, 1, v2
    v_and_b32 v136, 2, v136
    s_cmp_lg_u32 s32, 0
    s_cbranch_scc1 L_sm_72
    v_mov_b32 v95, 0
    s_mov_b64 exec, 0xff
    buffer_atomic_add v95, v93, s[24:27], s97 offen offset:4 sc0 sc1
    s_mov_b64 exec, -1
L_sm_72:
    v_xor_b32 v136, v136, v3
    v_lshlrev_b32 v136, 4, v136
    v_lshl_add_u32 v136, v2, 6, v136
    v_add_u32 v90, s48, v136
    v_lshrrev_b32 v136, 2, v1
    v_lshlrev_b32 v136, 6, v136
    v_and_b32 v137, 3, v1
    v_lshl_add_u32 v136, v137, 3, v136
    v_and_b32 v137, 1, v3
    v_lshl_add_u32 v88, v137, 5, v136
    v_xor_b32 v89, 32, v88
    s_lshr_b32 s48, s32, 1
    s_lshl_b32 s48, s48, 6
    s_and_b32 s49, s32, 1
    s_lshl_b32 s49, s49, 3
    s_add_u32 s48, s48, s49
    v_mul_u32_u24 v91, 144, v2
    v_lshl_add_u32 v91, v3, 4, v91
    v_add_u32 v91, s48, v91
    v_and_b32 v136, 12, v2
    v_add_u32 v136, v136, v2
    v_mul_u32_u24 v136, 144, v136
    v_lshl_add_u32 v92, v3, 4, v136
    buffer_load_dwordx4 a[56:59], v4, s[24:27], s80 offen offset:2048 sc1
    s_add_u32 s80, s80, 12288
    buffer_load_dwordx4 a[60:63], v4, s[24:27], s81 offen offset:0 sc1
    buffer_load_dwordx4 a[64:67], v4, s[24:27], s81 offen offset:1024 sc1
    buffer_load_dwordx4 a[68:71], v4, s[24:27], s81 offen offset:2048 sc1
    s_add_u32 s81, s81, 12288
    buffer_load_dwordx4 a[72:75], v4, s[24:27], s82 offen offset:0 sc1
    buffer_load_dwordx4 a[76:79], v4, s[24:27], s82 offen offset:1024 sc1
L_m3:
    s_cmp_lg_u32 s32, 1
    s_cbranch_scc1 L_tn_75
    s_call_b64 s[40:41], L_onet1
    s_call_b64 s[40:41], L_pg10
    s_call_b64 s[40:41], L_pg13
    s_branch L_te_74
L_tn_75:
    s_cmp_lg_u32 s32, 2
    s_cbranch_scc1 L_tn_76
    s_call_b64 s[40:41], L_pg14
    s_call_b64 s[40:41], L_pg11
    s_nop 0
    s_branch L_te_74
L_tn_76:
    s_cmp_lg_u32 s32, 3
    s_cbranch_scc1 L_te_74
    s_call_b64 s[40:41], L_pg9
    s_call_b64 s[40:41], L_pg12
    s_nop 0
L_te_74:
    s_cmp_lg_u32 s32, 0
    s_cbranch_scc1 L_pe_81
    s_mov_b32 s42, 65536
    s_mov_b64 exec, 0xff
    s_waitcnt vmcnt(6)
    s_branch L_pc_79
L_pl_78:
    v_mov_b32 v95, 0
    buffer_atomic_add v95, v93, s[24:27], s97 offen offset:4 sc0 sc1
    s_waitcnt vmcnt(0)
L_pc_79:
    v_and_b32 v94, 32, v95
    v_cmp_ne_u32 vcc, 32, v94
    s_cbranch_vccz L_pd_80
    s_sub_u32 s42, s42, 1
    s_cbranch_scc0 L_pl_78
L_pd_80:
    s_mov_b64 exec, -1
L_pe_81:
    s_barrier
    buffer_load_dwordx4 v[208:211], v249, s[24:27], s60 offen offset:0 sc1
    buffer_load_dwordx4 v[212:215], v249, s[24:27], s60 offen offset:16 sc1
    buffer_load_dwordx4 v[96:99], v249, s[24:27], s61 offen offset:0 sc1
    buffer_load_dwordx4 v[100:103], v249, s[24:27], s61 offen offset:16 sc1
    s_cmp_eq_u32 s67, 0
    s_cbranch_scc1 L_one1
    buffer_load_dwordx4 v[104:107], v249, s[24:27], s63 offen offset:0 sc1
    buffer_load_dwordx4 v[108:111], v249, s[24:27], s63 offen offset:16 sc1
    buffer_load_dwordx4 a[80:83], v4, s[24:27], s82 offen offset:2048 sc1
    s_add_u32 s82, s82, 12288
    buffer_load_dwordx4 a[84:87], v4, s[24:27], s83 offen offset:0 sc1
    buffer_load_dwordx4 a[88:91], v4, s[24:27], s83 offen offset:1024 sc1
    buffer_load_dwordx4 a[92:95], v4, s[24:27], s83 offen offset:2048 sc1
    s_add_u32 s83, s83, 12288
    buffer_load_dwordx4 a[96:99], v4, s[24:27], s80 offen offset:0 sc1
    buffer_load_dwordx4 a[100:103], v4, s[24:27], s80 offen offset:1024 sc1
    v_mov_b32 v240, 0x4227c5ac
    s_waitcnt vmcnt(10)
    v_fma_f32 v208, v208, s55, v240
    v_fma_f32 v209, v209, s55, v240
    v_fma_f32 v210, v210, s55, v240
    v_fma_f32 v211, v211, s55, v240
    v_fma_f32 v212, v212, s55, v240
    v_fma_f32 v213, v213, s55, v240
    v_fma_f32 v214, v214, s55, v240
    v_fma_f32 v215, v215, s55, v240
    v_rsq_f32 v208, v208
    v_rsq_f32 v209, v209
    v_rsq_f32 v210, v210
    v_rsq_f32 v211, v211
    v_rsq_f32 v212, v212
    v_rsq_f32 v213, v213
    v_rsq_f32 v214, v214
    v_rsq_f32 v215, v215
    s_waitcnt vmcnt(8)
    v_lshlrev_b32 v128, 16, v96
    v_lshlrev_b32 v129, 16, v97
    v_lshlrev_b32 v130, 16, v98
    v_lshlrev_b32 v131, 16, v99
    v_lshlrev_b32 v132, 16, v100
    v_lshlrev_b32 v133, 16, v101
    v_lshlrev_b32 v134, 16, v102
    v_lshlrev_b32 v135, 16, v103
    v_pk_mul_f32 v[128:129], v[128:129], v[208:209]
    v_pk_mul_f32 v[130:131], v[130:131], v[210:211]
    v_pk_mul_f32 v[132:133], v[132:133], v[212:213]
    v_pk_mul_f32 v[134:135], v[134:135], v[214:215]
    v_cvt_pk_bf16_f32 v224, v128, v129
    v_cvt_pk_bf16_f32 v225, v130, v131
    v_cvt_pk_bf16_f32 v226, v132, v133
    v_cvt_pk_bf16_f32 v227, v134, v135
    ds_write_b128 v90, v[224:227] offset:0
    v_and_b32 v136, 0xffff0000, v96
    v_and_b32 v137, 0xffff0000, v97
    v_and_b32 v138, 0xffff0000, v98
    v_and_b32 v139, 0xffff0000, v99
    v_and_b32 v140, 0xffff0000, v100
    v_and_b32 v141, 0xffff0000, v101
    v_and_b32 v142, 0xffff0000, v102
    v_and_b32 v143, 0xffff0000, v103
    v_pk_mul_f32 v[136:137], v[136:137], v[208:209]
    v_pk_mul_f32 v[138:139], v[138:139], v[210:211]
    v_pk_mul_f32 v[140:141], v[140:141], v[212:213]
    v_pk_mul_f32 v[142:143], v[142:143], v[214:215]
    v_cvt_pk_bf16_f32 v228, v136, v137
    v_cvt_pk_bf16_f32 v229, v138, v139
    v_cvt_pk_bf16_f32 v230, v140, v141
    v_cvt_pk_bf16_f32 v231, v142, v143
    ds_write_b128 v90, v[228:231] offset:4096
    s_waitcnt vmcnt(6)
    v_lshlrev_b32 v160, 16, v104
    v_lshlrev_b32 v161, 16, v105
    v_lshlrev_b32 v162, 16, v106
    v_lshlrev_b32 v163, 16, v107
    v_lshlrev_b32 v164, 16, v108
    v_lshlrev_b32 v165, 16, v109
    v_lshlrev_b32 v166, 16, v110
    v_lshlrev_b32 v167, 16, v111
    v_pk_mul_f32 v[160:161], v[160:161], v[208:209]
    v_pk_mul_f32 v[162:163], v[162:163], v[210:211]
    v_pk_mul_f32 v[164:165], v[164:165], v[212:213]
    v_pk_mul_f32 v[166:167], v[166:167], v[214:215]
    v_cvt_pk_bf16_f32 v232, v160, v161
    v_cvt_pk_bf16_f32 v233, v162, v163
    v_cvt_pk_bf16_f32 v234, v164, v165
    v_cvt_pk_bf16_f32 v235, v166, v167
    s_waitcnt lgkmcnt(0)
    s_barrier
    ds_read_b64_tr_b16 v[128:129], v88 offset:0
    ds_read_b64_tr_b16 v[130:131], v88 offset:1024
    ds_read_b64_tr_b16 v[144:145], v88 offset:4096
    ds_read_b64_tr_b16 v[146:147], v88 offset:5120
    ds_read_b64_tr_b16 v[136:137], v88 offset:2048
    ds_read_b64_tr_b16 v[138:139], v88 offset:3072
    ds_read_b64_tr_b16 v[152:153], v88 offset:6144
    ds_read_b64_tr_b16 v[154:155], v88 offset:7168
    ds_read_b64_tr_b16 v[132:133], v89 offset:0
    ds_read_b64_tr_b16 v[134:135], v89 offset:1024
    ds_read_b64_tr_b16 v[148:149], v89 offset:4096
    ds_read_b64_tr_b16 v[150:151], v89 offset:5120
    v_and_b32 v168, 0xffff0000, v104
    v_and_b32 v169, 0xffff0000, v105
    v_and_b32 v170, 0xffff0000, v106
    v_and_b32 v171, 0xffff0000, v107
    ds_read_b64_tr_b16 v[140:141], v89 offset:2048
    v_and_b32 v172, 0xffff0000, v108
    v_and_b32 v173, 0xffff0000, v109
    v_and_b32 v174, 0xffff0000, v110
    ds_read_b64_tr_b16 v[142:143], v89 offset:3072
    v_and_b32 v175, 0xffff0000, v111
    v_pk_mul_f32 v[168:169], v[168:169], v[208:209]
    v_pk_mul_f32 v[170:171], v[170:171], v[210:211]
    ds_read_b64_tr_b16 v[156:157], v89 offset:6144
    v_pk_mul_f32 v[172:173], v[172:173], v[212:213]
    v_pk_mul_f32 v[174:175], v[174:175], v[214:215]
    v_cvt_pk_bf16_f32 v236, v168, v169
    s_waitcnt lgkmcnt(11)
    ds_read_b64_tr_b16 v[158:159], v89 offset:7168
    v_cvt_pk_bf16_f32 v237, v170, v171
    v_cvt_pk_bf16_f32 v238, v172, v173
    v_cvt_pk_bf16_f32 v239, v174, v175
    ds_write_b128 v90, v[232:235] offset:8192
    ds_write_b128 v90, v[236:239] offset:12288
    v_mfma_f32_16x16x32_bf16 v[192:195], v[128:131], v[8:11], 0
    buffer_load_dwordx4 a[104:107], v4, s[24:27], s80 offen offset:2048 sc1
    s_add_u32 s80, s80, 12288
    v_mfma_f32_16x16x32_bf16 v[192:195], v[144:147], v[16:19], v[192:195]
    buffer_load_dwordx4 a[108:111], v4, s[24:27], s81 offen offset:0 sc1
    v_mfma_f32_16x16x32_bf16 v[200:203], v[144:147], v[8:11], 0
    buffer_load_dwordx4 a[112:115], v4, s[24:27], s81 offen offset:1024 sc1
    v_mfma_f32_16x16x32_bf16 v[200:203], v[128:131], v[24:27], v[200:203]
    buffer_load_dwordx4 a[116:119], v4, s[24:27], s81 offen offset:2048 sc1
    s_add_u32 s81, s81, 12288
    s_waitcnt lgkmcnt(10)
    v_mfma_f32_16x16x32_bf16 v[192:195], v[136:139], v[12:15], v[192:195]
    buffer_load_dwordx4 a[120:123], v4, s[24:27], s82 offen offset:0 sc1
    v_mfma_f32_16x16x32_bf16 v[192:195], v[152:155], v[20:23], v[192:195]
    buffer_load_dwordx4 a[124:127], v4, s[24:27], s82 offen offset:1024 sc1
    s_waitcnt lgkmcnt(0)
    s_barrier
    v_mfma_f32_16x16x32_bf16 v[200:203], v[152:155], v[12:15], v[200:203]
    ds_read_b64_tr_b16 v[160:161], v88 offset:8192
    ds_read_b64_tr_b16 v[162:163], v88 offset:9216
    v_mfma_f32_16x16x32_bf16 v[200:203], v[136:139], v[28:31], v[200:203]
    ds_read_b64_tr_b16 v[176:177], v88 offset:12288
    ds_read_b64_tr_b16 v[178:179], v88 offset:13312
    v_mfma_f32_16x16x32_bf16 v[196:199], v[132:135], v[8:11], 0
    ds_read_b64_tr_b16 v[168:169], v88 offset:10240
    ds_read_b64_tr_b16 v[170:171], v88 offset:11264
    v_mfma_f32_16x16x32_bf16 v[196:199], v[148:151], v[16:19], v[196:199]
    ds_read_b64_tr_b16 v[184:185], v88 offset:14336
    ds_read_b64_tr_b16 v[186:187], v88 offset:15360
    v_mfma_f32_16x16x32_bf16 v[204:207], v[148:151], v[8:11], 0
    buffer_load_dwordx4 a[208:211], v4, s[24:27], s5 offen offset:1024 sc1
    ds_read_b64_tr_b16 v[164:165], v89 offset:8192
    v_mfma_f32_16x16x32_bf16 v[204:207], v[132:135], v[24:27], v[204:207]
    ds_read_b64_tr_b16 v[166:167], v89 offset:9216
    ds_read_b64_tr_b16 v[180:181], v89 offset:12288
    v_mfma_f32_16x16x32_bf16 v[196:199], v[140:143], v[12:15], v[196:199]
    ds_read_b64_tr_b16 v[182:183], v89 offset:13312
    ds_read_b64_tr_b16 v[172:173], v89 offset:10240
    v_mfma_f32_16x16x32_bf16 v[196:199], v[156:159], v[20:23], v[196:199]
    ds_read_b64_tr_b16 v[174:175], v89 offset:11264
    v_mfma_f32_16x16x32_bf16 v[204:207], v[156:159], v[12:15], v[204:207]
    ds_read_b64_tr_b16 v[188:189], v89 offset:14336
    v_mfma_f32_16x16x32_bf16 v[204:207], v[140:143], v[28:31], v[204:207]
    s_waitcnt lgkmcnt(11)
    ds_read_b64_tr_b16 v[190:191], v89 offset:15360
    v_pk_mul_f32 v[240:241], v[192:193], v[56:57]
    v_pk_mul_f32 v[242:243], v[194:195], v[58:59]
    v_pk_mul_f32 v[244:245], v[196:197], v[60:61]
    v_pk_mul_f32 v[246:247], v[198:199], v[62:63]
    v_pk_fma_f32 v[240:241], v[200:201], v[64:65], v[240:241]
    v_pk_fma_f32 v[242:243], v[202:203], v[66:67], v[242:243]
    v_pk_fma_f32 v[244:245], v[204:205], v[68:69], v[244:245]
    v_pk_fma_f32 v[246:247], v[206:207], v[70:71], v[246:247]
    buffer_load_dwordx4 a[212:215], v4, s[24:27], s5 offen offset:2048 sc1
    v_pk_mul_f32 v[200:201], v[200:201], v[56:57]
    v_pk_mul_f32 v[202:203], v[202:203], v[58:59]
    v_pk_mul_f32 v[204:205], v[204:205], v[60:61]
    v_pk_mul_f32 v[206:207], v[206:207], v[62:63]
    v_pk_fma_f32 v[200:201], v[192:193], v[64:65], v[200:201] neg_lo:[1,0,0] neg_hi:[1,0,0]
    v_pk_fma_f32 v[202:203], v[194:195], v[66:67], v[202:203] neg_lo:[1,0,0] neg_hi:[1,0,0]
    v_pk_fma_f32 v[204:205], v[196:197], v[68:69], v[204:205] neg_lo:[1,0,0] neg_hi:[1,0,0]
    v_pk_fma_f32 v[206:207], v[198:199], v[70:71], v[206:207] neg_lo:[1,0,0] neg_hi:[1,0,0]
    v_mfma_f32_16x16x32_bf16 v[208:211], v[160:163], v[8:11], 0
    v_cvt_pk_bf16_f32 v224, v240, v241
    v_cvt_pk_bf16_f32 v228, v200, v201
    v_cvt_pk_bf16_f32 v225, v242, v243
    v_mfma_f32_16x16x32_bf16 v[208:211], v[176:179], v[16:19], v[208:211]
    v_cvt_pk_bf16_f32 v229, v202, v203
    v_cvt_pk_bf16_f32 v226, v244, v245
    v_cvt_pk_bf16_f32 v230, v204, v205
    v_mfma_f32_16x16x32_bf16 v[216:219], v[176:179], v[8:11], 0
    v_cvt_pk_bf16_f32 v227, v246, v247
    buffer_load_dwordx4 a[128:131], v4, s[24:27], s82 offen offset:2048 sc1
    s_add_u32 s82, s82, 12288
    v_cvt_pk_bf16_f32 v231, v206, v207
    v_mfma_f32_16x16x32_bf16 v[216:219], v[160:163], v[24:27], v[216:219]
    v_lshlrev_b32 v128, 16, v112
    v_and_b32 v129, 0xffff0000, v112
    s_waitcnt lgkmcnt(8)
    v_mfma_f32_16x16x32_bf16 v[208:211], v[168:171], v[12:15], v[208:211]
    v_lshlrev_b32 v130, 16, v113
    v_and_b32 v131, 0xffff0000, v113
    v_mfma_f32_16x16x32_bf16 v[208:211], v[184:187], v[20:23], v[208:211]
    buffer_load_dwordx4 a[132:135], v4, s[24:27], s83 offen offset:0 sc1
    v_lshlrev_b32 v132, 16, v114
    v_mfma_f32_16x16x32_bf16 v[216:219], v[184:187], v[12:15], v[216:219]
    v_and_b32 v133, 0xffff0000, v114
    v_lshlrev_b32 v134, 16, v115
    v_mfma_f32_16x16x32_bf16 v[216:219], v[168:171], v[28:31], v[216:219]
    v_and_b32 v135, 0xffff0000, v115
    v_lshlrev_b32 v136, 16, v116
    s_waitcnt lgkmcnt(4)
    v_mfma_f32_16x16x32_bf16 v[212:215], v[164:167], v[8:11], 0
    v_and_b32 v137, 0xffff0000, v116
    v_lshlrev_b32 v138, 16, v117
    v_mfma_f32_16x16x32_bf16 v[212:215], v[180:183], v[16:19], v[212:215]
    buffer_load_dwordx4 a[136:139], v4, s[24:27], s83 offen offset:1024 sc1
    v_and_b32 v139, 0xffff0000, v117
    v_mfma_f32_16x16x32_bf16 v[220:223], v[180:183], v[8:11], 0
    v_lshlrev_b32 v140, 16, v118
    v_and_b32 v141, 0xffff0000, v118
    v_mfma_f32_16x16x32_bf16 v[220:223], v[164:167], v[24:27], v[220:223]
    v_lshlrev_b32 v142, 16, v119
    v_and_b32 v143, 0xffff0000, v119
    s_waitcnt lgkmcnt(0)
    v_mfma_f32_16x16x32_bf16 v[212:215], v[172:175], v[12:15], v[212:215]
    buffer_load_dwordx4 a[216:219], v4, s[24:27], s6 offen offset:0 sc1
    v_mfma_f32_16x16x32_bf16 v[212:215], v[188:191], v[20:23], v[212:215]
    v_lshlrev_b32 v144, 16, v120
    v_and_b32 v145, 0xffff0000, v120
    v_mfma_f32_16x16x32_bf16 v[220:223], v[188:191], v[12:15], v[220:223]
    v_lshlrev_b32 v146, 16, v121
    v_and_b32 v147, 0xffff0000, v121
    v_mfma_f32_16x16x32_bf16 v[220:223], v[172:175], v[28:31], v[220:223]
    v_lshlrev_b32 v148, 16, v122
    v_and_b32 v149, 0xffff0000, v122
    v_lshlrev_b32 v150, 16, v123
    v_and_b32 v151, 0xffff0000, v123
    v_pk_mul_f32 v[240:241], v[208:209], v[56:57]
    v_pk_mul_f32 v[242:243], v[210:211], v[58:59]
    v_pk_mul_f32 v[244:245], v[212:213], v[60:61]
    v_pk_mul_f32 v[246:247], v[214:215], v[62:63]
    v_pk_fma_f32 v[240:241], v[216:217], v[64:65], v[240:241]
    v_pk_fma_f32 v[242:243], v[218:219], v[66:67], v[242:243]
    v_pk_fma_f32 v[244:245], v[220:221], v[68:69], v[244:245]
    buffer_load_dwordx4 a[220:223], v4, s[24:27], s6 offen offset:1024 sc1
    v_pk_fma_f32 v[246:247], v[222:223], v[70:71], v[246:247]
    v_pk_mul_f32 v[216:217], v[216:217], v[56:57]
    v_pk_mul_f32 v[218:219], v[218:219], v[58:59]
    v_pk_mul_f32 v[220:221], v[220:221], v[60:61]
    v_pk_mul_f32 v[222:223], v[222:223], v[62:63]
    v_pk_fma_f32 v[216:217], v[208:209], v[64:65], v[216:217] neg_lo:[1,0,0] neg_hi:[1,0,0]
    v_pk_fma_f32 v[218:219], v[210:211], v[66:67], v[218:219] neg_lo:[1,0,0] neg_hi:[1,0,0]
    v_pk_fma_f32 v[220:221], v[212:213], v[68:69], v[220:221] neg_lo:[1,0,0] neg_hi:[1,0,0]
    v_pk_fma_f32 v[222:223], v[214:215], v[70:71], v[222:223] neg_lo:[1,0,0] neg_hi:[1,0,0]
    v_mfma_f32_16x16x32_bf16 v[192:195], v[32:35], v[224:227], 0
    v_cvt_pk_bf16_f32 v232, v240, v241
    v_cvt_pk_bf16_f32 v236, v216, v217
    v_cvt_pk_bf16_f32 v233, v242, v243
    v_mfma_f32_16x16x32_bf16 v[192:195], v[40:43], v[228:231], v[192:195]
    v_cvt_pk_bf16_f32 v237, v218, v219
    v_cvt_pk_bf16_f32 v234, v244, v245
    v_cvt_pk_bf16_f32 v238, v220, v221
    v_mfma_f32_16x16x32_bf16 v[200:203], v[32:35], v[228:231], 0
    v_cvt_pk_bf16_f32 v235, v246, v247
    v_cvt_pk_bf16_f32 v239, v222, v223
    v_mfma_f32_16x16x32_bf16 v[200:203], v[48:51], v[224:227], v[200:203]
    buffer_load_dwordx4 a[140:143], v4, s[24:27], s83 offen offset:2048 sc1
    s_add_u32 s83, s83, 12288
    buffer_load_dwordx4 a[144:147], v4, s[24:27], s80 offen offset:0 sc1
    v_mfma_f32_16x16x32_bf16 v[196:199], v[36:39], v[224:227], 0
    v_lshlrev_b32 v152, 16, v124
    v_and_b32 v153, 0xffff0000, v124
    v_mfma_f32_16x16x32_bf16 v[196:199], v[44:47], v[228:231], v[196:199]
    v_lshlrev_b32 v154, 16, v125
    v_and_b32 v155, 0xffff0000, v125
    v_mfma_f32_16x16x32_bf16 v[204:207], v[36:39], v[228:231], 0
    v_lshlrev_b32 v156, 16, v126
    v_and_b32 v157, 0xffff0000, v126
    v_mfma_f32_16x16x32_bf16 v[204:207], v[52:55], v[224:227], v[204:207]
    v_lshlrev_b32 v158, 16, v127
    v_and_b32 v159, 0xffff0000, v127
    v_pk_mul_f32 v[240:241], v[192:193], v[128:129]
    v_pk_mul_f32 v[242:243], v[194:195], v[130:131]
    v_pk_mul_f32 v[244:245], v[196:197], v[132:133]
    v_pk_mul_f32 v[246:247], v[198:199], v[134:135]
    v_pk_fma_f32 v[240:241], v[200:201], v[136:137], v[240:241] neg_lo:[1,0,0] neg_hi:[1,0,0]
    v_pk_fma_f32 v[242:243], v[202:203], v[138:139], v[242:243] neg_lo:[1,0,0] neg_hi:[1,0,0]
    v_pk_fma_f32 v[244:245], v[204:205], v[140:141], v[244:245] neg_lo:[1,0,0] neg_hi:[1,0,0]
    v_pk_fma_f32 v[246:247], v[206:207], v[142:143], v[246:247] neg_lo:[1,0,0] neg_hi:[1,0,0]
    buffer_load_dwordx4 a[224:227], v4, s[24:27], s6 offen offset:2048 sc1
    v_pk_mul_f32 v[200:201], v[200:201], v[128:129]
    v_pk_mul_f32 v[202:203], v[202:203], v[130:131]
    v_pk_mul_f32 v[204:205], v[204:205], v[132:133]
    v_pk_mul_f32 v[206:207], v[206:207], v[134:135]
    v_pk_fma_f32 v[200:201], v[192:193], v[136:137], v[200:201]
    v_pk_fma_f32 v[202:203], v[194:195], v[138:139], v[202:203]
    v_pk_fma_f32 v[204:205], v[196:197], v[140:141], v[204:205]
    v_pk_fma_f32 v[206:207], v[198:199], v[142:143], v[206:207]
    v_mfma_f32_16x16x32_bf16 v[208:211], v[32:35], v[232:235], 0
    v_cvt_pk_bf16_f32 v224, v240, v241
    v_cvt_pk_bf16_f32 v228, v200, v201
    v_mfma_f32_16x16x32_bf16 v[208:211], v[40:43], v[236:239], v[208:211]
    v_cvt_pk_bf16_f32 v225, v242, v243
    v_cvt_pk_bf16_f32 v229, v202, v203
    v_mfma_f32_16x16x32_bf16 v[216:219], v[32:35], v[236:239], 0
    v_cvt_pk_bf16_f32 v226, v244, v245
    v_cvt_pk_bf16_f32 v230, v204, v205
    v_mfma_f32_16x16x32_bf16 v[216:219], v[48:51], v[232:235], v[216:219]
    v_cvt_pk_bf16_f32 v227, v246, v247
    v_cvt_pk_bf16_f32 v231, v206, v207
    v_mfma_f32_16x16x32_bf16 v[212:215], v[36:39], v[232:235], 0
    buffer_load_dwordx4 a[148:151], v4, s[24:27], s80 offen offset:1024 sc1
    buffer_load_dwordx4 a[152:155], v4, s[24:27], s80 offen offset:2048 sc1
    s_add_u32 s80, s80, 12288
    v_mfma_f32_16x16x32_bf16 v[212:215], v[44:47], v[236:239], v[212:215]
    v_mul_f32 v240, v208, v144
    v_mul_f32 v241, v209, v145
    v_fma_f32 v240, -v216, v152, v240
    v_mfma_f32_16x16x32_bf16 v[220:223], v[36:39], v[236:239], 0
    v_fma_f32 v241, -v217, v153, v241
    v_mul_f32 v216, v216, v144
    v_mul_f32 v217, v217, v145
    v_mfma_f32_16x16x32_bf16 v[220:223], v[52:55], v[232:235], v[220:223]
    v_fmac_f32 v216, v208, v152
    v_fmac_f32 v217, v209, v153
    v_pk_mul_f32 v[242:243], v[210:211], v[146:147]
    v_pk_mul_f32 v[244:245], v[212:213], v[148:149]
    v_pk_mul_f32 v[246:247], v[214:215], v[150:151]
    v_pk_fma_f32 v[242:243], v[218:219], v[154:155], v[242:243] neg_lo:[1,0,0] neg_hi:[1,0,0]
    s_nop 1
    v_pk_fma_f32 v[244:245], v[220:221], v[156:157], v[244:245] neg_lo:[1,0,0] neg_hi:[1,0,0]
    v_pk_fma_f32 v[246:247], v[222:223], v[158:159], v[246:247] neg_lo:[1,0,0] neg_hi:[1,0,0]
    v_pk_mul_f32 v[218:219], v[218:219], v[146:147]
    v_pk_mul_f32 v[220:221], v[220:221], v[148:149]
    v_pk_mul_f32 v[222:223], v[222:223], v[150:151]
    v_pk_fma_f32 v[218:219], v[210:211], v[154:155], v[218:219]
    v_pk_fma_f32 v[220:221], v[212:213], v[156:157], v[220:221]
    v_pk_fma_f32 v[222:223], v[214:215], v[158:159], v[222:223]
    v_mfma_f32_16x16x32_bf16 v[192:195], v[224:227], v[32:35], 0
    v_cvt_pk_bf16_f32 v232, v240, v241
    v_cvt_pk_bf16_f32 v236, v216, v217
    v_mfma_f32_16x16x32_bf16 v[192:195], v[228:231], v[48:51], v[192:195]
    v_cvt_pk_bf16_f32 v233, v242, v243
    v_cvt_pk_bf16_f32 v237, v218, v219
    v_mfma_f32_16x16x32_bf16 v[200:203], v[228:231], v[32:35], 0
    v_cvt_pk_bf16_f32 v234, v244, v245
    v_cvt_pk_bf16_f32 v238, v220, v221
    v_mfma_f32_16x16x32_bf16 v[200:203], v[224:227], v[40:43], v[200:203]
    v_cvt_pk_bf16_f32 v235, v246, v247
    v_cvt_pk_bf16_f32 v239, v222, v223
    v_mfma_f32_16x16x32_bf16 v[196:199], v[224:227], v[36:39], 0
    buffer_load_dwordx4 a[156:159], v4, s[24:27], s81 offen offset:0 sc1
    buffer_load_dwordx4 a[160:163], v4, s[24:27], s81 offen offset:1024 sc1
    v_mfma_f32_16x16x32_bf16 v[196:199], v[228:231], v[52:55], v[196:199]
    v_mul_f32 v240, v192, v72
    v_mul_f32 v241, v193, v73
    v_fma_f32 v240, -v200, v80, v240
    v_mfma_f32_16x16x32_bf16 v[204:207], v[228:231], v[36:39], 0
    v_fma_f32 v241, -v201, v81, v241
    v_mul_f32 v200, v200, v72
    v_mul_f32 v201, v201, v73
    v_mfma_f32_16x16x32_bf16 v[204:207], v[224:227], v[44:47], v[204:207]
    v_fmac_f32 v200, v192, v80
    v_fmac_f32 v201, v193, v81
    v_pk_mul_f32 v[242:243], v[194:195], v[74:75]
    v_pk_mul_f32 v[244:245], v[196:197], v[76:77]
    v_pk_mul_f32 v[246:247], v[198:199], v[78:79]
    v_pk_fma_f32 v[242:243], v[202:203], v[82:83], v[242:243] neg_lo:[1,0,0] neg_hi:[1,0,0]
    s_nop 1
    v_pk_fma_f32 v[244:245], v[204:205], v[84:85], v[244:245] neg_lo:[1,0,0] neg_hi:[1,0,0]
    v_pk_fma_f32 v[246:247], v[206:207], v[86:87], v[246:247] neg_lo:[1,0,0] neg_hi:[1,0,0]
    v_pk_mul_f32 v[202:203], v[202:203], v[74:75]
    v_pk_mul_f32 v[204:205], v[204:205], v[76:77]
    v_pk_mul_f32 v[206:207], v[206:207], v[78:79]
    v_pk_fma_f32 v[202:203], v[194:195], v[82:83], v[202:203]
    v_pk_fma_f32 v[204:205], v[196:197], v[84:85], v[204:205]
    v_pk_fma_f32 v[206:207], v[198:199], v[86:87], v[206:207]
    v_mfma_f32_16x16x32_bf16 v[208:211], v[232:235], v[32:35], 0
    v_cvt_pk_bf16_f32 v224, v240, v241
    v_cvt_pk_bf16_f32 v228, v200, v201
    v_cvt_pk_bf16_f32 v225, v242, v243
    v_mfma_f32_16x16x32_bf16 v[208:211], v[236:239], v[48:51], v[208:211]
    v_cvt_pk_bf16_f32 v229, v202, v203
    ds_write_b64 v91, v[224:225] offset:16384
    ds_write_b64 v91, v[228:229] offset:20992
    v_mfma_f32_16x16x32_bf16 v[216:219], v[236:239], v[32:35], 0
    v_cvt_pk_bf16_f32 v226, v244, v245
    v_cvt_pk_bf16_f32 v230, v204, v205
    v_mfma_f32_16x16x32_bf16 v[216:219], v[232:235], v[40:43], v[216:219]
    v_cvt_pk_bf16_f32 v227, v246, v247
    v_cvt_pk_bf16_f32 v231, v206, v207
    v_mfma_f32_16x16x32_bf16 v[212:215], v[232:235], v[36:39], 0
    ds_write_b64 v91, v[226:227] offset:18688
    ds_write_b64 v91, v[230:231] offset:23296
    v_mfma_f32_16x16x32_bf16 v[212:215], v[236:239], v[52:55], v[212:215]
    buffer_load_dwordx4 a[164:167], v4, s[24:27], s81 offen offset:2048 sc1
    s_add_u32 s81, s81, 12288
    buffer_load_dwordx4 a[168:171], v4, s[24:27], s82 offen offset:0 sc1
    v_mfma_f32_16x16x32_bf16 v[220:223], v[236:239], v[36:39], 0
    v_lshlrev_b32 v192, 16, v96
    v_lshlrev_b32 v193, 16, v97
    v_mfma_f32_16x16x32_bf16 v[220:223], v[232:235], v[44:47], v[220:223]
    v_lshlrev_b32 v194, 16, v98
    v_lshlrev_b32 v195, 16, v99
    s_waitcnt lgkmcnt(0)
    s_barrier
    s_branch L_pgx9
L_pg9:
    s_setpc_b64 s[40:41]
L_pgx9:
    ds_read_b128 v[128:131], v92 offset:16384
    ds_read_b128 v[144:147], v92 offset:20992
    ds_read_b128 v[136:139], v92 offset:16448
    ds_read_b128 v[152:155], v92 offset:21056
    ds_read_b128 v[132:135], v92 offset:16960
    ds_read_b128 v[148:151], v92 offset:21568
    ds_read_b128 v[140:143], v92 offset:17024
    ds_read_b128 v[156:159], v92 offset:21632
    v_pk_mul_f32 v[240:241], v[208:209], v[72:73]
    v_pk_mul_f32 v[242:243], v[210:211], v[74:75]
    v_pk_mul_f32 v[244:245], v[212:213], v[76:77]
    v_pk_mul_f32 v[246:247], v[214:215], v[78:79]
    v_pk_fma_f32 v[240:241], v[216:217], v[80:81], v[240:241] neg_lo:[1,0,0] neg_hi:[1,0,0]
    v_pk_fma_f32 v[242:243], v[218:219], v[82:83], v[242:243] neg_lo:[1,0,0] neg_hi:[1,0,0]
    v_pk_fma_f32 v[244:245], v[220:221], v[84:85], v[244:245] neg_lo:[1,0,0] neg_hi:[1,0,0]
    v_pk_fma_f32 v[246:247], v[222:223], v[86:87], v[246:247] neg_lo:[1,0,0] neg_hi:[1,0,0]
    buffer_load_dwordx4 a[228:231], v4, s[24:27], s7 offen offset:0 sc1
    v_pk_mul_f32 v[216:217], v[216:217], v[72:73]
    v_pk_mul_f32 v[218:219], v[218:219], v[74:75]
    v_pk_mul_f32 v[220:221], v[220:221], v[76:77]
    v_pk_mul_f32 v[222:223], v[222:223], v[78:79]
    v_pk_fma_f32 v[216:217], v[208:209], v[80:81], v[216:217]
    v_pk_fma_f32 v[218:219], v[210:211], v[82:83], v[218:219]
    v_pk_fma_f32 v[220:221], v[212:213], v[84:85], v[220:221]
    v_pk_fma_f32 v[222:223], v[214:215], v[86:87], v[222:223]
    s_waitcnt lgkmcnt(6)
    v_mfma_f32_16x16x32_bf16 v[192:195], v[128:131], v[8:11], v[192:195]
    buffer_load_dwordx4 a[232:235], v4, s[24:27], s7 offen offset:1024 sc1
    v_lshlrev_b32 v196, 16, v100
    v_lshlrev_b32 v197, 16, v101
    v_mfma_f32_16x16x32_bf16 v[192:195], v[144:147], v[24:27], v[192:195]
    v_lshlrev_b32 v198, 16, v102
    v_lshlrev_b32 v199, 16, v103
    v_cvt_pk_bf16_f32 v232, v240, v241
    s_waitcnt lgkmcnt(4)
    v_mfma_f32_16x16x32_bf16 v[192:195], v[136:139], v[12:15], v[192:195]
    v_cvt_pk_bf16_f32 v236, v216, v217
    v_cvt_pk_bf16_f32 v233, v242, v243
    v_cvt_pk_bf16_f32 v237, v218, v219
    v_mfma_f32_16x16x32_bf16 v[192:195], v[152:155], v[28:31], v[192:195]
    ds_write_b64 v91, v[232:233] offset:25600
    ds_write_b64 v91, v[236:237] offset:30208
    s_waitcnt lgkmcnt(4)
    v_mfma_f32_16x16x32_bf16 v[196:199], v[132:135], v[8:11], v[196:199]
    buffer_load_dwordx4 a[236:239], v4, s[24:27], s7 offen offset:2048 sc1
    v_cvt_pk_bf16_f32 v234, v244, v245
    v_cvt_pk_bf16_f32 v238, v220, v221
    v_mfma_f32_16x16x32_bf16 v[196:199], v[148:151], v[24:27], v[196:199]
    v_cvt_pk_bf16_f32 v235, v246, v247
    v_cvt_pk_bf16_f32 v239, v222, v223
    ds_write_b64 v91, v[234:235] offset:27904
    s_waitcnt lgkmcnt(3)
    v_mfma_f32_16x16x32_bf16 v[196:199], v[140:143], v[12:15], v[196:199]
    ds_write_b64 v91, v[238:239] offset:32512
    v_and_b32 v200, 0xffff0000, v96
    v_and_b32 v201, 0xffff0000, v97
    v_mfma_f32_16x16x32_bf16 v[196:199], v[156:159], v[28:31], v[196:199]
    v_and_b32 v202, 0xffff0000, v98
    v_and_b32 v203, 0xffff0000, v99
    s_nop 1
    v_mfma_f32_16x16x32_bf16 v[200:203], v[144:147], v[8:11], v[200:203]
    v_and_b32 v204, 0xffff0000, v100
    v_and_b32 v205, 0xffff0000, v101
    v_mfma_f32_16x16x32_bf16 v[200:203], v[128:131], v[16:19], v[200:203]
    v_and_b32 v206, 0xffff0000, v102
    v_and_b32 v207, 0xffff0000, v103
    s_waitcnt lgkmcnt(0)
    s_barrier
    v_mfma_f32_16x16x32_bf16 v[200:203], v[152:155], v[12:15], v[200:203]
    ds_read_b128 v[160:163], v92 offset:25600
    ds_read_b128 v[176:179], v92 offset:30208
    ds_read_b128 v[168:171], v92 offset:25664
    v_mfma_f32_16x16x32_bf16 v[200:203], v[136:139], v[20:23], v[200:203]
    ds_read_b128 v[184:187], v92 offset:30272
    ds_read_b128 v[164:167], v92 offset:26176
    ds_read_b128 v[180:183], v92 offset:30784
    v_mfma_f32_16x16x32_bf16 v[204:207], v[148:151], v[8:11], v[204:207]
    ds_read_b128 v[172:175], v92 offset:26240
    ds_read_b128 v[188:191], v92 offset:30848
    v_mfma_f32_16x16x32_bf16 v[204:207], v[132:135], v[16:19], v[204:207]
    v_lshlrev_b32 v208, 16, v104
    v_lshlrev_b32 v209, 16, v105
    v_mfma_f32_16x16x32_bf16 v[204:207], v[156:159], v[12:15], v[204:207]
    v_lshlrev_b32 v210, 16, v106
    v_lshlrev_b32 v211, 16, v107
    v_mfma_f32_16x16x32_bf16 v[204:207], v[140:143], v[20:23], v[204:207]
    buffer_load_dwordx4 a[172:175], v4, s[24:27], s82 offen offset:1024 sc1
    buffer_load_dwordx4 a[176:179], v4, s[24:27], s82 offen offset:2048 sc1
    s_add_u32 s82, s82, 12288
    s_waitcnt lgkmcnt(6)
    v_mfma_f32_16x16x32_bf16 v[208:211], v[160:163], v[8:11], v[208:211]
    v_lshlrev_b32 v212, 16, v108
    v_lshlrev_b32 v213, 16, v109
    v_lshlrev_b32 v214, 16, v110
    v_mfma_f32_16x16x32_bf16 v[208:211], v[176:179], v[24:27], v[208:211]
    v_lshlrev_b32 v215, 16, v111
    buffer_load_dwordx4 a[180:183], v4, s[24:27], s83 offen offset:0 sc1
    s_waitcnt lgkmcnt(4)
    v_mfma_f32_16x16x32_bf16 v[208:211], v[168:171], v[12:15], v[208:211]
    v_cvt_pk_bf16_f32 v224, v192, v193
    v_cvt_pk_bf16_f32 v225, v194, v195
    v_mfma_f32_16x16x32_bf16 v[208:211], v[184:187], v[28:31], v[208:211]
    v_cvt_pk_bf16_f32 v226, v196, v197
    v_cvt_pk_bf16_f32 v227, v198, v199
    s_waitcnt lgkmcnt(2)
    v_mfma_f32_16x16x32_bf16 v[212:215], v[164:167], v[8:11], v[212:215]
    buffer_store_dwordx4 v[224:227], v248, s[24:27], s58 offen offset:0 sc1
    v_and_b32 v216, 0xffff0000, v104
    v_and_b32 v217, 0xffff0000, v105
    v_mfma_f32_16x16x32_bf16 v[212:215], v[180:183], v[24:27], v[212:215]
    v_and_b32 v218, 0xffff0000, v106
    v_and_b32 v219, 0xffff0000, v107
    s_waitcnt lgkmcnt(0)
    v_mfma_f32_16x16x32_bf16 v[212:215], v[172:175], v[12:15], v[212:215]
    v_and_b32 v220, 0xffff0000, v108
    v_and_b32 v221, 0xffff0000, v109
    v_mfma_f32_16x16x32_bf16 v[212:215], v[188:191], v[28:31], v[212:215]
    v_and_b32 v222, 0xffff0000, v110
    v_and_b32 v223, 0xffff0000, v111
    v_mfma_f32_16x16x32_bf16 v[216:219], v[176:179], v[8:11], v[216:219]
    v_cvt_pk_bf16_f32 v228, v200, v201
    v_cvt_pk_bf16_f32 v229, v202, v203
    v_mfma_f32_16x16x32_bf16 v[216:219], v[160:163], v[16:19], v[216:219]
    v_cvt_pk_bf16_f32 v230, v204, v205
    v_cvt_pk_bf16_f32 v231, v206, v207
    v_mfma_f32_16x16x32_bf16 v[216:219], v[184:187], v[12:15], v[216:219]
    buffer_store_dwordx4 v[228:231], v248, s[24:27], s58 offen offset:1024 sc1
    v_cvt_pk_bf16_f32 v232, v208, v209
    v_mfma_f32_16x16x32_bf16 v[216:219], v[168:171], v[20:23], v[216:219]
    v_cvt_pk_bf16_f32 v233, v210, v211
    v_cvt_pk_bf16_f32 v234, v212, v213
    v_mfma_f32_16x16x32_bf16 v[220:223], v[180:183], v[8:11], v[220:223]
    v_cvt_pk_bf16_f32 v235, v214, v215
    v_mfma_f32_16x16x32_bf16 v[220:223], v[164:167], v[16:19], v[220:223]
    buffer_store_dwordx4 v[232:235], v248, s[24:27], s58 offen offset:64 sc1
    v_mfma_f32_16x16x32_bf16 v[220:223], v[188:191], v[12:15], v[220:223]
    s_nop 0
    v_cvt_pk_bf16_f32 v236, v216, v217
    v_mfma_f32_16x16x32_bf16 v[220:223], v[172:175], v[20:23], v[220:223]
    v_cvt_pk_bf16_f32 v237, v218, v219
    s_nop 6
    v_cvt_pk_bf16_f32 v238, v220, v221
    v_cvt_pk_bf16_f32 v239, v222, v223
    buffer_store_dwordx4 v[236:239], v248, s[24:27], s58 offen offset:1088 sc1
L_join_73:
    s_lshl_b32 s46, s67, 15
    s_sub_u32 s46, 33280, s46
    v_mul_u32_u24 v240, 4096, v1
    v_mov_b32 v241, s46
    buffer_load_dwordx4 a[184:187], v4, s[24:27], s83 offen offset:1024 sc1
    s_and_b32 s95, s36, 7
    s_lshr_b32 s96, s36, 3
    s_lshl_b32 s85, s32, 11
    s_mul_i32 s84, s35, 164480
    s_add_u32 s84, s84, 8380416
    v_add_u32 v133, s84, v4
    s_mul_i32 s46, s35, 393216
    s_add_u32 s46, s46, 17358848
    s_lshl_b32 s47, s36, 2
    s_add_u32 s47, s47, s32
    s_mul_i32 s47, s47, 768
    s_add_u32 s86, s46, s47
    s_mul_i32 s47, s96, 49152
    s_mul_i32 s48, s32, 12288
    s_add_u32 s87, s46, s47
    s_add_u32 s87, s87, s48
    s_lshl_b32 s48, s95, 2
    s_add_u32 s48, s48, s32
    s_mul_i32 s88, s48, 61440
    s_add_u32 s88, s88, 29548544
    s_mul_i32 s89, s48, 15360
    s_add_u32 s89, s89, 34177024
    s_mul_i32 s48, s35, 2048
    s_add_u32 s48, s48, 128
    s_lshr_b32 s49, s36, 2
    s_mul_i32 s49, s49, 512
    s_add_u32 s90, s48, s49
    s_mul_i32 s49, s32, 512
    s_add_u32 s91, s48, s49
    v_xor_b32 v5, s96, v3
    v_mul_u32_u24 v5, 49152, v5
    v_lshl_add_u32 v16, v2, 4, v5
    buffer_load_dwordx4 a[188:191], v4, s[24:27], s83 offen offset:2048 sc1
    s_add_u32 s83, s83, 12288
    v_lshrrev_b32 v5, 1, v3
    v_mul_u32_u24 v5, 98048, v5
    v_sub_u32 v17, v16, v5
    s_add_u32 s78, s86, 196608
    s_add_u32 s79, s86, 294912
    v_lshrrev_b32 v5, 2, v1
    v_lshlrev_b32 v5, 6, v5
    v_and_b32 v6, 3, v1
    v_lshl_add_u32 v5, v6, 3, v5
    v_xor_b32 v6, s96, v3
    v_and_b32 v6, 1, v6
    v_lshl_add_u32 v5, v6, 5, v5
    v_xor_b32 v6, 32, v5
    s_xor_b32 s46, s32, 0
    s_lshl_b32 s46, s46, 11
    v_add_u32 v8, s46, v5
    v_add_u32 v12, s46, v6
    s_xor_b32 s46, s32, 1
    s_lshl_b32 s46, s46, 11
    v_add_u32 v9, s46, v5
    v_add_u32 v13, s46, v6
    s_xor_b32 s46, s32, 2
    s_lshl_b32 s46, s46, 11
    v_add_u32 v10, s46, v5
    v_add_u32 v14, s46, v6
    s_xor_b32 s46, s32, 3
    s_lshl_b32 s46, s46, 11
    v_add_u32 v11, s46, v5
    v_add_u32 v15, s46, v6
    v_lshlrev_b32 v19, 28, v2
    v_lshl_or_b32 v19, v3, 28, v19
    buffer_load_dwordx4 a[192:195], v4, s[24:27], s80 offen offset:0 sc1
    s_mov_b32 s66, 0x00f0000f
    s_mov_b32 s67, 0xf0000f00
    s_cmp_eq_u32 s32, 0
    s_cselect_b32 s64, 0xffff, 0
    s_mov_b32 s65, 0
    v_mov_b32 v5, 0xffff0000
    v_cndmask_b32 v21, -1, v5, s[64:65]
    s_lshl_b32 s46, s35, 3
    s_add_u32 s46, s46, s96
    s_mov_b32 s28, s18
    s_mov_b32 s29, s19
    s_mov_b32 s30, 2621440
    s_mov_b32 s31, 0x20000
    s_lshl1_add_u32 s46, s35, s96
    s_mul_i32 s92, s46, 81920
    s_mul_i32 s47, s95, 80
    s_add_u32 s92, s92, s47
    s_bitcmp1_b32 s32, 0
    s_cselect_b32 s47, 40, 0
    s_add_u32 s92, s92, s47
    s_bitcmp1_b32 s32, 1
    s_cselect_b32 s47, 640, 0
    s_cselect_b32 s94, -1.0, 1.0
    s_add_u32 s92, s92, s47
    v_and_b32 v5, 8, v2
    v_mad_u32_u24 v5, v5, 3, v2
    v_mul_u32_u24 v5, 1280, v5
    v_lshl_add_u32 v22, v3, 3, v5
    v_mul_u32_u24 v6, 10240, v3
    v_add_u32 v23, v5, v6
    v_mul_u32_u24 v104, 512, v2
    buffer_load_dwordx4 v[160:163], v4, s[24:27], s89 offen offset:0 sc1
    buffer_load_dwordx4 v[164:167], v4, s[24:27], s89 offen offset:1024 sc1
    v_mov_b32 v106, 0
    s_cmp_ge_u32 s34, 8
    s_cbranch_scc1 L_ns_82
    s_cmp_lg_u32 s32, 0
    s_cbranch_scc1 L_sm_83
    v_mov_b32 v106, 0
    s_mov_b64 exec, 0xff
    buffer_atomic_add v106, v104, s[24:27], s97 offen offset:4 sc0 sc1
    s_mov_b64 exec, -1
L_sm_83:
L_ns_82:
    s_cmp_eq_u32 s32, 0
    s_cselect_b32 s46, 0xff, 0
    s_mov_b32 s47, 0
    v_mov_b32 v108, 802816
    v_cndmask_b32 v107, -2.0, v104, s[46:47]
    v_cndmask_b32 v108, 0, v108, s[46:47]
    s_waitcnt vmcnt(5)
    s_barrier
    s_cmp_lg_u32 s32, 0
    s_cbranch_scc1 L_sg_84
    s_mov_b64 exec, 0xffff
    buffer_atomic_add v241, v240, s[24:27], s43 offen offset:4 sc1
    s_mov_b64 exec, -1
L_sg_84:
    s_cmp_lt_u32 s34, 8
    s_cbranch_scc1 L_we_85
    buffer_load_dwordx4 a[208:211], v4, s[24:27], s5 offen offset:1024 sc1
    buffer_load_dwordx4 a[212:215], v4, s[24:27], s5 offen offset:2048 sc1
    buffer_load_dwordx4 a[216:219], v4, s[24:27], s6 offen offset:0 sc1
    buffer_load_dwordx4 a[220:223], v4, s[24:27], s6 offen offset:1024 sc1
    buffer_load_dwordx4 a[224:227], v4, s[24:27], s6 offen offset:2048 sc1
    buffer_load_dwordx4 a[228:231], v4, s[24:27], s7 offen offset:0 sc1
    buffer_load_dwordx4 a[232:235], v4, s[24:27], s7 offen offset:1024 sc1
    buffer_load_dwordx4 a[236:239], v4, s[24:27], s7 offen offset:2048 sc1
    s_waitcnt vmcnt(9)
    s_cmp_lg_u32 s32, 0
    s_cbranch_scc1 L_sm_86
    v_mov_b32 v106, 0
    s_mov_b64 exec, 0xff
    buffer_atomic_add v106, v104, s[24:27], s97 offen offset:4 sc0 sc1
    s_mov_b64 exec, -1
L_sm_86:
    s_waitcnt vmcnt(0)
L_we_85:
L_c1:
    s_cmp_lg_u32 s32, 0
    s_cbranch_scc1 L_pe_90
    s_mov_b32 s42, 65536
    s_mov_b64 exec, 0xff
    s_waitcnt vmcnt(1)
    s_branch L_pc_88
L_pl_87:
    v_mov_b32 v106, 0
    buffer_atomic_add v106, v104, s[24:27], s97 offen offset:4 sc0 sc1
    s_waitcnt vmcnt(0)
L_pc_88:
    v_and_b32 v105, 786432, v106
    v_cmp_ne_u32 vcc, 786432, v105
    s_cbranch_vccz L_pd_89
    s_sub_u32 s42, s42, 1
    s_cbranch_scc0 L_pl_87
L_pd_89:
    s_mov_b64 exec, -1
L_pe_90:
    s_barrier
    s_add_u32 m0, s85, 0
    s_nop 0
    buffer_load_dwordx4 v133, s[24:27], m0 offen offset:0 sc1 lds
    buffer_load_dwordx4 v133, s[24:27], m0 offen offset:1024 sc1 lds
    s_add_u32 m0, s85, 40960
    s_nop 0
    buffer_load_dwordx4 v133, s[24:27], m0 offen offset:0 sc1 lds
    buffer_load_dwordx4 v133, s[24:27], m0 offen offset:1024 sc1 lds
    buffer_load_dwordx4 v[168:171], v4, s[24:27], s89 offen offset:2048 sc1
    s_add_u32 m0, s85, 8192
    s_nop 0
    buffer_load_dwordx4 v133, s[24:27], m0 offen offset:0 sc1 lds
    buffer_load_dwordx4 v133, s[24:27], m0 offen offset:1024 sc1 lds
    s_add_u32 m0, s85, 49152
    s_nop 0
    buffer_load_dwordx4 v133, s[24:27], m0 offen offset:0 sc1 lds
    buffer_load_dwordx4 v133, s[24:27], m0 offen offset:1024 sc1 lds
    buffer_load_dwordx4 v[172:175], v4, s[24:27], s89 offen offset:3072 sc1
    s_add_u32 s74, s89, 4096
    buffer_load_dwordx4 v[176:179], v4, s[24:27], s74 offen offset:0 sc1
    s_waitcnt vmcnt(9)
    s_waitcnt vmcnt(7)
    s_barrier
    ds_read_b64_tr_b16 v[24:25], v8 offset:0
    ds_read_b64_tr_b16 v[26:27], v8 offset:1024
    ds_read_b64_tr_b16 v[28:29], v9 offset:0
    ds_read_b64_tr_b16 v[30:31], v9 offset:1024
    ds_read_b64_tr_b16 v[32:33], v12 offset:0
    ds_read_b64_tr_b16 v[34:35], v12 offset:1024
    ds_read_b64_tr_b16 v[36:37], v13 offset:0
    ds_read_b64_tr_b16 v[38:39], v13 offset:1024
    ds_read_b64_tr_b16 v[40:41], v8 offset:40960
    ds_read_b64_tr_b16 v[42:43], v8 offset:41984
    ds_read_b64_tr_b16 v[44:45], v9 offset:40960
    ds_read_b64_tr_b16 v[46:47], v9 offset:41984
    s_waitcnt lgkmcnt(8)
    v_mfma_f32_16x16x32_bf16 v[136:139], v[160:163], v[24:27], 0
    ds_read_b64_tr_b16 v[48:49], v12 offset:40960
    v_mfma_f32_16x16x32_bf16 v[140:143], v[164:167], v[24:27], 0
    ds_read_b64_tr_b16 v[50:51], v12 offset:41984
    s_waitcnt vmcnt(6)
    v_mfma_f32_16x16x32_bf16 v[144:147], v[168:171], v[24:27], 0
    ds_read_b64_tr_b16 v[52:53], v13 offset:40960
    v_mfma_f32_16x16x32_bf16 v[56:59], a[0:3], v[24:27], 0
    ds_read_b64_tr_b16 v[54:55], v13 offset:41984
    v_mfma_f32_16x16x32_bf16 v[56:59], a[12:15], v[28:31], v[56:59]
    buffer_load_dwordx4 v[180:183], v4, s[24:27], s74 offen offset:1024 sc1
    v_mfma_f32_16x16x32_bf16 v[60:63], a[4:7], v[24:27], 0
    v_mfma_f32_16x16x32_bf16 v[60:63], a[16:19], v[28:31], v[60:63]
    v_mfma_f32_16x16x32_bf16 v[64:67], a[8:11], v[24:27], 0
    v_and_b32 v26, v21, v26
    v_mfma_f32_16x16x32_bf16 v[64:67], a[20:23], v[28:31], v[64:67]
    s_add_u32 m0, s85, 16384
    v_mfma_f32_16x16x32_bf16 a[240:243], v[24:27], v[24:27], 0
    buffer_load_dwordx4 v133, s[24:27], m0 offen offset:0 sc1 lds
    s_waitcnt lgkmcnt(8)
    v_mfma_f32_16x16x32_bf16 v[68:71], a[0:3], v[32:35], 0
    ds_read_b64_tr_b16 v[24:25], v10 offset:0
    v_mfma_f32_16x16x32_bf16 v[68:71], a[12:15], v[36:39], v[68:71]
    ds_read_b64_tr_b16 v[26:27], v10 offset:1024
    v_mfma_f32_16x16x32_bf16 v[72:75], a[4:7], v[32:35], 0
    ds_read_b64_tr_b16 v[28:29], v11 offset:0
    v_mfma_f32_16x16x32_bf16 v[72:75], a[16:19], v[36:39], v[72:75]
    ds_read_b64_tr_b16 v[30:31], v11 offset:1024
    v_mfma_f32_16x16x32_bf16 v[76:79], a[8:11], v[32:35], 0
    buffer_load_dwordx4 v133, s[24:27], m0 offen offset:1024 sc1 lds
    v_mfma_f32_16x16x32_bf16 v[76:79], a[20:23], v[36:39], v[76:79]
    s_waitcnt lgkmcnt(8)
    v_mfma_f32_16x16x32_bf16 v[148:151], v[160:163], v[40:43], 0
    ds_read_b64_tr_b16 v[32:33], v14 offset:0
    v_mfma_f32_16x16x32_bf16 v[152:155], v[164:167], v[40:43], 0
    ds_read_b64_tr_b16 v[34:35], v14 offset:1024
    s_add_u32 m0, s85, 57344
    v_mfma_f32_16x16x32_bf16 v[156:159], v[168:171], v[40:43], 0
    ds_read_b64_tr_b16 v[36:37], v15 offset:0
    v_mfma_f32_16x16x32_bf16 v[80:83], a[0:3], v[40:43], 0
    ds_read_b64_tr_b16 v[38:39], v15 offset:1024
    buffer_load_dwordx4 v133, s[24:27], m0 offen offset:0 sc1 lds
    v_mfma_f32_16x16x32_bf16 v[80:83], a[12:15], v[44:47], v[80:83]
    v_mfma_f32_16x16x32_bf16 v[84:87], a[4:7], v[40:43], 0
    v_mfma_f32_16x16x32_bf16 v[84:87], a[16:19], v[44:47], v[84:87]
    buffer_load_dwordx4 v133, s[24:27], m0 offen offset:1024 sc1 lds
    v_mfma_f32_16x16x32_bf16 v[88:91], a[8:11], v[40:43], 0
    v_and_b32 v42, v21, v42
    v_mfma_f32_16x16x32_bf16 v[88:91], a[20:23], v[44:47], v[88:91]
    s_nop 0
    v_mfma_f32_16x16x32_bf16 a[244:247], v[40:43], v[40:43], 0
    s_waitcnt lgkmcnt(8)
    v_mfma_f32_16x16x32_bf16 v[92:95], a[0:3], v[48:51], 0
    ds_read_b64_tr_b16 v[40:41], v10 offset:40960
    v_mov_b32 v18, 0
    v_mfma_f32_16x16x32_bf16 v[92:95], a[12:15], v[52:55], v[92:95]
    ds_read_b64_tr_b16 v[42:43], v10 offset:41984
    buffer_atomic_add v18, v107, s[24:27], s97 offen offset:4 sc0 sc1
    v_mfma_f32_16x16x32_bf16 v[96:99], a[4:7], v[48:51], 0
    ds_read_b64_tr_b16 v[44:45], v11 offset:40960
    buffer_load_dwordx4 v[184:187], v4, s[24:27], s74 offen offset:2048 sc1
    v_mfma_f32_16x16x32_bf16 v[96:99], a[16:19], v[52:55], v[96:99]
    ds_read_b64_tr_b16 v[46:47], v11 offset:41984
    v_mfma_f32_16x16x32_bf16 v[100:103], a[8:11], v[48:51], 0
    v_mfma_f32_16x16x32_bf16 v[100:103], a[20:23], v[52:55], v[100:103]
    buffer_load_dwordx4 v[188:191], v4, s[24:27], s74 offen offset:3072 sc1
    s_waitcnt lgkmcnt(8)
    v_mfma_f32_16x16x32_bf16 v[56:59], a[24:27], v[24:27], v[56:59]
    ds_read_b64_tr_b16 v[48:49], v14 offset:40960
    v_mfma_f32_16x16x32_bf16 v[56:59], a[36:39], v[28:31], v[56:59]
    ds_read_b64_tr_b16 v[50:51], v14 offset:41984
    v_mfma_f32_16x16x32_bf16 v[60:63], a[28:31], v[24:27], v[60:63]
    ds_read_b64_tr_b16 v[52:53], v15 offset:40960
    v_mfma_f32_16x16x32_bf16 v[60:63], a[40:43], v[28:31], v[60:63]
    ds_read_b64_tr_b16 v[54:55], v15 offset:41984
    s_add_u32 s74, s89, 8192
    v_mfma_f32_16x16x32_bf16 v[64:67], a[32:35], v[24:27], v[64:67]
    buffer_load_dwordx4 v[192:195], v4, s[24:27], s74 offen offset:0 sc1
    v_mfma_f32_16x16x32_bf16 v[64:67], a[44:47], v[28:31], v[64:67]
    s_waitcnt lgkmcnt(8)
    v_mfma_f32_16x16x32_bf16 v[68:71], a[24:27], v[32:35], v[68:71]
    s_waitcnt vmcnt(11)
    s_barrier
    v_mfma_f32_16x16x32_bf16 v[68:71], a[36:39], v[36:39], v[68:71]
    ds_read_b64_tr_b16 v[24:25], v8 offset:8192
    v_mfma_f32_16x16x32_bf16 v[72:75], a[28:31], v[32:35], v[72:75]
    ds_read_b64_tr_b16 v[26:27], v8 offset:9216
    v_mfma_f32_16x16x32_bf16 v[72:75], a[40:43], v[36:39], v[72:75]
    ds_read_b64_tr_b16 v[28:29], v9 offset:8192
    buffer_load_dwordx4 v[196:199], v4, s[24:27], s74 offen offset:1024 sc1
    v_mfma_f32_16x16x32_bf16 v[76:79], a[32:35], v[32:35], v[76:79]
    ds_read_b64_tr_b16 v[30:31], v9 offset:9216
    v_mfma_f32_16x16x32_bf16 v[76:79], a[44:47], v[36:39], v[76:79]
    s_waitcnt lgkmcnt(8)
    v_mfma_f32_16x16x32_bf16 v[80:83], a[24:27], v[40:43], v[80:83]
    ds_read_b64_tr_b16 v[32:33], v12 offset:8192
    v_mfma_f32_16x16x32_bf16 v[80:83], a[36:39], v[44:47], v[80:83]
    ds_read_b64_tr_b16 v[34:35], v12 offset:9216
    buffer_load_dwordx4 v[200:203], v4, s[24:27], s74 offen offset:2048 sc1
    v_mfma_f32_16x16x32_bf16 v[84:87], a[28:31], v[40:43], v[84:87]
    ds_read_b64_tr_b16 v[36:37], v13 offset:8192
    v_mfma_f32_16x16x32_bf16 v[84:87], a[40:43], v[44:47], v[84:87]
    ds_read_b64_tr_b16 v[38:39], v13 offset:9216
    v_mfma_f32_16x16x32_bf16 v[88:91], a[32:35], v[40:43], v[88:91]
    buffer_load_dwordx4 v[204:207], v4, s[24:27], s74 offen offset:3072 sc1
    v_mfma_f32_16x16x32_bf16 v[88:91], a[44:47], v[44:47], v[88:91]
    s_waitcnt lgkmcnt(8)
    v_mfma_f32_16x16x32_bf16 v[92:95], a[24:27], v[48:51], v[92:95]
    ds_read_b64_tr_b16 v[40:41], v8 offset:49152
    v_mfma_f32_16x16x32_bf16 v[92:95], a[36:39], v[52:55], v[92:95]
    ds_read_b64_tr_b16 v[42:43], v8 offset:50176
    v_mfma_f32_16x16x32_bf16 v[96:99], a[28:31], v[48:51], v[96:99]
    ds_read_b64_tr_b16 v[44:45], v9 offset:49152
    s_add_u32 m0, s85, 81920
    v_mfma_f32_16x16x32_bf16 v[96:99], a[40:43], v[52:55], v[96:99]
    ds_read_b64_tr_b16 v[46:47], v9 offset:50176
    v_mfma_f32_16x16x32_bf16 v[100:103], a[32:35], v[48:51], v[100:103]
    buffer_load_dwordx4 v133, s[24:27], m0 offen offset:0 sc1 lds
    v_mfma_f32_16x16x32_bf16 v[100:103], a[44:47], v[52:55], v[100:103]
    s_waitcnt lgkmcnt(8)
    s_waitcnt vmcnt(14)
    v_mfma_f32_16x16x32_bf16 v[136:139], v[172:175], v[24:27], v[136:139]
    ds_read_b64_tr_b16 v[48:49], v12 offset:49152
    s_waitcnt vmcnt(13)
    v_mfma_f32_16x16x32_bf16 v[140:143], v[176:179], v[24:27], v[140:143]
    ds_read_b64_tr_b16 v[50:51], v12 offset:50176
    s_waitcnt vmcnt(12)
    v_mfma_f32_16x16x32_bf16 v[144:147], v[180:183], v[24:27], v[144:147]
    ds_read_b64_tr_b16 v[52:53], v13 offset:49152
    v_mfma_f32_16x16x32_bf16 v[56:59], a[48:51], v[24:27], v[56:59]
    ds_read_b64_tr_b16 v[54:55], v13 offset:50176
    buffer_load_dwordx4 v133, s[24:27], m0 offen offset:1024 sc1 lds
    v_mfma_f32_16x16x32_bf16 v[56:59], a[60:63], v[28:31], v[56:59]
    v_mfma_f32_16x16x32_bf16 v[60:63], a[52:55], v[24:27], v[60:63]
    s_add_u32 s74, s89, 12288
    v_mfma_f32_16x16x32_bf16 v[60:63], a[64:67], v[28:31], v[60:63]
    buffer_load_dwordx4 v[208:211], v4, s[24:27], s74 offen offset:0 sc1
    v_mfma_f32_16x16x32_bf16 v[64:67], a[56:59], v[24:27], v[64:67]
    v_mfma_f32_16x16x32_bf16 v[64:67], a[68:71], v[28:31], v[64:67]
    v_mfma_f32_16x16x32_bf16 a[240:243], v[24:27], v[24:27], a[240:243]
    s_waitcnt lgkmcnt(8)
    v_mfma_f32_16x16x32_bf16 v[68:71], a[48:51], v[32:35], v[68:71]
    ds_read_b64_tr_b16 v[24:25], v10 offset:8192
    v_mfma_f32_16x16x32_bf16 v[68:71], a[60:63], v[36:39], v[68:71]
    ds_read_b64_tr_b16 v[26:27], v10 offset:9216
    v_mfma_f32_16x16x32_bf16 v[72:75], a[52:55], v[32:35], v[72:75]
    ds_read_b64_tr_b16 v[28:29], v11 offset:8192
    buffer_load_dwordx4 v[212:215], v4, s[24:27], s74 offen offset:1024 sc1
    v_mfma_f32_16x16x32_bf16 v[72:75], a[64:67], v[36:39], v[72:75]
    ds_read_b64_tr_b16 v[30:31], v11 offset:9216
    v_mfma_f32_16x16x32_bf16 v[76:79], a[56:59], v[32:35], v[76:79]
    v_mfma_f32_16x16x32_bf16 v[76:79], a[68:71], v[36:39], v[76:79]
    buffer_load_dwordx4 v[216:219], v4, s[24:27], s74 offen offset:2048 sc1
    s_waitcnt lgkmcnt(8)
    v_mfma_f32_16x16x32_bf16 v[148:151], v[172:175], v[40:43], v[148:151]
    ds_read_b64_tr_b16 v[32:33], v14 offset:8192
    v_mfma_f32_16x16x32_bf16 v[152:155], v[176:179], v[40:43], v[152:155]
    ds_read_b64_tr_b16 v[34:35], v14 offset:9216
    v_mfma_f32_16x16x32_bf16 v[156:159], v[180:183], v[40:43], v[156:159]
    ds_read_b64_tr_b16 v[36:37], v15 offset:8192
    v_mfma_f32_16x16x32_bf16 v[80:83], a[48:51], v[40:43], v[80:83]
    ds_read_b64_tr_b16 v[38:39], v15 offset:9216
    v_mfma_f32_16x16x32_bf16 v[80:83], a[60:63], v[44:47], v[80:83]
    buffer_load_dwordx4 a[196:199], v4, s[24:27], s80 offen offset:1024 sc1
    v_mfma_f32_16x16x32_bf16 v[84:87], a[52:55], v[40:43], v[84:87]
    v_mfma_f32_16x16x32_bf16 v[84:87], a[64:67], v[44:47], v[84:87]
    v_mfma_f32_16x16x32_bf16 v[88:91], a[56:59], v[40:43], v[88:91]
    v_mfma_f32_16x16x32_bf16 v[88:91], a[68:71], v[44:47], v[88:91]
    v_mfma_f32_16x16x32_bf16 a[244:247], v[40:43], v[40:43], a[244:247]
    buffer_load_dwordx4 a[200:203], v4, s[24:27], s80 offen offset:2048 sc1
    s_waitcnt lgkmcnt(8)
    v_mfma_f32_16x16x32_bf16 v[92:95], a[48:51], v[48:51], v[92:95]
    ds_read_b64_tr_b16 v[40:41], v10 offset:49152
    v_mfma_f32_16x16x32_bf16 v[92:95], a[60:63], v[52:55], v[92:95]
    ds_read_b64_tr_b16 v[42:43], v10 offset:50176
    v_mfma_f32_16x16x32_bf16 v[96:99], a[52:55], v[48:51], v[96:99]
    ds_read_b64_tr_b16 v[44:45], v11 offset:49152
    v_mfma_f32_16x16x32_bf16 v[96:99], a[64:67], v[52:55], v[96:99]
    ds_read_b64_tr_b16 v[46:47], v11 offset:50176
    v_mfma_f32_16x16x32_bf16 v[100:103], a[56:59], v[48:51], v[100:103]
    buffer_load_dwordx4 a[204:207], v4, s[24:27], s81 offen offset:0 sc1
    v_mfma_f32_16x16x32_bf16 v[100:103], a[68:71], v[52:55], v[100:103]
    s_waitcnt lgkmcnt(8)
    v_mfma_f32_16x16x32_bf16 v[56:59], a[72:75], v[24:27], v[56:59]
    ds_read_b64_tr_b16 v[48:49], v14 offset:49152
    v_mfma_f32_16x16x32_bf16 v[56:59], a[84:87], v[28:31], v[56:59]
    ds_read_b64_tr_b16 v[50:51], v14 offset:50176
    s_add_u32 m0, s85, 90112
    v_mfma_f32_16x16x32_bf16 v[60:63], a[76:79], v[24:27], v[60:63]
    ds_read_b64_tr_b16 v[52:53], v15 offset:49152
    v_mfma_f32_16x16x32_bf16 v[60:63], a[88:91], v[28:31], v[60:63]
    ds_read_b64_tr_b16 v[54:55], v15 offset:50176
    buffer_load_dwordx4 v133, s[24:27], m0 offen offset:0 sc1 lds
    v_mfma_f32_16x16x32_bf16 v[64:67], a[80:83], v[24:27], v[64:67]
    s_waitcnt vmcnt(15)
    v_cmp_gt_u32 vcc, v108, v18
    s_cbranch_vccnz L_fw_91
L_fd_93:
    v_mfma_f32_16x16x32_bf16 v[64:67], a[92:95], v[28:31], v[64:67]
    s_waitcnt lgkmcnt(8)
    v_mfma_f32_16x16x32_bf16 v[68:71], a[72:75], v[32:35], v[68:71]
    s_barrier
    s_add_u32 m0, s85, 24576
    v_mfma_f32_16x16x32_bf16 v[68:71], a[84:87], v[36:39], v[68:71]
    ds_read_b64_tr_b16 v[24:25], v8 offset:16384
    buffer_load_dwordx4 v133, s[24:27], m0 offen offset:0 sc1 lds
    v_mfma_f32_16x16x32_bf16 v[72:75], a[76:79], v[32:35], v[72:75]
    ds_read_b64_tr_b16 v[26:27], v8 offset:17408
    v_mfma_f32_16x16x32_bf16 v[72:75], a[88:91], v[36:39], v[72:75]
    ds_read_b64_tr_b16 v[28:29], v9 offset:16384
    buffer_load_dwordx4 v133, s[24:27], m0 offen offset:1024 sc1 lds
    v_mfma_f32_16x16x32_bf16 v[76:79], a[80:83], v[32:35], v[76:79]
    ds_read_b64_tr_b16 v[30:31], v9 offset:17408
    v_mfma_f32_16x16x32_bf16 v[76:79], a[92:95], v[36:39], v[76:79]
    s_waitcnt lgkmcnt(8)
    v_mfma_f32_16x16x32_bf16 v[80:83], a[72:75], v[40:43], v[80:83]
    ds_read_b64_tr_b16 v[32:33], v12 offset:16384
    s_add_u32 m0, s85, 65536
    v_mfma_f32_16x16x32_bf16 v[80:83], a[84:87], v[44:47], v[80:83]
    ds_read_b64_tr_b16 v[34:35], v12 offset:17408
    buffer_load_dwordx4 v133, s[24:27], m0 offen offset:0 sc1 lds
    v_mfma_f32_16x16x32_bf16 v[84:87], a[76:79], v[40:43], v[84:87]
    ds_read_b64_tr_b16 v[36:37], v13 offset:16384
    v_mfma_f32_16x16x32_bf16 v[84:87], a[88:91], v[44:47], v[84:87]
    ds_read_b64_tr_b16 v[38:39], v13 offset:17408
    v_mfma_f32_16x16x32_bf16 v[88:91], a[80:83], v[40:43], v[88:91]
    v_mfma_f32_16x16x32_bf16 v[88:91], a[92:95], v[44:47], v[88:91]
    buffer_load_dwordx4 v133, s[24:27], m0 offen offset:1024 sc1 lds
    s_waitcnt lgkmcnt(8)
    v_mfma_f32_16x16x32_bf16 v[92:95], a[72:75], v[48:51], v[92:95]
    ds_read_b64_tr_b16 v[40:41], v8 offset:57344
    v_mfma_f32_16x16x32_bf16 v[92:95], a[84:87], v[52:55], v[92:95]
    ds_read_b64_tr_b16 v[42:43], v8 offset:58368
    v_mfma_f32_16x16x32_bf16 v[96:99], a[76:79], v[48:51], v[96:99]
    ds_read_b64_tr_b16 v[44:45], v9 offset:57344
    v_mfma_f32_16x16x32_bf16 v[96:99], a[88:91], v[52:55], v[96:99]
    ds_read_b64_tr_b16 v[46:47], v9 offset:58368
    s_add_u32 m0, s85, 32768
    v_mfma_f32_16x16x32_bf16 v[100:103], a[80:83], v[48:51], v[100:103]
    buffer_load_dwordx4 v133, s[24:27], m0 offen offset:0 sc1 lds
    v_mfma_f32_16x16x32_bf16 v[100:103], a[92:95], v[52:55], v[100:103]
    s_waitcnt lgkmcnt(8)
    s_waitcnt vmcnt(19)
    v_mfma_f32_16x16x32_bf16 v[136:139], v[184:187], v[24:27], v[136:139]
    ds_read_b64_tr_b16 v[48:49], v12 offset:57344
    s_waitcnt vmcnt(18)
    v_mfma_f32_16x16x32_bf16 v[140:143], v[188:191], v[24:27], v[140:143]
    ds_read_b64_tr_b16 v[50:51], v12 offset:58368
    s_waitcnt vmcnt(17)
    v_mfma_f32_16x16x32_bf16 v[144:147], v[192:195], v[24:27], v[144:147]
    ds_read_b64_tr_b16 v[52:53], v13 offset:57344
    v_mfma_f32_16x16x32_bf16 v[56:59], a[96:99], v[24:27], v[56:59]
    s_branch L_pgx10
L_pg10:
    s_setpc_b64 s[40:41]
L_pgx10:
    ds_read_b64_tr_b16 v[54:55], v13 offset:58368
    v_mfma_f32_16x16x32_bf16 v[56:59], a[108:111], v[28:31], v[56:59]
    buffer_load_dwordx4 v133, s[24:27], m0 offen offset:1024 sc1 lds
    v_mfma_f32_16x16x32_bf16 v[60:63], a[100:103], v[24:27], v[60:63]
    v_mfma_f32_16x16x32_bf16 v[60:63], a[112:115], v[28:31], v[60:63]
    s_add_u32 m0, s85, 73728
    v_mfma_f32_16x16x32_bf16 v[64:67], a[104:107], v[24:27], v[64:67]
    buffer_load_dwordx4 v133, s[24:27], m0 offen offset:0 sc1 lds
    v_mfma_f32_16x16x32_bf16 v[64:67], a[116:119], v[28:31], v[64:67]
    v_mfma_f32_16x16x32_bf16 a[240:243], v[24:27], v[24:27], a[240:243]
    s_waitcnt lgkmcnt(8)
    v_mfma_f32_16x16x32_bf16 v[68:71], a[96:99], v[32:35], v[68:71]
    ds_read_b64_tr_b16 v[24:25], v10 offset:16384
    v_mfma_f32_16x16x32_bf16 v[68:71], a[108:111], v[36:39], v[68:71]
    ds_read_b64_tr_b16 v[26:27], v10 offset:17408
    v_mfma_f32_16x16x32_bf16 v[72:75], a[100:103], v[32:35], v[72:75]
    ds_read_b64_tr_b16 v[28:29], v11 offset:16384
    v_mfma_f32_16x16x32_bf16 v[72:75], a[112:115], v[36:39], v[72:75]
    ds_read_b64_tr_b16 v[30:31], v11 offset:17408
    buffer_load_dwordx4 v133, s[24:27], m0 offen offset:1024 sc1 lds
    v_mfma_f32_16x16x32_bf16 v[76:79], a[104:107], v[32:35], v[76:79]
    v_mfma_f32_16x16x32_bf16 v[76:79], a[116:119], v[36:39], v[76:79]
    s_add_u32 m0, s85, 90112
    s_waitcnt lgkmcnt(8)
    v_mfma_f32_16x16x32_bf16 v[148:151], v[184:187], v[40:43], v[148:151]
    ds_read_b64_tr_b16 v[32:33], v14 offset:16384
    v_mfma_f32_16x16x32_bf16 v[152:155], v[188:191], v[40:43], v[152:155]
    ds_read_b64_tr_b16 v[34:35], v14 offset:17408
    v_mfma_f32_16x16x32_bf16 v[156:159], v[192:195], v[40:43], v[156:159]
    ds_read_b64_tr_b16 v[36:37], v15 offset:16384
    buffer_load_dwordx4 v133, s[24:27], m0 offen offset:1024 sc1 lds
    v_mfma_f32_16x16x32_bf16 v[80:83], a[96:99], v[40:43], v[80:83]
    ds_read_b64_tr_b16 v[38:39], v15 offset:17408
    v_mfma_f32_16x16x32_bf16 v[80:83], a[108:111], v[44:47], v[80:83]
    s_add_u32 m0, s85, 98304
    v_mfma_f32_16x16x32_bf16 v[84:87], a[100:103], v[40:43], v[84:87]
    buffer_load_dwordx4 v133, s[24:27], m0 offen offset:0 sc1 lds
    v_mfma_f32_16x16x32_bf16 v[84:87], a[112:115], v[44:47], v[84:87]
    v_mfma_f32_16x16x32_bf16 v[88:91], a[104:107], v[40:43], v[88:91]
    v_mfma_f32_16x16x32_bf16 v[88:91], a[116:119], v[44:47], v[88:91]
    v_mfma_f32_16x16x32_bf16 a[244:247], v[40:43], v[40:43], a[244:247]
    s_waitcnt lgkmcnt(8)
    v_mfma_f32_16x16x32_bf16 v[92:95], a[96:99], v[48:51], v[92:95]
    ds_read_b64_tr_b16 v[40:41], v10 offset:57344
    v_mfma_f32_16x16x32_bf16 v[92:95], a[108:111], v[52:55], v[92:95]
    ds_read_b64_tr_b16 v[42:43], v10 offset:58368
    buffer_load_dwordx4 v133, s[24:27], m0 offen offset:1024 sc1 lds
    v_mfma_f32_16x16x32_bf16 v[96:99], a[100:103], v[48:51], v[96:99]
    ds_read_b64_tr_b16 v[44:45], v11 offset:57344
    v_mfma_f32_16x16x32_bf16 v[96:99], a[112:115], v[52:55], v[96:99]
    ds_read_b64_tr_b16 v[46:47], v11 offset:58368
    s_add_u32 m0, s85, 106496
    v_mfma_f32_16x16x32_bf16 v[100:103], a[104:107], v[48:51], v[100:103]
    buffer_load_dwordx4 v133, s[24:27], m0 offen offset:0 sc1 lds
    v_mfma_f32_16x16x32_bf16 v[100:103], a[116:119], v[52:55], v[100:103]
    s_waitcnt lgkmcnt(8)
    v_mfma_f32_16x16x32_bf16 v[56:59], a[120:123], v[24:27], v[56:59]
    ds_read_b64_tr_b16 v[48:49], v14 offset:57344
    v_mfma_f32_16x16x32_bf16 v[56:59], a[132:135], v[28:31], v[56:59]
    ds_read_b64_tr_b16 v[50:51], v14 offset:58368
    v_mfma_f32_16x16x32_bf16 v[60:63], a[124:127], v[24:27], v[60:63]
    ds_read_b64_tr_b16 v[52:53], v15 offset:57344
    v_mfma_f32_16x16x32_bf16 v[60:63], a[136:139], v[28:31], v[60:63]
    ds_read_b64_tr_b16 v[54:55], v15 offset:58368
    v_mfma_f32_16x16x32_bf16 v[64:67], a[128:131], v[24:27], v[64:67]
    buffer_load_dwordx4 v133, s[24:27], m0 offen offset:1024 sc1 lds
    v_mfma_f32_16x16x32_bf16 v[64:67], a[140:143], v[28:31], v[64:67]
    s_waitcnt lgkmcnt(8)
    v_mfma_f32_16x16x32_bf16 v[68:71], a[120:123], v[32:35], v[68:71]
    s_waitcnt vmcnt(9)
    s_barrier
    v_mfma_f32_16x16x32_bf16 v[68:71], a[132:135], v[36:39], v[68:71]
    ds_read_b64_tr_b16 v[24:25], v8 offset:24576
    s_add_u32 m0, s85, 114688
    v_mfma_f32_16x16x32_bf16 v[72:75], a[124:127], v[32:35], v[72:75]
    ds_read_b64_tr_b16 v[26:27], v8 offset:25600
    buffer_load_dwordx4 v133, s[24:27], m0 offen offset:0 sc1 lds
    v_mfma_f32_16x16x32_bf16 v[72:75], a[136:139], v[36:39], v[72:75]
    ds_read_b64_tr_b16 v[28:29], v9 offset:24576
    v_add_u32 v8, 0x6000, v8
    v_mfma_f32_16x16x32_bf16 v[76:79], a[128:131], v[32:35], v[76:79]
    ds_read_b64_tr_b16 v[30:31], v9 offset:25600
    v_mfma_f32_16x16x32_bf16 v[76:79], a[140:143], v[36:39], v[76:79]
    buffer_load_dwordx4 v133, s[24:27], m0 offen offset:1024 sc1 lds
    s_waitcnt lgkmcnt(8)
    v_mfma_f32_16x16x32_bf16 v[80:83], a[120:123], v[40:43], v[80:83]
    ds_read_b64_tr_b16 v[32:33], v12 offset:24576
    v_add_u32 v9, 0x6000, v9
    v_mfma_f32_16x16x32_bf16 v[80:83], a[132:135], v[44:47], v[80:83]
    ds_read_b64_tr_b16 v[34:35], v12 offset:25600
    v_mfma_f32_16x16x32_bf16 v[84:87], a[124:127], v[40:43], v[84:87]
    ds_read_b64_tr_b16 v[36:37], v13 offset:24576
    v_add_u32 v133, 122880, v133
    s_add_u32 m0, s85, 0
    v_mfma_f32_16x16x32_bf16 v[84:87], a[136:139], v[44:47], v[84:87]
    ds_read_b64_tr_b16 v[38:39], v13 offset:25600
    v_add_u32 v12, 0x6000, v12
    v_mfma_f32_16x16x32_bf16 v[88:91], a[128:131], v[40:43], v[88:91]
    buffer_load_dwordx4 v133, s[24:27], m0 offen offset:0 sc1 lds
    v_add_u32 v13, 0x6000, v13
    v_mfma_f32_16x16x32_bf16 v[88:91], a[140:143], v[44:47], v[88:91]
    s_waitcnt lgkmcnt(8)
    v_mfma_f32_16x16x32_bf16 v[92:95], a[120:123], v[48:51], v[92:95]
    ds_read_b64_tr_b16 v[40:41], v8 offset:40960
    v_mfma_f32_16x16x32_bf16 v[92:95], a[132:135], v[52:55], v[92:95]
    ds_read_b64_tr_b16 v[42:43], v8 offset:41984
    v_mfma_f32_16x16x32_bf16 v[96:99], a[124:127], v[48:51], v[96:99]
    ds_read_b64_tr_b16 v[44:45], v9 offset:40960
    v_mfma_f32_16x16x32_bf16 v[96:99], a[136:139], v[52:55], v[96:99]
    ds_read_b64_tr_b16 v[46:47], v9 offset:41984
    buffer_load_dwordx4 v133, s[24:27], m0 offen offset:1024 sc1 lds
    v_mfma_f32_16x16x32_bf16 v[100:103], a[128:131], v[48:51], v[100:103]
    v_mfma_f32_16x16x32_bf16 v[100:103], a[140:143], v[52:55], v[100:103]
    s_add_u32 m0, s85, 8192
    s_waitcnt lgkmcnt(8)
    v_mfma_f32_16x16x32_bf16 v[136:139], v[196:199], v[24:27], v[136:139]
    ds_read_b64_tr_b16 v[48:49], v12 offset:40960
    v_mfma_f32_16x16x32_bf16 v[140:143], v[200:203], v[24:27], v[140:143]
    ds_read_b64_tr_b16 v[50:51], v12 offset:41984
    v_mfma_f32_16x16x32_bf16 v[144:147], v[204:207], v[24:27], v[144:147]
    ds_read_b64_tr_b16 v[52:53], v13 offset:40960
    buffer_load_dwordx4 v133, s[24:27], m0 offen offset:0 sc1 lds
    v_mfma_f32_16x16x32_bf16 v[56:59], a[144:147], v[24:27], v[56:59]
    ds_read_b64_tr_b16 v[54:55], v13 offset:41984
    v_mfma_f32_16x16x32_bf16 v[56:59], a[156:159], v[28:31], v[56:59]
    v_mfma_f32_16x16x32_bf16 v[60:63], a[148:151], v[24:27], v[60:63]
    buffer_load_dwordx4 v133, s[24:27], m0 offen offset:1024 sc1 lds
    v_mfma_f32_16x16x32_bf16 v[60:63], a[160:163], v[28:31], v[60:63]
    v_mfma_f32_16x16x32_bf16 v[64:67], a[152:155], v[24:27], v[64:67]
    v_mfma_f32_16x16x32_bf16 v[64:67], a[164:167], v[28:31], v[64:67]
    v_mfma_f32_16x16x32_bf16 a[240:243], v[24:27], v[24:27], a[240:243]
    s_add_u32 m0, s85, 38912
    s_add_u32 s68, s88, 8192
    s_waitcnt lgkmcnt(8)
    v_mfma_f32_16x16x32_bf16 v[68:71], a[144:147], v[32:35], v[68:71]
    ds_read_b64_tr_b16 v[24:25], v10 offset:24576
    v_mfma_f32_16x16x32_bf16 v[68:71], a[156:159], v[36:39], v[68:71]
    ds_read_b64_tr_b16 v[26:27], v10 offset:25600
    buffer_load_dwordx4 v4, s[24:27], s68 offen offset:2048 sc1 lds
    v_mfma_f32_16x16x32_bf16 v[72:75], a[148:151], v[32:35], v[72:75]
    ds_read_b64_tr_b16 v[28:29], v11 offset:24576
    v_add_u32 v10, 0x6000, v10
    v_mfma_f32_16x16x32_bf16 v[72:75], a[160:163], v[36:39], v[72:75]
    ds_read_b64_tr_b16 v[30:31], v11 offset:25600
    v_mfma_f32_16x16x32_bf16 v[76:79], a[152:155], v[32:35], v[76:79]
    buffer_load_dwordx4 v4, s[24:27], s68 offen offset:3072 sc1 lds
    v_add_u32 v11, 0x6000, v11
    v_mfma_f32_16x16x32_bf16 v[76:79], a[164:167], v[36:39], v[76:79]
    s_waitcnt lgkmcnt(8)
    v_mfma_f32_16x16x32_bf16 v[148:151], v[196:199], v[40:43], v[148:151]
    ds_read_b64_tr_b16 v[32:33], v14 offset:24576
    v_mfma_f32_16x16x32_bf16 v[152:155], v[200:203], v[40:43], v[152:155]
    ds_read_b64_tr_b16 v[34:35], v14 offset:25600
    v_mfma_f32_16x16x32_bf16 v[156:159], v[204:207], v[40:43], v[156:159]
    ds_read_b64_tr_b16 v[36:37], v15 offset:24576
    s_add_u32 m0, s85, 49152
    s_add_u32 s68, s88, 12288
    v_mfma_f32_16x16x32_bf16 v[80:83], a[144:147], v[40:43], v[80:83]
    ds_read_b64_tr_b16 v[38:39], v15 offset:25600
    v_add_u32 v14, 0x6000, v14
    v_mfma_f32_16x16x32_bf16 v[80:83], a[156:159], v[44:47], v[80:83]
    buffer_load_dwordx4 v4, s[24:27], s68 offen offset:0 sc1 lds
    v_add_u32 v15, 0x6000, v15
    v_mfma_f32_16x16x32_bf16 v[84:87], a[148:151], v[40:43], v[84:87]
    v_mfma_f32_16x16x32_bf16 v[84:87], a[160:163], v[44:47], v[84:87]
    v_mfma_f32_16x16x32_bf16 v[88:91], a[152:155], v[40:43], v[88:91]
    buffer_load_dwordx4 v4, s[24:27], s68 offen offset:1024 sc1 lds
    v_mfma_f32_16x16x32_bf16 v[88:91], a[164:167], v[44:47], v[88:91]
    v_mfma_f32_16x16x32_bf16 a[244:247], v[40:43], v[40:43], a[244:247]
    s_waitcnt lgkmcnt(8)
    v_mfma_f32_16x16x32_bf16 v[92:95], a[144:147], v[48:51], v[92:95]
    ds_read_b64_tr_b16 v[40:41], v10 offset:40960
    s_add_u32 m0, s85, 122880
    s_add_u32 s68, s88, 20480
    v_mfma_f32_16x16x32_bf16 v[92:95], a[156:159], v[52:55], v[92:95]
    ds_read_b64_tr_b16 v[42:43], v10 offset:41984
    v_mfma_f32_16x16x32_bf16 v[96:99], a[148:151], v[48:51], v[96:99]
    ds_read_b64_tr_b16 v[44:45], v11 offset:40960
    v_mfma_f32_16x16x32_bf16 v[96:99], a[160:163], v[52:55], v[96:99]
    ds_read_b64_tr_b16 v[46:47], v11 offset:41984
    buffer_load_dwordx4 v4, s[24:27], s68 offen offset:0 sc1 lds
    v_mfma_f32_16x16x32_bf16 v[100:103], a[152:155], v[48:51], v[100:103]
    v_mfma_f32_16x16x32_bf16 v[100:103], a[164:167], v[52:55], v[100:103]
    s_waitcnt lgkmcnt(8)
    v_mfma_f32_16x16x32_bf16 v[56:59], a[168:171], v[24:27], v[56:59]
    ds_read_b64_tr_b16 v[48:49], v14 offset:40960
    v_mfma_f32_16x16x32_bf16 v[56:59], a[180:183], v[28:31], v[56:59]
    ds_read_b64_tr_b16 v[50:51], v14 offset:41984
    buffer_load_dwordx4 v[220:223], v4, s[24:27], s88 offen offset:0 sc1
    v_mfma_f32_16x16x32_bf16 v[60:63], a[172:175], v[24:27], v[60:63]
    ds_read_b64_tr_b16 v[52:53], v15 offset:40960
    v_mfma_f32_16x16x32_bf16 v[60:63], a[184:187], v[28:31], v[60:63]
    ds_read_b64_tr_b16 v[54:55], v15 offset:41984
    v_mfma_f32_16x16x32_bf16 v[64:67], a[176:179], v[24:27], v[64:67]
    buffer_load_dwordx4 v[224:227], v4, s[24:27], s88 offen offset:1024 sc1
    v_mfma_f32_16x16x32_bf16 v[64:67], a[188:191], v[28:31], v[64:67]
    s_waitcnt lgkmcnt(8)
    v_mfma_f32_16x16x32_bf16 v[68:71], a[168:171], v[32:35], v[68:71]
    s_waitcnt vmcnt(18)
    s_barrier
    v_mfma_f32_16x16x32_bf16 v[68:71], a[180:183], v[36:39], v[68:71]
    ds_read_b64_tr_b16 v[24:25], v8 offset:8192
    s_add_u32 m0, s85, 16384
    v_mfma_f32_16x16x32_bf16 v[72:75], a[172:175], v[32:35], v[72:75]
    ds_read_b64_tr_b16 v[26:27], v8 offset:9216
    v_mfma_f32_16x16x32_bf16 v[72:75], a[184:187], v[36:39], v[72:75]
    ds_read_b64_tr_b16 v[28:29], v9 offset:8192
    buffer_load_dwordx4 v133, s[24:27], m0 offen offset:0 sc1 lds
    v_mfma_f32_16x16x32_bf16 v[76:79], a[176:179], v[32:35], v[76:79]
    ds_read_b64_tr_b16 v[30:31], v9 offset:9216
    v_mfma_f32_16x16x32_bf16 v[76:79], a[188:191], v[36:39], v[76:79]
    s_waitcnt lgkmcnt(8)
    v_mfma_f32_16x16x32_bf16 v[80:83], a[168:171], v[40:43], v[80:83]
    ds_read_b64_tr_b16 v[32:33], v12 offset:8192
    v_mfma_f32_16x16x32_bf16 v[80:83], a[180:183], v[44:47], v[80:83]
    ds_read_b64_tr_b16 v[34:35], v12 offset:9216
    v_mfma_f32_16x16x32_bf16 v[84:87], a[172:175], v[40:43], v[84:87]
    ds_read_b64_tr_b16 v[36:37], v13 offset:8192
    buffer_load_dwordx4 v133, s[24:27], m0 offen offset:1024 sc1 lds
    v_mfma_f32_16x16x32_bf16 v[84:87], a[184:187], v[44:47], v[84:87]
    ds_read_b64_tr_b16 v[38:39], v13 offset:9216
    v_mfma_f32_16x16x32_bf16 v[88:91], a[176:179], v[40:43], v[88:91]
    s_add_u32 m0, s85, 55296
    s_add_u32 s68, s88, 12288
    v_mfma_f32_16x16x32_bf16 v[88:91], a[188:191], v[44:47], v[88:91]
    buffer_load_dwordx4 v4, s[24:27], s68 offen offset:2048 sc1 lds
    s_waitcnt lgkmcnt(8)
    v_mfma_f32_16x16x32_bf16 v[92:95], a[168:171], v[48:51], v[92:95]
    ds_read_b64_tr_b16 v[40:41], v10 offset:8192
    v_mfma_f32_16x16x32_bf16 v[92:95], a[180:183], v[52:55], v[92:95]
    ds_read_b64_tr_b16 v[42:43], v10 offset:9216
    v_mfma_f32_16x16x32_bf16 v[96:99], a[172:175], v[48:51], v[96:99]
    ds_read_b64_tr_b16 v[44:45], v11 offset:8192
    v_mfma_f32_16x16x32_bf16 v[96:99], a[184:187], v[52:55], v[96:99]
    ds_read_b64_tr_b16 v[46:47], v11 offset:9216
    v_mfma_f32_16x16x32_bf16 v[100:103], a[176:179], v[48:51], v[100:103]
    buffer_load_dwordx4 v4, s[24:27], s68 offen offset:3072 sc1 lds
    v_mfma_f32_16x16x32_bf16 v[100:103], a[188:191], v[52:55], v[100:103]
    s_waitcnt lgkmcnt(8)
    v_mfma_f32_16x16x32_bf16 v[136:139], v[208:211], v[24:27], v[136:139]
    ds_read_b64_tr_b16 v[48:49], v14 offset:8192
    v_mfma_f32_16x16x32_bf16 v[140:143], v[212:215], v[24:27], v[140:143]
    ds_read_b64_tr_b16 v[50:51], v14 offset:9216
    v_mfma_f32_16x16x32_bf16 v[144:147], v[216:219], v[24:27], v[144:147]
    ds_read_b64_tr_b16 v[52:53], v15 offset:8192
    v_mfma_f32_16x16x32_bf16 v[56:59], a[192:195], v[24:27], v[56:59]
    ds_read_b64_tr_b16 v[54:55], v15 offset:9216
    v_mfma_f32_16x16x32_bf16 v[56:59], a[204:207], v[28:31], v[56:59]
    buffer_load_dwordx4 v[228:231], v4, s[24:27], s88 offen offset:2048 sc1
    v_mfma_f32_16x16x32_bf16 v[60:63], a[196:199], v[24:27], v[60:63]
    v_mfma_f32_16x16x32_bf16 v[60:63], a[208:211], v[28:31], v[60:63]
    v_mfma_f32_16x16x32_bf16 v[64:67], a[200:203], v[24:27], v[64:67]
    buffer_load_dwordx4 v[232:235], v4, s[24:27], s88 offen offset:3072 sc1
    v_mfma_f32_16x16x32_bf16 v[64:67], a[212:215], v[28:31], v[64:67]
    v_mfma_f32_16x16x32_bf16 a[240:243], v[24:27], v[24:27], a[240:243]
    s_waitcnt lgkmcnt(8)
    v_mfma_f32_16x16x32_bf16 v[68:71], a[192:195], v[32:35], v[68:71]
    ds_read_b64_tr_b16 v[24:25], v8 offset:49152
    s_add_u32 s73, s88, 4096
    v_mfma_f32_16x16x32_bf16 v[68:71], a[204:207], v[36:39], v[68:71]
    ds_read_b64_tr_b16 v[26:27], v8 offset:50176
    s_lshl_b32 s52, s32, 8
    v_mfma_f32_16x16x32_bf16 v[72:75], a[196:199], v[32:35], v[72:75]
    ds_read_b64_tr_b16 v[28:29], v9 offset:49152
    s_add_u32 s52, s52, 158720
    v_mfma_f32_16x16x32_bf16 v[72:75], a[208:211], v[36:39], v[72:75]
    ds_read_b64_tr_b16 v[30:31], v9 offset:50176
    buffer_load_dwordx4 v[236:239], v4, s[24:27], s73 offen offset:0 sc1
    v_mfma_f32_16x16x32_bf16 v[76:79], a[200:203], v[32:35], v[76:79]
    v_lshl_add_u32 v5, v2, 4, s52
    v_mfma_f32_16x16x32_bf16 v[76:79], a[212:215], v[36:39], v[76:79]
    s_waitcnt lgkmcnt(8)
    v_mfma_f32_16x16x32_bf16 v[56:59], a[216:219], v[40:43], v[56:59]
    ds_read_b64_tr_b16 v[32:33], v10 offset:49152
    v_mfma_f32_16x16x32_bf16 v[56:59], a[228:231], v[44:47], v[56:59]
    ds_read_b64_tr_b16 v[34:35], v10 offset:50176
    buffer_load_dwordx4 v[240:243], v4, s[24:27], s73 offen offset:1024 sc1
    v_mfma_f32_16x16x32_bf16 v[60:63], a[220:223], v[40:43], v[60:63]
    ds_read_b64_tr_b16 v[36:37], v11 offset:49152
    v_mfma_f32_16x16x32_bf16 v[60:63], a[232:235], v[44:47], v[60:63]
    ds_read_b64_tr_b16 v[38:39], v11 offset:50176
    v_mfma_f32_16x16x32_bf16 v[64:67], a[224:227], v[40:43], v[64:67]
    s_mov_b64 exec, s[66:67]
    ds_write_b128 v5, a[240:243]
    s_mov_b64 exec, -1
    v_mfma_f32_16x16x32_bf16 v[64:67], a[236:239], v[44:47], v[64:67]
    buffer_load_dwordx4 v[244:247], v4, s[24:27], s73 offen offset:2048 sc1
    s_waitcnt lgkmcnt(9)
    v_mfma_f32_16x16x32_bf16 v[68:71], a[216:219], v[48:51], v[68:71]
    ds_read_b64_tr_b16 v[40:41], v12 offset:49152
    s_mul_i32 s52, s32, 2560
    v_mfma_f32_16x16x32_bf16 v[68:71], a[228:231], v[52:55], v[68:71]
    ds_read_b64_tr_b16 v[42:43], v12 offset:50176
    s_add_u32 s52, s52, 148480
    v_mfma_f32_16x16x32_bf16 v[72:75], a[220:223], v[48:51], v[72:75]
    ds_read_b64_tr_b16 v[44:45], v13 offset:49152
    buffer_load_dwordx4 v[248:251], v4, s[24:27], s73 offen offset:3072 sc1
    v_mfma_f32_16x16x32_bf16 v[72:75], a[232:235], v[52:55], v[72:75]
    ds_read_b64_tr_b16 v[46:47], v13 offset:50176
    v_add_u32 v6, s52, v4
    v_mfma_f32_16x16x32_bf16 v[76:79], a[224:227], v[48:51], v[76:79]
    ds_write_b128 v6, v[136:139] offset:0
    ds_write_b128 v6, v[140:143] offset:1024
    v_mfma_f32_16x16x32_bf16 v[76:79], a[236:239], v[52:55], v[76:79]
    s_add_u32 s73, s88, 8192
    s_waitcnt lgkmcnt(11)
    v_mfma_f32_16x16x32_bf16 v[148:151], v[208:211], v[24:27], v[148:151]
    ds_read_b64_tr_b16 v[48:49], v14 offset:49152
    buffer_load_dwordx4 a[248:251], v4, s[24:27], s73 offen offset:0 sc1
    v_mfma_f32_16x16x32_bf16 v[152:155], v[212:215], v[24:27], v[152:155]
    ds_read_b64_tr_b16 v[50:51], v14 offset:50176
    v_max_f32 v56, 0, v56
    v_mfma_f32_16x16x32_bf16 v[156:159], v[216:219], v[24:27], v[156:159]
    ds_read_b64_tr_b16 v[52:53], v15 offset:49152
    v_max_f32 v57, 0, v57
    v_mfma_f32_16x16x32_bf16 v[80:83], a[192:195], v[24:27], v[80:83]
    ds_read_b64_tr_b16 v[54:55], v15 offset:50176
    buffer_load_dwordx4 a[252:255], v4, s[24:27], s73 offen offset:1024 sc1
    v_mfma_f32_16x16x32_bf16 v[80:83], a[204:207], v[28:31], v[80:83]
    s_mov_b32 exec_hi, 0
    s_waitcnt lgkmcnt(11)
    ds_write_b128 v6, v[144:147] offset:2048
    s_mov_b32 exec_hi, -1
    v_mfma_f32_16x16x32_bf16 v[84:87], a[196:199], v[24:27], v[84:87]
    v_mul_f32 v56, v56, v60
    v_mul_f32 v57, v57, v61
    v_mfma_f32_16x16x32_bf16 v[84:87], a[208:211], v[28:31], v[84:87]
    v_cvt_pk_bf16_f32 v56, v56, v57
    v_max_f32 v58, 0, v58
    v_mfma_f32_16x16x32_bf16 v[88:91], a[200:203], v[24:27], v[88:91]
    v_max_f32 v59, 0, v59
    v_mul_f32 v58, v58, v62
    v_mfma_f32_16x16x32_bf16 v[88:91], a[212:215], v[28:31], v[88:91]
    v_mul_f32 v59, v59, v63
    v_cvt_pk_bf16_f32 v60, v58, v59
    v_mfma_f32_16x16x32_bf16 a[244:247], v[24:27], v[24:27], a[244:247]
    v_permlane32_swap_b32 v64, v66
    v_mfma_f32_16x16x32_bf16 v[80:83], a[216:219], v[32:35], v[80:83]
    s_waitcnt vmcnt(23)
    s_barrier
    v_mfma_f32_16x16x32_bf16 v[80:83], a[228:231], v[36:39], v[80:83]
    ds_read_b64_tr_b16 v[24:25], v8 offset:57344
    s_add_u32 m0, s85, 65536
    s_add_u32 s68, s88, 16384
    v_mfma_f32_16x16x32_bf16 v[84:87], a[220:223], v[32:35], v[84:87]
    ds_read_b64_tr_b16 v[26:27], v8 offset:58368
    buffer_load_dwordx4 v4, s[24:27], s68 offen offset:0 sc1 lds
    v_mfma_f32_16x16x32_bf16 v[84:87], a[232:235], v[36:39], v[84:87]
    ds_read_b64_tr_b16 v[28:29], v9 offset:57344
    v_add_u32 v8, 0x10000, v8
    v_mfma_f32_16x16x32_bf16 v[88:91], a[224:227], v[32:35], v[88:91]
    s_waitcnt lgkmcnt(11)
    ds_read_b64_tr_b16 v[30:31], v9 offset:58368
    v_mfma_f32_16x16x32_bf16 v[88:91], a[236:239], v[36:39], v[88:91]
    buffer_load_dwordx4 v4, s[24:27], s68 offen offset:1024 sc1 lds
    s_waitcnt lgkmcnt(11)
    v_mfma_f32_16x16x32_bf16 v[92:95], a[192:195], v[40:43], v[92:95]
    ds_read_b64_tr_b16 v[32:33], v12 offset:57344
    v_add_u32 v9, 0x10000, v9
    v_mfma_f32_16x16x32_bf16 v[92:95], a[204:207], v[44:47], v[92:95]
    ds_read_b64_tr_b16 v[34:35], v12 offset:58368
    s_add_u32 m0, s85, 24576
    v_mfma_f32_16x16x32_bf16 v[96:99], a[196:199], v[40:43], v[96:99]
    ds_read_b64_tr_b16 v[36:37], v13 offset:57344
    v_add_u32 v12, 0x10000, v12
    v_mfma_f32_16x16x32_bf16 v[96:99], a[208:211], v[44:47], v[96:99]
    ds_read_b64_tr_b16 v[38:39], v13 offset:58368
    v_permlane32_swap_b32 v65, v67
    v_mfma_f32_16x16x32_bf16 v[100:103], a[200:203], v[40:43], v[100:103]
    buffer_load_dwordx4 v133, s[24:27], m0 offen offset:0 sc1 lds
    v_add_u32 v13, 0x10000, v13
    v_mfma_f32_16x16x32_bf16 v[100:103], a[212:215], v[44:47], v[100:103]
    v_max_f32 v64, 0, v64
    s_waitcnt lgkmcnt(9)
    v_mfma_f32_16x16x32_bf16 v[92:95], a[216:219], v[48:51], v[92:95]
    ds_read_b64_tr_b16 v[40:41], v10 offset:57344
    v_max_f32 v65, 0, v65
    v_mfma_f32_16x16x32_bf16 v[92:95], a[228:231], v[52:55], v[92:95]
    ds_read_b64_tr_b16 v[42:43], v10 offset:58368
    v_mul_f32 v64, v64, v66
    v_mfma_f32_16x16x32_bf16 v[96:99], a[220:223], v[48:51], v[96:99]
    ds_read_b64_tr_b16 v[44:45], v11 offset:57344
    buffer_load_dwordx4 v133, s[24:27], m0 offen offset:1024 sc1 lds
    v_mfma_f32_16x16x32_bf16 v[96:99], a[232:235], v[52:55], v[96:99]
    ds_read_b64_tr_b16 v[46:47], v11 offset:58368
    v_add_u32 v10, 0x10000, v10
    v_mfma_f32_16x16x32_bf16 v[100:103], a[224:227], v[48:51], v[100:103]
    v_add_u32 v11, 0x10000, v11
    v_mul_f32 v65, v65, v67
    v_mfma_f32_16x16x32_bf16 v[100:103], a[236:239], v[52:55], v[100:103]
    s_add_u32 m0, s85, 32768
    s_waitcnt lgkmcnt(8)
    v_mfma_f32_16x16x32_bf16 v[136:139], v[160:163], v[24:27], 0
    ds_read_b64_tr_b16 v[48:49], v14 offset:57344
    v_cvt_pk_bf16_f32 v64, v64, v65
    v_mfma_f32_16x16x32_bf16 v[140:143], v[164:167], v[24:27], 0
    ds_read_b64_tr_b16 v[50:51], v14 offset:58368
    buffer_load_dwordx4 v133, s[24:27], m0 offen offset:0 sc1 lds
    v_mfma_f32_16x16x32_bf16 v[144:147], v[168:171], v[24:27], 0
    ds_read_b64_tr_b16 v[52:53], v15 offset:57344
    v_add_u32 v14, 0x10000, v14
    v_mfma_f32_16x16x32_bf16 v[104:107], a[0:3], v[24:27], 0
    ds_read_b64_tr_b16 v[54:55], v15 offset:58368
    v_max_f32 v68, 0, v68
    v_mfma_f32_16x16x32_bf16 v[104:107], a[12:15], v[28:31], v[104:107]
    buffer_load_dwordx4 v133, s[24:27], m0 offen offset:1024 sc1 lds
    v_add_u32 v15, 0x10000, v15
    v_mfma_f32_16x16x32_bf16 v[108:111], a[4:7], v[24:27], 0
    v_max_f32 v69, 0, v69
    v_mul_f32 v68, v68, v72
    v_mfma_f32_16x16x32_bf16 v[108:111], a[16:19], v[28:31], v[108:111]
    v_mul_f32 v69, v69, v73
    v_cvt_pk_bf16_f32 v57, v68, v69
    v_mfma_f32_16x16x32_bf16 v[112:115], a[8:11], v[24:27], 0
    v_and_b32 v26, v21, v26
    v_max_f32 v70, 0, v70
    v_mfma_f32_16x16x32_bf16 v[112:115], a[20:23], v[28:31], v[112:115]
    v_max_f32 v71, 0, v71
    v_mul_f32 v70, v70, v74
    v_mfma_f32_16x16x32_bf16 a[240:243], v[24:27], v[24:27], 0
    v_mul_f32 v71, v71, v75
    s_waitcnt lgkmcnt(8)
    v_mfma_f32_16x16x32_bf16 v[116:119], a[0:3], v[32:35], 0
    s_barrier
    s_add_u32 m0, s85, 71680
    v_mfma_f32_16x16x32_bf16 v[116:119], a[12:15], v[36:39], v[116:119]
    ds_read_b64_tr_b16 v[24:25], v8 offset:0
    buffer_load_dwordx4 v4, s[24:27], s68 offen offset:2048 sc1 lds
    v_mfma_f32_16x16x32_bf16 v[120:123], a[4:7], v[32:35], 0
    ds_read_b64_tr_b16 v[26:27], v8 offset:1024
    v_cvt_pk_bf16_f32 v61, v70, v71
    v_mfma_f32_16x16x32_bf16 v[120:123], a[16:19], v[36:39], v[120:123]
    ds_read_b64_tr_b16 v[28:29], v9 offset:0
    v_permlane32_swap_b32 v76, v78
    v_mfma_f32_16x16x32_bf16 v[124:127], a[8:11], v[32:35], 0
    ds_read_b64_tr_b16 v[30:31], v9 offset:1024
    buffer_load_dwordx4 v4, s[24:27], s68 offen offset:3072 sc1 lds
    v_mfma_f32_16x16x32_bf16 v[124:127], a[20:23], v[36:39], v[124:127]
    v_permlane32_swap_b32 v77, v79
    s_waitcnt lgkmcnt(8)
    v_mfma_f32_16x16x32_bf16 v[104:107], a[24:27], v[40:43], v[104:107]
    ds_read_b64_tr_b16 v[32:33], v12 offset:0
    v_max_f32 v76, 0, v76
    v_mfma_f32_16x16x32_bf16 v[104:107], a[36:39], v[44:47], v[104:107]
    ds_read_b64_tr_b16 v[34:35], v12 offset:1024
    v_max_f32 v77, 0, v77
    v_mfma_f32_16x16x32_bf16 v[108:111], a[28:31], v[40:43], v[108:111]
    ds_read_b64_tr_b16 v[36:37], v13 offset:0
    v_mul_f32 v76, v76, v78
    v_mfma_f32_16x16x32_bf16 v[108:111], a[40:43], v[44:47], v[108:111]
    ds_read_b64_tr_b16 v[38:39], v13 offset:1024
    v_mul_f32 v77, v77, v79
    v_mfma_f32_16x16x32_bf16 v[112:115], a[32:35], v[40:43], v[112:115]
    v_cvt_pk_bf16_f32 v65, v76, v77
    v_max_f32 v80, 0, v80
    v_mfma_f32_16x16x32_bf16 v[112:115], a[44:47], v[44:47], v[112:115]
    v_max_f32 v81, 0, v81
    s_waitcnt lgkmcnt(8)
    v_mfma_f32_16x16x32_bf16 v[116:119], a[24:27], v[48:51], v[116:119]
    ds_read_b64_tr_b16 v[40:41], v10 offset:0
    v_mul_f32 v80, v80, v84
    v_mfma_f32_16x16x32_bf16 v[116:119], a[36:39], v[52:55], v[116:119]
    ds_read_b64_tr_b16 v[42:43], v10 offset:1024
    v_mul_f32 v81, v81, v85
    v_mfma_f32_16x16x32_bf16 v[120:123], a[28:31], v[48:51], v[120:123]
    ds_read_b64_tr_b16 v[44:45], v11 offset:0
    v_cvt_pk_bf16_f32 v58, v80, v81
    v_mfma_f32_16x16x32_bf16 v[120:123], a[40:43], v[52:55], v[120:123]
    ds_read_b64_tr_b16 v[46:47], v11 offset:1024
    v_max_f32 v82, 0, v82
    v_mfma_f32_16x16x32_bf16 v[124:127], a[32:35], v[48:51], v[124:127]
    v_max_f32 v83, 0, v83
    v_mul_f32 v82, v82, v86
    v_mfma_f32_16x16x32_bf16 v[124:127], a[44:47], v[52:55], v[124:127]
    v_mul_f32 v83, v83, v87
    s_waitcnt lgkmcnt(8)
    v_mfma_f32_16x16x32_bf16 v[136:139], v[172:175], v[24:27], v[136:139]
    ds_read_b64_tr_b16 v[48:49], v14 offset:0
    v_cvt_pk_bf16_f32 v62, v82, v83
    v_mfma_f32_16x16x32_bf16 v[140:143], v[176:179], v[24:27], v[140:143]
    ds_read_b64_tr_b16 v[50:51], v14 offset:1024
    v_permlane32_swap_b32 v88, v90
    v_mfma_f32_16x16x32_bf16 v[144:147], v[180:183], v[24:27], v[144:147]
    ds_read_b64_tr_b16 v[52:53], v15 offset:0
    v_permlane32_swap_b32 v89, v91
    v_mfma_f32_16x16x32_bf16 v[104:107], a[48:51], v[24:27], v[104:107]
    ds_read_b64_tr_b16 v[54:55], v15 offset:1024
    v_max_f32 v88, 0, v88
    v_mfma_f32_16x16x32_bf16 v[104:107], a[60:63], v[28:31], v[104:107]
    v_max_f32 v89, 0, v89
    v_mul_f32 v88, v88, v90
    v_mfma_f32_16x16x32_bf16 v[108:111], a[52:55], v[24:27], v[108:111]
    v_mul_f32 v89, v89, v91
    v_cvt_pk_bf16_f32 v66, v88, v89
    v_mfma_f32_16x16x32_bf16 v[108:111], a[64:67], v[28:31], v[108:111]
    v_max_f32 v92, 0, v92
    v_max_f32 v93, 0, v93
    v_mfma_f32_16x16x32_bf16 v[112:115], a[56:59], v[24:27], v[112:115]
    v_mul_f32 v92, v92, v96
    v_mul_f32 v93, v93, v97
    v_mfma_f32_16x16x32_bf16 v[112:115], a[68:71], v[28:31], v[112:115]
    v_cvt_pk_bf16_f32 v59, v92, v93
    v_max_f32 v94, 0, v94
    v_mfma_f32_16x16x32_bf16 a[240:243], v[24:27], v[24:27], a[240:243]
    v_max_f32 v95, 0, v95
    s_waitcnt lgkmcnt(8)
    v_mfma_f32_16x16x32_bf16 v[116:119], a[48:51], v[32:35], v[116:119]
    ds_read_b64_tr_b16 v[24:25], v8 offset:8192
    v_permlane32_swap_b32 v56, v58
    v_mfma_f32_16x16x32_bf16 v[116:119], a[60:63], v[36:39], v[116:119]
    ds_read_b64_tr_b16 v[26:27], v8 offset:9216
    v_permlane32_swap_b32 v57, v59
    v_mfma_f32_16x16x32_bf16 v[120:123], a[52:55], v[32:35], v[120:123]
    ds_read_b64_tr_b16 v[28:29], v9 offset:8192
    v_permlane16_swap_b32 v56, v57
    v_mfma_f32_16x16x32_bf16 v[120:123], a[64:67], v[36:39], v[120:123]
    ds_read_b64_tr_b16 v[30:31], v9 offset:9216
    v_permlane16_swap_b32 v58, v59
    v_mfma_f32_16x16x32_bf16 v[124:127], a[56:59], v[32:35], v[124:127]
    buffer_store_dwordx4 v[56:59], v16, s[24:27], s86 offen offset:0 sc1
    v_mul_f32 v94, v94, v98
    v_mfma_f32_16x16x32_bf16 v[124:127], a[68:71], v[36:39], v[124:127]
    v_mul_f32 v95, v95, v99
    s_waitcnt lgkmcnt(8)
    v_mfma_f32_16x16x32_bf16 v[104:107], a[72:75], v[40:43], v[104:107]
    ds_read_b64_tr_b16 v[32:33], v12 offset:8192
    v_cvt_pk_bf16_f32 v63, v94, v95
    v_mfma_f32_16x16x32_bf16 v[104:107], a[84:87], v[44:47], v[104:107]
    ds_read_b64_tr_b16 v[34:35], v12 offset:9216
    v_permlane32_swap_b32 v100, v102
    v_mfma_f32_16x16x32_bf16 v[108:111], a[76:79], v[40:43], v[108:111]
    ds_read_b64_tr_b16 v[36:37], v13 offset:8192
    v_permlane32_swap_b32 v101, v103
    v_mfma_f32_16x16x32_bf16 v[108:111], a[88:91], v[44:47], v[108:111]
    ds_read_b64_tr_b16 v[38:39], v13 offset:9216
    v_permlane32_swap_b32 v60, v62
    v_mfma_f32_16x16x32_bf16 v[112:115], a[80:83], v[40:43], v[112:115]
    v_permlane32_swap_b32 v61, v63
    s_lshl_b32 s52, s32, 8
    v_mfma_f32_16x16x32_bf16 v[112:115], a[92:95], v[44:47], v[112:115]
    v_permlane16_swap_b32 v60, v61
    s_waitcnt lgkmcnt(8)
    v_mfma_f32_16x16x32_bf16 v[116:119], a[72:75], v[48:51], v[116:119]
    ds_read_b64_tr_b16 v[40:41], v10 offset:8192
    v_permlane16_swap_b32 v62, v63
    v_mfma_f32_16x16x32_bf16 v[116:119], a[84:87], v[52:55], v[116:119]
    ds_read_b64_tr_b16 v[42:43], v10 offset:9216
    buffer_store_dwordx4 v[60:63], v16, s[24:27], s86 offen offset:256 sc1
    v_mfma_f32_16x16x32_bf16 v[120:123], a[76:79], v[48:51], v[120:123]
    ds_read_b64_tr_b16 v[44:45], v11 offset:8192
    v_max_f32 v100, 0, v100
    v_mfma_f32_16x16x32_bf16 v[120:123], a[88:91], v[52:55], v[120:123]
    ds_read_b64_tr_b16 v[46:47], v11 offset:9216
    v_max_f32 v101, 0, v101
    v_mfma_f32_16x16x32_bf16 v[124:127], a[80:83], v[48:51], v[124:127]
    v_mul_f32 v100, v100, v102
    v_mul_f32 v101, v101, v103
    v_mfma_f32_16x16x32_bf16 v[124:127], a[92:95], v[52:55], v[124:127]
    v_cvt_pk_bf16_f32 v67, v100, v101
    s_waitcnt lgkmcnt(8)
    v_mfma_f32_16x16x32_bf16 v[136:139], v[184:187], v[24:27], v[136:139]
    ds_read_b64_tr_b16 v[48:49], v14 offset:8192
    v_permlane32_swap_b32 v64, v66
    v_mfma_f32_16x16x32_bf16 v[140:143], v[188:191], v[24:27], v[140:143]
    ds_read_b64_tr_b16 v[50:51], v14 offset:9216
    v_permlane32_swap_b32 v65, v67
    v_mfma_f32_16x16x32_bf16 v[144:147], v[192:195], v[24:27], v[144:147]
    ds_read_b64_tr_b16 v[52:53], v15 offset:8192
    v_permlane16_swap_b32 v64, v65
    v_mfma_f32_16x16x32_bf16 v[104:107], a[96:99], v[24:27], v[104:107]
    s_branch L_pgx11
L_pg11:
    s_setpc_b64 s[40:41]
L_pgx11:
    ds_read_b64_tr_b16 v[54:55], v15 offset:9216
    v_permlane16_swap_b32 v66, v67
    v_mfma_f32_16x16x32_bf16 v[104:107], a[108:111], v[28:31], v[104:107]
    buffer_store_dwordx4 v[64:67], v16, s[24:27], s86 offen offset:512 sc1
    v_mov_b32 v20, 1024
    v_mfma_f32_16x16x32_bf16 v[108:111], a[100:103], v[24:27], v[108:111]
    s_add_u32 s73, s88, 20480
    s_add_u32 s52, s52, 159744
    v_mfma_f32_16x16x32_bf16 v[108:111], a[112:115], v[28:31], v[108:111]
    buffer_load_dwordx4 v[80:83], v4, s[24:27], s73 offen offset:1024 sc1
    v_lshl_add_u32 v5, v2, 4, s52
    v_mfma_f32_16x16x32_bf16 v[112:115], a[104:107], v[24:27], v[112:115]
    s_mov_b64 exec, s[66:67]
    ds_write_b128 v5, a[244:247]
    s_mov_b64 exec, -1
    v_mfma_f32_16x16x32_bf16 v[112:115], a[116:119], v[28:31], v[112:115]
    buffer_load_dwordx4 v[84:87], v4, s[24:27], s73 offen offset:2048 sc1
    s_mul_i32 s52, s32, 2560
    v_mfma_f32_16x16x32_bf16 a[240:243], v[24:27], v[24:27], a[240:243]
    s_add_u32 s52, s52, 138240
    s_waitcnt lgkmcnt(9)
    v_mfma_f32_16x16x32_bf16 v[116:119], a[96:99], v[32:35], v[116:119]
    ds_read_b64_tr_b16 v[24:25], v8 offset:16384
    v_add_u32 v6, s52, v4
    v_mfma_f32_16x16x32_bf16 v[116:119], a[108:111], v[36:39], v[116:119]
    ds_read_b64_tr_b16 v[26:27], v8 offset:17408
    ds_write_b128 v6, v[148:151] offset:0
    v_mfma_f32_16x16x32_bf16 v[120:123], a[100:103], v[32:35], v[120:123]
    ds_read_b64_tr_b16 v[28:29], v9 offset:16384
    buffer_load_dwordx4 v[88:91], v4, s[24:27], s73 offen offset:3072 sc1
    v_mfma_f32_16x16x32_bf16 v[120:123], a[112:115], v[36:39], v[120:123]
    ds_read_b64_tr_b16 v[30:31], v9 offset:17408
    s_add_u32 s73, s88, 24576
    v_mfma_f32_16x16x32_bf16 v[124:127], a[104:107], v[32:35], v[124:127]
    buffer_load_dwordx4 v[92:95], v4, s[24:27], s73 offen offset:0 sc1
    ds_write_b128 v6, v[152:155] offset:1024
    v_mfma_f32_16x16x32_bf16 v[124:127], a[116:119], v[36:39], v[124:127]
    s_waitcnt lgkmcnt(11)
    v_mfma_f32_16x16x32_bf16 v[104:107], a[120:123], v[40:43], v[104:107]
    ds_read_b64_tr_b16 v[32:33], v12 offset:16384
    v_mfma_f32_16x16x32_bf16 v[104:107], a[132:135], v[44:47], v[104:107]
    ds_read_b64_tr_b16 v[34:35], v12 offset:17408
    v_mfma_f32_16x16x32_bf16 v[108:111], a[124:127], v[40:43], v[108:111]
    ds_read_b64_tr_b16 v[36:37], v13 offset:16384
    buffer_load_dwordx4 v[96:99], v4, s[24:27], s73 offen offset:1024 sc1
    v_mfma_f32_16x16x32_bf16 v[108:111], a[136:139], v[44:47], v[108:111]
    ds_read_b64_tr_b16 v[38:39], v13 offset:17408
    v_mfma_f32_16x16x32_bf16 v[112:115], a[128:131], v[40:43], v[112:115]
    s_mov_b32 exec_hi, 0
    s_waitcnt lgkmcnt(11)
    ds_write_b128 v6, v[156:159] offset:2048
    s_mov_b32 exec_hi, -1
    v_mfma_f32_16x16x32_bf16 v[112:115], a[140:143], v[44:47], v[112:115]
    buffer_load_dwordx4 v[100:103], v4, s[24:27], s73 offen offset:2048 sc1
    v_mfma_f32_16x16x32_bf16 v[116:119], a[120:123], v[48:51], v[116:119]
    ds_read_b64_tr_b16 v[40:41], v10 offset:16384
    v_mfma_f32_16x16x32_bf16 v[116:119], a[132:135], v[52:55], v[116:119]
    ds_read_b64_tr_b16 v[42:43], v10 offset:17408
    v_mfma_f32_16x16x32_bf16 v[120:123], a[124:127], v[48:51], v[120:123]
    ds_read_b64_tr_b16 v[44:45], v11 offset:16384
    v_mfma_f32_16x16x32_bf16 v[120:123], a[136:139], v[52:55], v[120:123]
    s_waitcnt lgkmcnt(11)
    ds_read_b64_tr_b16 v[46:47], v11 offset:17408
    v_mfma_f32_16x16x32_bf16 v[124:127], a[128:131], v[48:51], v[124:127]
    buffer_load_dwordx4 a[244:247], v4, s[24:27], s73 offen offset:3072 sc1
    v_mfma_f32_16x16x32_bf16 v[124:127], a[140:143], v[52:55], v[124:127]
    s_add_u32 s73, s88, 28672
    s_waitcnt lgkmcnt(10)
    v_mfma_f32_16x16x32_bf16 v[136:139], v[196:199], v[24:27], v[136:139]
    ds_read_b64_tr_b16 v[48:49], v8 offset:24576
    v_mfma_f32_16x16x32_bf16 v[140:143], v[200:203], v[24:27], v[140:143]
    ds_read_b64_tr_b16 v[50:51], v8 offset:25600
    buffer_load_dwordx4 v[148:151], v4, s[24:27], s73 offen offset:0 sc1
    v_mfma_f32_16x16x32_bf16 v[144:147], v[204:207], v[24:27], v[144:147]
    ds_read_b64_tr_b16 v[52:53], v9 offset:24576
    v_add_u32 v8, 0xfffea000, v8
    v_mfma_f32_16x16x32_bf16 v[104:107], a[144:147], v[24:27], v[104:107]
    ds_read_b64_tr_b16 v[54:55], v9 offset:25600
    v_mfma_f32_16x16x32_bf16 v[104:107], a[156:159], v[28:31], v[104:107]
    v_add_u32 v9, 0xfffea000, v9
    v_mfma_f32_16x16x32_bf16 v[108:111], a[148:151], v[24:27], v[108:111]
    buffer_load_dwordx4 v[152:155], v4, s[24:27], s73 offen offset:1024 sc1
    v_mfma_f32_16x16x32_bf16 v[108:111], a[160:163], v[28:31], v[108:111]
    v_mfma_f32_16x16x32_bf16 v[112:115], a[152:155], v[24:27], v[112:115]
    v_mfma_f32_16x16x32_bf16 v[112:115], a[164:167], v[28:31], v[112:115]
    v_mfma_f32_16x16x32_bf16 a[240:243], v[24:27], v[24:27], a[240:243]
    buffer_load_dwordx4 v[156:159], v4, s[24:27], s73 offen offset:2048 sc1
    s_waitcnt lgkmcnt(9)
    v_mfma_f32_16x16x32_bf16 v[116:119], a[144:147], v[32:35], v[116:119]
    ds_read_b64_tr_b16 v[24:25], v10 offset:24576
    v_mfma_f32_16x16x32_bf16 v[116:119], a[156:159], v[36:39], v[116:119]
    ds_read_b64_tr_b16 v[26:27], v10 offset:25600
    v_mfma_f32_16x16x32_bf16 v[120:123], a[148:151], v[32:35], v[120:123]
    ds_read_b64_tr_b16 v[28:29], v11 offset:24576
    v_add_u32 v10, 0xfffea000, v10
    v_mfma_f32_16x16x32_bf16 v[120:123], a[160:163], v[36:39], v[120:123]
    ds_read_b64_tr_b16 v[30:31], v11 offset:25600
    v_mfma_f32_16x16x32_bf16 v[124:127], a[152:155], v[32:35], v[124:127]
    v_add_u32 v11, 0xfffea000, v11
    v_mfma_f32_16x16x32_bf16 v[124:127], a[164:167], v[36:39], v[124:127]
    s_waitcnt lgkmcnt(8)
    v_mfma_f32_16x16x32_bf16 v[104:107], a[168:171], v[40:43], v[104:107]
    ds_read_b64_tr_b16 v[32:33], v14 offset:16384
    v_mfma_f32_16x16x32_bf16 v[104:107], a[180:183], v[44:47], v[104:107]
    ds_read_b64_tr_b16 v[34:35], v14 offset:17408
    v_mfma_f32_16x16x32_bf16 v[108:111], a[172:175], v[40:43], v[108:111]
    ds_read_b64_tr_b16 v[36:37], v15 offset:16384
    v_mfma_f32_16x16x32_bf16 v[108:111], a[184:187], v[44:47], v[108:111]
    ds_read_b64_tr_b16 v[38:39], v15 offset:17408
    v_mfma_f32_16x16x32_bf16 v[112:115], a[176:179], v[40:43], v[112:115]
    s_waitcnt vmcnt(10)
    buffer_atomic_add v20, v19, s[24:27], s90 offen sc1
    v_mfma_f32_16x16x32_bf16 v[112:115], a[188:191], v[44:47], v[112:115]
    s_waitcnt lgkmcnt(8)
    v_mfma_f32_16x16x32_bf16 v[136:139], v[208:211], v[48:51], v[136:139]
    ds_read_b64_tr_b16 v[40:41], v12 offset:24576
    v_mfma_f32_16x16x32_bf16 v[140:143], v[212:215], v[48:51], v[140:143]
    ds_read_b64_tr_b16 v[42:43], v12 offset:25600
    v_mfma_f32_16x16x32_bf16 v[144:147], v[216:219], v[48:51], v[144:147]
    ds_read_b64_tr_b16 v[44:45], v13 offset:24576
    v_add_u32 v12, 0xfffea000, v12
    v_mfma_f32_16x16x32_bf16 v[104:107], a[192:195], v[48:51], v[104:107]
    ds_read_b64_tr_b16 v[46:47], v13 offset:25600
    v_mfma_f32_16x16x32_bf16 v[104:107], a[204:207], v[52:55], v[104:107]
    v_add_u32 v13, 0xfffea000, v13
    v_mfma_f32_16x16x32_bf16 v[108:111], a[196:199], v[48:51], v[108:111]
    v_mfma_f32_16x16x32_bf16 v[108:111], a[208:211], v[52:55], v[108:111]
    v_mfma_f32_16x16x32_bf16 v[112:115], a[200:203], v[48:51], v[112:115]
    v_mfma_f32_16x16x32_bf16 v[112:115], a[212:215], v[52:55], v[112:115]
    v_mfma_f32_16x16x32_bf16 a[240:243], v[48:51], v[48:51], a[240:243]
    s_waitcnt lgkmcnt(8)
    v_mfma_f32_16x16x32_bf16 v[104:107], a[216:219], v[24:27], v[104:107]
    ds_read_b64_tr_b16 v[48:49], v14 offset:24576
    s_lshl_b32 s52, s32, 8
    v_mfma_f32_16x16x32_bf16 v[104:107], a[228:231], v[28:31], v[104:107]
    ds_read_b64_tr_b16 v[50:51], v14 offset:25600
    s_add_u32 s52, s52, 160768
    v_mfma_f32_16x16x32_bf16 v[108:111], a[220:223], v[24:27], v[108:111]
    ds_read_b64_tr_b16 v[52:53], v15 offset:24576
    v_add_u32 v14, 0xfffea000, v14
    v_mfma_f32_16x16x32_bf16 v[108:111], a[232:235], v[28:31], v[108:111]
    ds_read_b64_tr_b16 v[54:55], v15 offset:25600
    v_lshl_add_u32 v5, v2, 4, s52
    v_mfma_f32_16x16x32_bf16 v[112:115], a[224:227], v[24:27], v[112:115]
    v_add_u32 v15, 0xfffea000, v15
    v_mfma_f32_16x16x32_bf16 v[112:115], a[236:239], v[28:31], v[112:115]
    s_waitcnt lgkmcnt(8)
    v_mfma_f32_16x16x32_bf16 v[116:119], a[168:171], v[32:35], v[116:119]
    s_barrier
    v_max_f32 v104, 0, v104
    v_mfma_f32_16x16x32_bf16 v[116:119], a[180:183], v[36:39], v[116:119]
    ds_read_b64_tr_b16 v[24:25], v8 offset:0
    v_max_f32 v105, 0, v105
    v_mfma_f32_16x16x32_bf16 v[120:123], a[172:175], v[32:35], v[120:123]
    ds_read_b64_tr_b16 v[26:27], v8 offset:1024
    v_mul_f32 v104, v104, v108
    v_mfma_f32_16x16x32_bf16 v[120:123], a[184:187], v[36:39], v[120:123]
    ds_read_b64_tr_b16 v[28:29], v9 offset:0
    v_mul_f32 v105, v105, v109
    v_mfma_f32_16x16x32_bf16 v[124:127], a[176:179], v[32:35], v[124:127]
    ds_read_b64_tr_b16 v[30:31], v9 offset:1024
    v_cvt_pk_bf16_f32 v104, v104, v105
    v_mfma_f32_16x16x32_bf16 v[124:127], a[188:191], v[36:39], v[124:127]
    v_max_f32 v106, 0, v106
    s_waitcnt lgkmcnt(8)
    v_mfma_f32_16x16x32_bf16 v[116:119], a[192:195], v[40:43], v[116:119]
    ds_read_b64_tr_b16 v[32:33], v12 offset:0
    v_max_f32 v107, 0, v107
    v_mfma_f32_16x16x32_bf16 v[116:119], a[204:207], v[44:47], v[116:119]
    ds_read_b64_tr_b16 v[34:35], v12 offset:1024
    v_mul_f32 v106, v106, v110
    v_mfma_f32_16x16x32_bf16 v[120:123], a[196:199], v[40:43], v[120:123]
    ds_read_b64_tr_b16 v[36:37], v13 offset:0
    v_mul_f32 v107, v107, v111
    v_mfma_f32_16x16x32_bf16 v[120:123], a[208:211], v[44:47], v[120:123]
    ds_read_b64_tr_b16 v[38:39], v13 offset:1024
    v_cvt_pk_bf16_f32 v106, v106, v107
    v_mfma_f32_16x16x32_bf16 v[124:127], a[200:203], v[40:43], v[124:127]
    s_mov_b64 exec, s[66:67]
    ds_write_b128 v5, a[240:243]
    s_mov_b64 exec, -1
    v_mfma_f32_16x16x32_bf16 v[124:127], a[212:215], v[44:47], v[124:127]
    s_mul_i32 s52, s32, 2560
    s_waitcnt lgkmcnt(9)
    v_mfma_f32_16x16x32_bf16 v[116:119], a[216:219], v[48:51], v[116:119]
    ds_read_b64_tr_b16 v[40:41], v10 offset:0
    s_add_u32 s52, s52, 102400
    v_mfma_f32_16x16x32_bf16 v[116:119], a[228:231], v[52:55], v[116:119]
    ds_read_b64_tr_b16 v[42:43], v10 offset:1024
    v_add_u32 v6, s52, v4
    v_mfma_f32_16x16x32_bf16 v[120:123], a[220:223], v[48:51], v[120:123]
    ds_read_b64_tr_b16 v[44:45], v11 offset:0
    ds_write_b128 v6, v[136:139] offset:0
    v_mfma_f32_16x16x32_bf16 v[120:123], a[232:235], v[52:55], v[120:123]
    ds_read_b64_tr_b16 v[46:47], v11 offset:1024
    ds_write_b128 v6, v[140:143] offset:1024
    v_mfma_f32_16x16x32_bf16 v[124:127], a[224:227], v[48:51], v[124:127]
    s_mov_b32 exec_hi, 0
    s_waitcnt lgkmcnt(11)
    ds_write_b128 v6, v[144:147] offset:2048
    s_mov_b32 exec_hi, -1
    v_mfma_f32_16x16x32_bf16 v[124:127], a[236:239], v[52:55], v[124:127]
    v_permlane32_swap_b32 v112, v114
    v_mfma_f32_16x16x32_bf16 v[136:139], v[160:163], v[24:27], 0
    ds_read_b64_tr_b16 v[48:49], v14 offset:0
    v_permlane32_swap_b32 v113, v115
    v_mfma_f32_16x16x32_bf16 v[140:143], v[164:167], v[24:27], 0
    ds_read_b64_tr_b16 v[50:51], v14 offset:1024
    v_max_f32 v112, 0, v112
    v_mfma_f32_16x16x32_bf16 v[144:147], v[168:171], v[24:27], 0
    ds_read_b64_tr_b16 v[52:53], v15 offset:0
    v_max_f32 v113, 0, v113
    v_mfma_f32_16x16x32_bf16 v[56:59], a[0:3], v[24:27], 0
    s_waitcnt lgkmcnt(11)
    ds_read_b64_tr_b16 v[54:55], v15 offset:1024
    v_mfma_f32_16x16x32_bf16 v[56:59], a[12:15], v[28:31], v[56:59]
    v_mul_f32 v112, v112, v114
    v_mul_f32 v113, v113, v115
    v_mfma_f32_16x16x32_bf16 v[60:63], a[4:7], v[24:27], 0
    v_cvt_pk_bf16_f32 v108, v112, v113
    v_max_f32 v116, 0, v116
    v_mfma_f32_16x16x32_bf16 v[60:63], a[16:19], v[28:31], v[60:63]
    v_max_f32 v117, 0, v117
    v_mul_f32 v116, v116, v120
    v_mfma_f32_16x16x32_bf16 v[64:67], a[8:11], v[24:27], 0
    v_and_b32 v26, v21, v26
    v_mul_f32 v117, v117, v121
    v_mfma_f32_16x16x32_bf16 v[64:67], a[20:23], v[28:31], v[64:67]
    v_cvt_pk_bf16_f32 v105, v116, v117
    v_max_f32 v118, 0, v118
    v_mfma_f32_16x16x32_bf16 a[240:243], v[24:27], v[24:27], 0
    v_max_f32 v119, 0, v119
    v_mfma_f32_16x16x32_bf16 v[68:71], a[0:3], v[32:35], 0
    ds_read_b64_tr_b16 v[24:25], v8 offset:8192
    v_mul_f32 v118, v118, v122
    v_mfma_f32_16x16x32_bf16 v[68:71], a[12:15], v[36:39], v[68:71]
    ds_read_b64_tr_b16 v[26:27], v8 offset:9216
    v_mul_f32 v119, v119, v123
    v_mfma_f32_16x16x32_bf16 v[72:75], a[4:7], v[32:35], 0
    ds_read_b64_tr_b16 v[28:29], v9 offset:8192
    v_cvt_pk_bf16_f32 v107, v118, v119
    v_mfma_f32_16x16x32_bf16 v[72:75], a[16:19], v[36:39], v[72:75]
    s_waitcnt lgkmcnt(11)
    ds_read_b64_tr_b16 v[30:31], v9 offset:9216
    v_mfma_f32_16x16x32_bf16 v[76:79], a[8:11], v[32:35], 0
    v_permlane32_swap_b32 v124, v126
    v_permlane32_swap_b32 v125, v127
    v_mfma_f32_16x16x32_bf16 v[76:79], a[20:23], v[36:39], v[76:79]
    v_permlane32_swap_b32 v104, v106
    s_waitcnt lgkmcnt(10)
    v_mfma_f32_16x16x32_bf16 v[56:59], a[24:27], v[40:43], v[56:59]
    ds_read_b64_tr_b16 v[32:33], v12 offset:8192
    buffer_load_dwordx4 a[0:3], v4, s[24:27], s73 offen offset:3072 sc1
    v_mfma_f32_16x16x32_bf16 v[56:59], a[36:39], v[44:47], v[56:59]
    ds_read_b64_tr_b16 v[34:35], v12 offset:9216
    s_add_u32 s73, s88, 32768
    v_mfma_f32_16x16x32_bf16 v[60:63], a[28:31], v[40:43], v[60:63]
    ds_read_b64_tr_b16 v[36:37], v13 offset:8192
    v_permlane32_swap_b32 v105, v107
    v_mfma_f32_16x16x32_bf16 v[60:63], a[40:43], v[44:47], v[60:63]
    ds_read_b64_tr_b16 v[38:39], v13 offset:9216
    buffer_load_dwordx4 a[4:7], v4, s[24:27], s73 offen offset:0 sc1
    v_mfma_f32_16x16x32_bf16 v[64:67], a[32:35], v[40:43], v[64:67]
    v_permlane16_swap_b32 v104, v105
    v_permlane16_swap_b32 v106, v107
    v_mfma_f32_16x16x32_bf16 v[64:67], a[44:47], v[44:47], v[64:67]
    buffer_store_dwordx4 v[104:107], v17, s[24:27], s78 offen offset:0 sc1
    s_waitcnt lgkmcnt(8)
    v_mfma_f32_16x16x32_bf16 v[68:71], a[24:27], v[48:51], v[68:71]
    ds_read_b64_tr_b16 v[40:41], v10 offset:8192
    v_mov_b32 v18, 0
    v_mfma_f32_16x16x32_bf16 v[68:71], a[36:39], v[52:55], v[68:71]
    ds_read_b64_tr_b16 v[42:43], v10 offset:9216
    buffer_atomic_add v18, v19, s[24:27], s91 offen sc0 sc1
    v_mfma_f32_16x16x32_bf16 v[72:75], a[28:31], v[48:51], v[72:75]
    ds_read_b64_tr_b16 v[44:45], v11 offset:8192
    v_max_f32 v124, 0, v124
    v_mfma_f32_16x16x32_bf16 v[72:75], a[40:43], v[52:55], v[72:75]
    ds_read_b64_tr_b16 v[46:47], v11 offset:9216
    v_max_f32 v125, 0, v125
    v_mfma_f32_16x16x32_bf16 v[76:79], a[32:35], v[48:51], v[76:79]
    buffer_load_dwordx4 a[8:11], v4, s[24:27], s73 offen offset:1024 sc1
    v_mul_f32 v124, v124, v126
    v_mfma_f32_16x16x32_bf16 v[76:79], a[44:47], v[52:55], v[76:79]
    v_mul_f32 v125, v125, v127
    s_waitcnt lgkmcnt(8)
    v_mfma_f32_16x16x32_bf16 v[136:139], v[172:175], v[24:27], v[136:139]
    ds_read_b64_tr_b16 v[48:49], v14 offset:8192
    v_cvt_pk_bf16_f32 v109, v124, v125
    v_mfma_f32_16x16x32_bf16 v[140:143], v[176:179], v[24:27], v[140:143]
    ds_read_b64_tr_b16 v[50:51], v14 offset:9216
    v_permlane32_swap_b32 v108, v110
    v_mfma_f32_16x16x32_bf16 v[144:147], v[180:183], v[24:27], v[144:147]
    ds_read_b64_tr_b16 v[52:53], v15 offset:8192
    v_permlane32_swap_b32 v109, v111
    v_mfma_f32_16x16x32_bf16 v[56:59], a[48:51], v[24:27], v[56:59]
    ds_read_b64_tr_b16 v[54:55], v15 offset:9216
    buffer_load_dwordx4 a[12:15], v4, s[24:27], s73 offen offset:2048 sc1
    v_mfma_f32_16x16x32_bf16 v[56:59], a[60:63], v[28:31], v[56:59]
    v_permlane16_swap_b32 v108, v109
    v_permlane16_swap_b32 v110, v111
    v_mfma_f32_16x16x32_bf16 v[60:63], a[52:55], v[24:27], v[60:63]
    s_mov_b32 exec_hi, 0
    buffer_store_dwordx4 v[108:111], v17, s[24:27], s78 offen offset:512 sc1
    s_mov_b32 exec_hi, -1
    v_mfma_f32_16x16x32_bf16 v[60:63], a[64:67], v[28:31], v[60:63]
    v_mov_b32 v20, 32
    v_mfma_f32_16x16x32_bf16 v[64:67], a[56:59], v[24:27], v[64:67]
    v_mfma_f32_16x16x32_bf16 v[64:67], a[68:71], v[28:31], v[64:67]
    buffer_load_dwordx4 a[16:19], v4, s[24:27], s73 offen offset:3072 sc1
    v_mfma_f32_16x16x32_bf16 a[240:243], v[24:27], v[24:27], a[240:243]
    s_waitcnt lgkmcnt(8)
    v_mfma_f32_16x16x32_bf16 v[68:71], a[48:51], v[32:35], v[68:71]
    ds_read_b64_tr_b16 v[24:25], v8 offset:16384
    v_mfma_f32_16x16x32_bf16 v[68:71], a[60:63], v[36:39], v[68:71]
    ds_read_b64_tr_b16 v[26:27], v8 offset:17408
    v_mfma_f32_16x16x32_bf16 v[72:75], a[52:55], v[32:35], v[72:75]
    ds_read_b64_tr_b16 v[28:29], v9 offset:16384
    s_add_u32 s73, s88, 36864
    v_mfma_f32_16x16x32_bf16 v[72:75], a[64:67], v[36:39], v[72:75]
    ds_read_b64_tr_b16 v[30:31], v9 offset:17408
    v_mfma_f32_16x16x32_bf16 v[76:79], a[56:59], v[32:35], v[76:79]
    buffer_load_dwordx4 a[20:23], v4, s[24:27], s73 offen offset:0 sc1
    v_mfma_f32_16x16x32_bf16 v[76:79], a[68:71], v[36:39], v[76:79]
    s_waitcnt lgkmcnt(8)
    v_mfma_f32_16x16x32_bf16 v[56:59], a[72:75], v[40:43], v[56:59]
    ds_read_b64_tr_b16 v[32:33], v12 offset:16384
    v_mfma_f32_16x16x32_bf16 v[56:59], a[84:87], v[44:47], v[56:59]
    ds_read_b64_tr_b16 v[34:35], v12 offset:17408
    v_mfma_f32_16x16x32_bf16 v[60:63], a[76:79], v[40:43], v[60:63]
    ds_read_b64_tr_b16 v[36:37], v13 offset:16384
    v_mfma_f32_16x16x32_bf16 v[60:63], a[88:91], v[44:47], v[60:63]
    ds_read_b64_tr_b16 v[38:39], v13 offset:17408
    buffer_load_dwordx4 a[24:27], v4, s[24:27], s73 offen offset:1024 sc1
    v_mfma_f32_16x16x32_bf16 v[64:67], a[80:83], v[40:43], v[64:67]
    v_mfma_f32_16x16x32_bf16 v[64:67], a[92:95], v[44:47], v[64:67]
    s_waitcnt lgkmcnt(8)
    v_mfma_f32_16x16x32_bf16 v[68:71], a[72:75], v[48:51], v[68:71]
    ds_read_b64_tr_b16 v[40:41], v10 offset:16384
    v_mfma_f32_16x16x32_bf16 v[68:71], a[84:87], v[52:55], v[68:71]
    ds_read_b64_tr_b16 v[42:43], v10 offset:17408
    v_mfma_f32_16x16x32_bf16 v[72:75], a[76:79], v[48:51], v[72:75]
    ds_read_b64_tr_b16 v[44:45], v11 offset:16384
    buffer_load_dwordx4 a[28:31], v4, s[24:27], s73 offen offset:2048 sc1
    v_mfma_f32_16x16x32_bf16 v[72:75], a[88:91], v[52:55], v[72:75]
    ds_read_b64_tr_b16 v[46:47], v11 offset:17408
    v_mfma_f32_16x16x32_bf16 v[76:79], a[80:83], v[48:51], v[76:79]
    v_mfma_f32_16x16x32_bf16 v[76:79], a[92:95], v[52:55], v[76:79]
    buffer_load_dwordx4 a[32:35], v4, s[24:27], s73 offen offset:3072 sc1
    s_waitcnt lgkmcnt(8)
    v_mfma_f32_16x16x32_bf16 v[136:139], v[184:187], v[24:27], v[136:139]
    ds_read_b64_tr_b16 v[48:49], v14 offset:16384
    v_mfma_f32_16x16x32_bf16 v[140:143], v[188:191], v[24:27], v[140:143]
    ds_read_b64_tr_b16 v[50:51], v14 offset:17408
    v_mfma_f32_16x16x32_bf16 v[144:147], v[192:195], v[24:27], v[144:147]
    ds_read_b64_tr_b16 v[52:53], v15 offset:16384
    s_add_u32 s73, s88, 40960
    v_mfma_f32_16x16x32_bf16 v[56:59], a[96:99], v[24:27], v[56:59]
    ds_read_b64_tr_b16 v[54:55], v15 offset:17408
    v_mfma_f32_16x16x32_bf16 v[56:59], a[108:111], v[28:31], v[56:59]
    buffer_load_dwordx4 a[36:39], v4, s[24:27], s73 offen offset:0 sc1
    v_mfma_f32_16x16x32_bf16 v[60:63], a[100:103], v[24:27], v[60:63]
    v_mfma_f32_16x16x32_bf16 v[60:63], a[112:115], v[28:31], v[60:63]
    v_mfma_f32_16x16x32_bf16 v[64:67], a[104:107], v[24:27], v[64:67]
    v_mfma_f32_16x16x32_bf16 v[64:67], a[116:119], v[28:31], v[64:67]
    buffer_load_dwordx4 a[40:43], v4, s[24:27], s73 offen offset:1024 sc1
    v_mfma_f32_16x16x32_bf16 a[240:243], v[24:27], v[24:27], a[240:243]
    s_waitcnt lgkmcnt(8)
    v_mfma_f32_16x16x32_bf16 v[68:71], a[96:99], v[32:35], v[68:71]
    ds_read_b64_tr_b16 v[24:25], v8 offset:24576
    v_mfma_f32_16x16x32_bf16 v[68:71], a[108:111], v[36:39], v[68:71]
    ds_read_b64_tr_b16 v[26:27], v8 offset:25600
    v_mfma_f32_16x16x32_bf16 v[72:75], a[100:103], v[32:35], v[72:75]
    ds_read_b64_tr_b16 v[28:29], v9 offset:24576
    v_mfma_f32_16x16x32_bf16 v[72:75], a[112:115], v[36:39], v[72:75]
    ds_read_b64_tr_b16 v[30:31], v9 offset:25600
    v_mfma_f32_16x16x32_bf16 v[76:79], a[104:107], v[32:35], v[76:79]
    buffer_load_dwordx4 a[44:47], v4, s[24:27], s73 offen offset:2048 sc1
    v_mfma_f32_16x16x32_bf16 v[76:79], a[116:119], v[36:39], v[76:79]
    s_waitcnt lgkmcnt(8)
    v_mfma_f32_16x16x32_bf16 v[56:59], a[120:123], v[40:43], v[56:59]
    s_waitcnt vmcnt(11)
    v_cmp_le_u32 vcc, 554188800, v18
    s_cbranch_vccz L_fw_94
L_fd_96:
    v_mfma_f32_16x16x32_bf16 v[56:59], a[132:135], v[44:47], v[56:59]
    ds_read_b64_tr_b16 v[32:33], v12 offset:24576
    v_mfma_f32_16x16x32_bf16 v[60:63], a[124:127], v[40:43], v[60:63]
    ds_read_b64_tr_b16 v[34:35], v12 offset:25600
    buffer_load_dwordx4 v[124:127], v4, s[24:27], s87 offen offset:0 sc1
    v_mfma_f32_16x16x32_bf16 v[60:63], a[136:139], v[44:47], v[60:63]
    ds_read_b64_tr_b16 v[36:37], v13 offset:24576
    v_mfma_f32_16x16x32_bf16 v[64:67], a[128:131], v[40:43], v[64:67]
    ds_read_b64_tr_b16 v[38:39], v13 offset:25600
    v_mfma_f32_16x16x32_bf16 v[64:67], a[140:143], v[44:47], v[64:67]
    s_waitcnt lgkmcnt(8)
    v_mfma_f32_16x16x32_bf16 v[68:71], a[120:123], v[48:51], v[68:71]
    ds_read_b64_tr_b16 v[40:41], v10 offset:24576
    v_mfma_f32_16x16x32_bf16 v[68:71], a[132:135], v[52:55], v[68:71]
    ds_read_b64_tr_b16 v[42:43], v10 offset:25600
    buffer_load_dwordx4 v[172:175], v4, s[24:27], s87 offen offset:1024 sc1
    v_mfma_f32_16x16x32_bf16 v[72:75], a[124:127], v[48:51], v[72:75]
    ds_read_b64_tr_b16 v[44:45], v11 offset:24576
    v_mfma_f32_16x16x32_bf16 v[72:75], a[136:139], v[52:55], v[72:75]
    ds_read_b64_tr_b16 v[46:47], v11 offset:25600
    s_add_u32 s70, s87, 98304
    v_mfma_f32_16x16x32_bf16 v[76:79], a[128:131], v[48:51], v[76:79]
    buffer_load_dwordx4 v[176:179], v4, s[24:27], s70 offen offset:0 sc1
    v_mfma_f32_16x16x32_bf16 v[76:79], a[140:143], v[52:55], v[76:79]
    s_waitcnt lgkmcnt(8)
    v_mfma_f32_16x16x32_bf16 v[136:139], v[196:199], v[24:27], v[136:139]
    ds_read_b64_tr_b16 v[48:49], v8 offset:32768
    v_mfma_f32_16x16x32_bf16 v[140:143], v[200:203], v[24:27], v[140:143]
    ds_read_b64_tr_b16 v[50:51], v8 offset:33792
    v_mfma_f32_16x16x32_bf16 v[144:147], v[204:207], v[24:27], v[144:147]
    ds_read_b64_tr_b16 v[52:53], v9 offset:32768
    v_mfma_f32_16x16x32_bf16 v[56:59], a[144:147], v[24:27], v[56:59]
    ds_read_b64_tr_b16 v[54:55], v9 offset:33792
    v_mfma_f32_16x16x32_bf16 v[56:59], a[156:159], v[28:31], v[56:59]
    buffer_load_dwordx4 v[180:183], v4, s[24:27], s70 offen offset:1024 sc1
    v_mfma_f32_16x16x32_bf16 v[60:63], a[148:151], v[24:27], v[60:63]
    v_mfma_f32_16x16x32_bf16 v[60:63], a[160:163], v[28:31], v[60:63]
    s_waitcnt vmcnt(12)
    buffer_atomic_add v20, v19, s[24:27], s90 offen sc1
    v_mfma_f32_16x16x32_bf16 v[64:67], a[152:155], v[24:27], v[64:67]
    buffer_load_dwordx4 a[48:51], v4, s[24:27], s87 offen offset:2048 sc1
    v_mfma_f32_16x16x32_bf16 v[64:67], a[164:167], v[28:31], v[64:67]
    v_mfma_f32_16x16x32_bf16 a[240:243], v[24:27], v[24:27], a[240:243]
    s_waitcnt lgkmcnt(8)
    v_mfma_f32_16x16x32_bf16 v[68:71], a[144:147], v[32:35], v[68:71]
    ds_read_b64_tr_b16 v[24:25], v10 offset:32768
    v_add_u32 v133, s85, v4
    v_add_u32 v133, 0xa000, v133
    v_mfma_f32_16x16x32_bf16 v[68:71], a[156:159], v[36:39], v[68:71]
    ds_read_b64_tr_b16 v[26:27], v10 offset:33792
    ds_read_b128 a[52:55], v133 offset:0
    v_mfma_f32_16x16x32_bf16 v[72:75], a[148:151], v[32:35], v[72:75]
    ds_read_b64_tr_b16 v[28:29], v11 offset:32768
    ds_read_b128 a[56:59], v133 offset:1024
    v_mfma_f32_16x16x32_bf16 v[72:75], a[160:163], v[36:39], v[72:75]
    ds_read_b64_tr_b16 v[30:31], v11 offset:33792
    buffer_load_dwordx4 a[60:63], v4, s[24:27], s87 offen offset:3072 sc1
    v_mfma_f32_16x16x32_bf16 v[76:79], a[152:155], v[32:35], v[76:79]
    ds_read_b128 a[64:67], v133 offset:8192
    s_waitcnt lgkmcnt(11)
    ds_read_b128 a[68:71], v133 offset:9216
    v_mfma_f32_16x16x32_bf16 v[76:79], a[164:167], v[36:39], v[76:79]
    ds_read_b128 a[72:75], v133 offset:16384
    v_mfma_f32_16x16x32_bf16 v[56:59], a[168:171], v[40:43], v[56:59]
    ds_read_b64_tr_b16 v[32:33], v14 offset:24576
    ds_read_b128 a[76:79], v133 offset:17408
    v_mfma_f32_16x16x32_bf16 v[56:59], a[180:183], v[44:47], v[56:59]
    s_waitcnt lgkmcnt(11)
    ds_read_b64_tr_b16 v[34:35], v14 offset:25600
    v_mfma_f32_16x16x32_bf16 v[60:63], a[172:175], v[40:43], v[60:63]
    ds_read_b64_tr_b16 v[36:37], v15 offset:24576
    buffer_load_dwordx4 a[80:83], v4, s[24:27], s70 offen offset:2048 sc1
    v_mfma_f32_16x16x32_bf16 v[60:63], a[184:187], v[44:47], v[60:63]
    ds_read_b64_tr_b16 v[38:39], v15 offset:25600
    ds_read_b128 a[84:87], v133 offset:24576
    v_mfma_f32_16x16x32_bf16 v[64:67], a[176:179], v[40:43], v[64:67]
    buffer_load_dwordx4 a[88:91], v4, s[24:27], s70 offen offset:3072 sc1
    s_waitcnt lgkmcnt(11)
    ds_read_b128 a[92:95], v133 offset:25600
    v_mfma_f32_16x16x32_bf16 v[64:67], a[188:191], v[44:47], v[64:67]
    ds_read_b128 v[184:187], v133 offset:32768
    v_mfma_f32_16x16x32_bf16 v[136:139], v[208:211], v[48:51], v[136:139]
    ds_read_b64_tr_b16 v[40:41], v12 offset:32768
    ds_read_b128 v[188:191], v133 offset:33792
    v_add_u32 v133, 0x14000, v133
    v_mfma_f32_16x16x32_bf16 v[140:143], v[212:215], v[48:51], v[140:143]
    s_waitcnt lgkmcnt(11)
    ds_read_b64_tr_b16 v[42:43], v12 offset:33792
    v_mfma_f32_16x16x32_bf16 v[144:147], v[216:219], v[48:51], v[144:147]
    ds_read_b64_tr_b16 v[44:45], v13 offset:32768
    s_add_u32 s69, s87, 4096
    v_mfma_f32_16x16x32_bf16 v[56:59], a[192:195], v[48:51], v[56:59]
    ds_read_b64_tr_b16 v[46:47], v13 offset:33792
    ds_read_b128 v[192:195], v133 offset:0
    v_mfma_f32_16x16x32_bf16 v[56:59], a[204:207], v[52:55], v[56:59]
    buffer_load_dwordx4 a[96:99], v4, s[24:27], s69 offen offset:0 sc1
    v_mfma_f32_16x16x32_bf16 v[60:63], a[196:199], v[48:51], v[60:63]
    v_mfma_f32_16x16x32_bf16 v[60:63], a[208:211], v[52:55], v[60:63]
    v_mfma_f32_16x16x32_bf16 v[64:67], a[200:203], v[48:51], v[64:67]
    buffer_load_dwordx4 a[100:103], v4, s[24:27], s69 offen offset:1024 sc1
    v_mfma_f32_16x16x32_bf16 v[64:67], a[212:215], v[52:55], v[64:67]
    v_mfma_f32_16x16x32_bf16 a[240:243], v[48:51], v[48:51], a[240:243]
    v_mfma_f32_16x16x32_bf16 v[56:59], a[216:219], v[24:27], v[56:59]
    s_waitcnt lgkmcnt(11)
    ds_read_b64_tr_b16 v[48:49], v14 offset:32768
    v_mfma_f32_16x16x32_bf16 v[56:59], a[228:231], v[28:31], v[56:59]
    ds_read_b64_tr_b16 v[50:51], v14 offset:33792
    s_add_u32 s70, s87, 102400
    v_mfma_f32_16x16x32_bf16 v[60:63], a[220:223], v[24:27], v[60:63]
    ds_read_b64_tr_b16 v[52:53], v15 offset:32768
    s_lshl_b32 s52, s32, 8
    v_mfma_f32_16x16x32_bf16 v[60:63], a[232:235], v[28:31], v[60:63]
    ds_read_b64_tr_b16 v[54:55], v15 offset:33792
    buffer_load_dwordx4 a[104:107], v4, s[24:27], s70 offen offset:0 sc1
    v_mfma_f32_16x16x32_bf16 v[64:67], a[224:227], v[24:27], v[64:67]
    s_add_u32 s52, s52, 161792
    v_lshl_add_u32 v5, v2, 4, s52
    v_mfma_f32_16x16x32_bf16 v[64:67], a[236:239], v[28:31], v[64:67]
    s_waitcnt lgkmcnt(13)
    v_mfma_f32_16x16x32_bf16 v[68:71], a[168:171], v[32:35], v[68:71]
    buffer_load_dwordx4 a[108:111], v4, s[24:27], s70 offen offset:1024 sc1
    v_max_f32 v56, 0, v56
    v_mfma_f32_16x16x32_bf16 v[68:71], a[180:183], v[36:39], v[68:71]
    s_mov_b64 exec, s[66:67]
    ds_write_b128 v5, a[240:243]
    s_mov_b64 exec, -1
    v_mfma_f32_16x16x32_bf16 v[72:75], a[172:175], v[32:35], v[72:75]
    s_mul_i32 s52, s32, 2560
    s_add_u32 s52, s52, 92160
    v_mfma_f32_16x16x32_bf16 v[72:75], a[184:187], v[36:39], v[72:75]
    buffer_load_dwordx4 a[112:115], v4, s[24:27], s69 offen offset:2048 sc1
    v_add_u32 v6, s52, v4
    v_mfma_f32_16x16x32_bf16 v[76:79], a[176:179], v[32:35], v[76:79]
    ds_write_b128 v6, v[136:139] offset:0
    s_waitcnt lgkmcnt(11)
    ds_write_b128 v6, v[140:143] offset:1024
    v_mfma_f32_16x16x32_bf16 v[76:79], a[188:191], v[36:39], v[76:79]
    buffer_load_dwordx4 a[116:119], v4, s[24:27], s69 offen offset:3072 sc1
    s_waitcnt lgkmcnt(8)
    v_mfma_f32_16x16x32_bf16 v[68:71], a[192:195], v[40:43], v[68:71]
    s_mov_b32 exec_hi, 0
    ds_write_b128 v6, v[144:147] offset:2048
    s_mov_b32 exec_hi, -1
    v_mfma_f32_16x16x32_bf16 v[68:71], a[204:207], v[44:47], v[68:71]
    buffer_load_dwordx4 a[120:123], v4, s[24:27], s70 offen offset:2048 sc1
    v_max_f32 v57, 0, v57
    v_mfma_f32_16x16x32_bf16 v[72:75], a[196:199], v[40:43], v[72:75]
    v_mul_f32 v56, v56, v60
    v_mul_f32 v57, v57, v61
    v_mfma_f32_16x16x32_bf16 v[72:75], a[208:211], v[44:47], v[72:75]
    v_cvt_pk_bf16_f32 v56, v56, v57
    v_max_f32 v58, 0, v58
    v_mfma_f32_16x16x32_bf16 v[76:79], a[200:203], v[40:43], v[76:79]
    buffer_load_dwordx4 a[124:127], v4, s[24:27], s70 offen offset:3072 sc1
    v_max_f32 v59, 0, v59
    v_mfma_f32_16x16x32_bf16 v[76:79], a[212:215], v[44:47], v[76:79]
    v_mul_f32 v58, v58, v62
    s_waitcnt lgkmcnt(4)
    v_mfma_f32_16x16x32_bf16 v[68:71], a[216:219], v[48:51], v[68:71]
    v_mul_f32 v59, v59, v63
    v_cvt_pk_bf16_f32 v58, v58, v59
    v_mfma_f32_16x16x32_bf16 v[68:71], a[228:231], v[52:55], v[68:71]
    v_permlane32_swap_b32 v64, v66
    v_permlane32_swap_b32 v65, v67
    v_mfma_f32_16x16x32_bf16 v[72:75], a[220:223], v[48:51], v[72:75]
    s_add_u32 s69, s87, 8192
    v_max_f32 v64, 0, v64
    v_mfma_f32_16x16x32_bf16 v[72:75], a[232:235], v[52:55], v[72:75]
    buffer_load_dwordx4 a[128:131], v4, s[24:27], s69 offen offset:0 sc1
    v_max_f32 v65, 0, v65
    v_mfma_f32_16x16x32_bf16 v[76:79], a[224:227], v[48:51], v[76:79]
    v_mul_f32 v64, v64, v66
    v_mul_f32 v65, v65, v67
    v_mfma_f32_16x16x32_bf16 v[76:79], a[236:239], v[52:55], v[76:79]
    v_cvt_pk_bf16_f32 v60, v64, v65
    v_max_f32 v68, 0, v68
    v_max_f32 v69, 0, v69
    v_mul_f32 v68, v68, v72
    v_mul_f32 v69, v69, v73
    v_cvt_pk_bf16_f32 v57, v68, v69
    v_max_f32 v70, 0, v70
    v_max_f32 v71, 0, v71
    v_mul_f32 v70, v70, v74
    v_mul_f32 v71, v71, v75
    v_cvt_pk_bf16_f32 v59, v70, v71
    v_permlane32_swap_b32 v76, v78
    v_permlane32_swap_b32 v77, v79
    v_permlane32_swap_b32 v56, v58
    s_branch L_pgx12
L_pg12:
    s_setpc_b64 s[40:41]
L_pgx12:
    v_permlane32_swap_b32 v57, v59
    s_nop 1
    v_permlane16_swap_b32 v56, v57
    v_permlane16_swap_b32 v58, v59
    buffer_store_dwordx4 v[56:59], v17, s[24:27], s79 offen offset:0 sc1
    v_max_f32 v76, 0, v76
    v_max_f32 v77, 0, v77
    v_mul_f32 v76, v76, v78
    v_mul_f32 v77, v77, v79
    v_cvt_pk_bf16_f32 v61, v76, v77
    v_permlane32_swap_b32 v60, v62
    s_nop 0
    v_permlane32_swap_b32 v61, v63
    s_nop 1
    v_permlane16_swap_b32 v60, v61
    v_permlane16_swap_b32 v62, v63
    s_mov_b32 exec_hi, 0
    buffer_store_dwordx4 v[60:63], v17, s[24:27], s79 offen offset:512 sc1
    s_mov_b32 exec_hi, -1
    v_mov_b32 v20, 1
    s_waitcnt vmcnt(19)
    v_mfma_f32_16x16x32_bf16 a[192:195], v[220:223], v[124:127], 0
    buffer_load_dwordx4 a[132:135], v4, s[24:27], s69 offen offset:1024 sc1
    s_mul_i32 s50, s32, 5120
    s_waitcnt vmcnt(19)
    v_mfma_f32_16x16x32_bf16 a[192:195], v[240:243], v[172:175], a[192:195]
    v_add_u32 v8, s50, v4
    s_lshl_b32 s50, s32, 8
    v_mfma_f32_16x16x32_bf16 a[196:199], v[224:227], v[124:127], 0
    v_lshl_add_u32 v10, v2, 4, s50
    v_lshl_add_u32 v9, v3, 10, v10
    v_mfma_f32_16x16x32_bf16 a[196:199], v[244:247], v[172:175], a[196:199]
    v_mul_u32_u24 v7, 20480, v3
    v_add_u32 v10, v10, v7
    v_mfma_f32_16x16x32_bf16 a[200:203], v[228:231], v[124:127], 0
    buffer_load_dwordx4 a[136:139], v4, s[24:27], s73 offen offset:3072 sc1
    v_and_b32 v7, 3, v2
    v_mfma_f32_16x16x32_bf16 a[200:203], v[248:251], v[172:175], a[200:203]
    v_lshl_add_u32 v7, v2, 2, v7
    v_lshlrev_b32 v7, 2, v7
    v_mfma_f32_16x16x32_bf16 a[204:207], v[232:235], v[124:127], 0
    v_add_u32 v11, 158720, v7
    v_lshl_add_u32 v12, v3, 10, v11
    v_mfma_f32_16x16x32_bf16 a[204:207], a[248:251], v[172:175], a[204:207]
    s_add_u32 s73, s88, 45056
    s_mov_b32 s51, 0x3acccccd
    v_mfma_f32_16x16x32_bf16 a[208:211], v[236:239], v[124:127], 0
    buffer_load_dwordx4 a[140:143], v4, s[24:27], s73 offen offset:0 sc1
    v_mov_b32 v7, 0x3727c5ac
    v_mfma_f32_16x16x32_bf16 a[208:211], a[252:255], v[172:175], a[208:211]
    s_and_b32 s50, s32, 1
    s_mul_i32 s50, s50, 1280
    s_waitcnt vmcnt(20)
    v_mfma_f32_16x16x32_bf16 a[212:215], v[220:223], v[176:179], 0
    s_add_u32 s50, s50, 92160
    v_add_u32 v13, s50, v4
    s_waitcnt vmcnt(19)
    v_mfma_f32_16x16x32_bf16 a[212:215], v[240:243], v[180:183], a[212:215]
    v_and_b32 v14, 2, v3
    v_mul_u32_u24 v14, 12800, v14
    v_mfma_f32_16x16x32_bf16 a[216:219], v[224:227], v[176:179], 0
    buffer_load_dwordx4 v[196:199], v4, s[24:27], s73 offen offset:1024 sc1
    v_sub_u32 v14, v13, v14
    v_mfma_f32_16x16x32_bf16 a[216:219], v[244:247], v[180:183], a[216:219]
    s_mov_b32 s50, -10496
    v_mad_i32_i24 v14, v3, s50, v14
    v_mfma_f32_16x16x32_bf16 a[220:223], v[228:231], v[176:179], 0
    v_mfma_f32_16x16x32_bf16 a[220:223], v[248:251], v[180:183], a[220:223]
    v_mfma_f32_16x16x32_bf16 a[224:227], v[232:235], v[176:179], 0
    v_mfma_f32_16x16x32_bf16 a[224:227], a[248:251], v[180:183], a[224:227]
    buffer_load_dwordx4 v[200:203], v4, s[24:27], s73 offen offset:2048 sc1
    v_mfma_f32_16x16x32_bf16 a[228:231], v[236:239], v[176:179], 0
    v_mfma_f32_16x16x32_bf16 a[228:231], a[252:255], v[180:183], a[228:231]
    s_waitcnt vmcnt(19)
    v_mfma_f32_16x16x32_bf16 a[192:195], a[52:55], a[48:51], a[192:195]
    s_waitcnt lgkmcnt(0)
    s_barrier
    v_mov_b32 v18, 0
    s_waitcnt vmcnt(18)
    v_mfma_f32_16x16x32_bf16 a[192:195], a[76:79], a[60:63], a[192:195]
    buffer_load_dwordx4 v[204:207], v4, s[24:27], s73 offen offset:3072 sc1
    buffer_atomic_add v18, v19, s[24:27], s91 offen sc0 sc1
    v_mfma_f32_16x16x32_bf16 a[196:199], a[56:59], a[48:51], a[196:199]
    ds_read2st64_b32 v[24:25], v11 offset0:0 offset1:1
    ds_read2st64_b32 v[26:27], v11 offset0:2 offset1:3
    v_mfma_f32_16x16x32_bf16 a[196:199], a[84:87], a[60:63], a[196:199]
    s_add_u32 s73, s88, 49152
    ds_read2st64_b32 v[28:29], v11 offset0:4 offset1:5
    v_mfma_f32_16x16x32_bf16 a[200:203], a[64:67], a[48:51], a[200:203]
    buffer_load_dwordx4 a[144:147], v4, s[24:27], s73 offen offset:0 sc1
    ds_read2st64_b32 v[30:31], v11 offset0:6 offset1:7
    v_mfma_f32_16x16x32_bf16 a[200:203], a[92:95], a[60:63], a[200:203]
    ds_read2st64_b32 v[32:33], v11 offset0:8 offset1:9
    ds_read2st64_b32 v[34:35], v11 offset0:10 offset1:11
    v_mfma_f32_16x16x32_bf16 a[204:207], a[68:71], a[48:51], a[204:207]
    ds_read2st64_b32 v[36:37], v11 offset0:12 offset1:13
    ds_read2st64_b32 v[38:39], v11 offset0:14 offset1:15
    v_mfma_f32_16x16x32_bf16 a[204:207], v[184:187], a[60:63], a[204:207]
    ds_read2st64_b32 v[40:41], v12 offset0:0 offset1:1
    ds_read2st64_b32 v[42:43], v12 offset0:2 offset1:3
    v_mfma_f32_16x16x32_bf16 a[208:211], a[72:75], a[48:51], a[208:211]
    v_mfma_f32_16x16x32_bf16 a[208:211], v[188:191], a[60:63], a[208:211]
    buffer_load_dwordx4 a[148:151], v4, s[24:27], s73 offen offset:1024 sc1
    s_waitcnt vmcnt(21)
    v_mfma_f32_16x16x32_bf16 a[212:215], a[52:55], a[80:83], a[212:215]
    s_waitcnt vmcnt(20)
    v_mfma_f32_16x16x32_bf16 a[212:215], a[76:79], a[88:91], a[212:215]
    v_mfma_f32_16x16x32_bf16 a[216:219], a[56:59], a[80:83], a[216:219]
    s_add_u32 s70, s87, 106496
    v_mfma_f32_16x16x32_bf16 a[216:219], a[84:87], a[88:91], a[216:219]
    buffer_load_dwordx4 a[152:155], v4, s[24:27], s70 offen offset:0 sc1
    s_waitcnt lgkmcnt(0)
    v_mfma_f32_16x16x32_bf16 a[220:223], a[64:67], a[80:83], a[220:223]
    s_waitcnt vmcnt(10)
    buffer_atomic_add v20, v19, s[24:27], s90 offen sc1
    v_mfma_f32_16x16x32_bf16 a[220:223], a[92:95], a[88:91], a[220:223]
    v_add_f32 v24, v24, v25
    v_add_f32 v26, v26, v27
    v_mfma_f32_16x16x32_bf16 a[224:227], a[68:71], a[80:83], a[224:227]
    v_add_f32 v24, v24, v26
    v_fma_f32 v24, v24, s51, v7
    v_mfma_f32_16x16x32_bf16 a[224:227], v[184:187], a[88:91], a[224:227]
    buffer_load_dwordx4 a[156:159], v4, s[24:27], s70 offen offset:1024 sc1
    v_rcp_f32 v128, v24
    v_mfma_f32_16x16x32_bf16 a[228:231], a[72:75], a[80:83], a[228:231]
    v_add_f32 v28, v28, v29
    v_add_f32 v30, v30, v31
    v_mfma_f32_16x16x32_bf16 a[228:231], v[188:191], a[88:91], a[228:231]
    v_add_f32 v28, v28, v30
    v_fma_f32 v28, v28, s51, v7
    v_mfma_f32_16x16x32_bf16 a[192:195], v[192:195], a[96:99], a[192:195]
    v_rcp_f32 v129, v28
    v_add_f32 v32, v32, v33
    v_mfma_f32_16x16x32_bf16 a[192:195], v[96:99], a[100:103], a[192:195]
    v_add_f32 v34, v34, v35
    v_add_f32 v32, v32, v34
    v_mfma_f32_16x16x32_bf16 a[196:199], v[80:83], a[96:99], a[196:199]
    buffer_load_dwordx4 a[160:163], v4, s[24:27], s69 offen offset:2048 sc1
    v_fma_f32 v32, v32, s51, v7
    v_mfma_f32_16x16x32_bf16 a[196:199], v[100:103], a[100:103], a[196:199]
    v_rcp_f32 v130, v32
    v_add_f32 v36, v36, v37
    v_mfma_f32_16x16x32_bf16 a[200:203], v[84:87], a[96:99], a[200:203]
    v_add_f32 v38, v38, v39
    v_add_f32 v36, v36, v38
    v_mfma_f32_16x16x32_bf16 a[200:203], a[244:247], a[100:103], a[200:203]
    v_fma_f32 v36, v36, s51, v7
    v_rcp_f32 v131, v36
    v_mfma_f32_16x16x32_bf16 a[204:207], v[88:91], a[96:99], a[204:207]
    buffer_load_dwordx4 a[164:167], v4, s[24:27], s69 offen offset:3072 sc1
    v_add_f32 v40, v40, v41
    v_mfma_f32_16x16x32_bf16 a[204:207], v[148:151], a[100:103], a[204:207]
    v_add_f32 v42, v42, v43
    v_add_f32 v40, v40, v42
    v_mfma_f32_16x16x32_bf16 a[208:211], v[92:95], a[96:99], a[208:211]
    v_fma_f32 v40, v40, s51, v7
    v_rcp_f32 v132, v40
    v_mfma_f32_16x16x32_bf16 a[208:211], v[152:155], a[100:103], a[208:211]
    ds_read_b128 v[24:27], v13 offset:56320
    ds_read_b128 v[28:31], v13 offset:58880
    v_mfma_f32_16x16x32_bf16 a[212:215], v[192:195], a[104:107], a[212:215]
    buffer_load_dwordx4 v[208:211], v4, s[24:27], s73 offen offset:2048 sc1
    ds_read_b128 v[32:35], v13 offset:61440
    v_mfma_f32_16x16x32_bf16 a[212:215], v[96:99], a[108:111], a[212:215]
    ds_read_b128 v[36:39], v13 offset:64000
    ds_read_b128 v[40:43], v13 offset:46080
    v_mfma_f32_16x16x32_bf16 a[216:219], v[80:83], a[104:107], a[216:219]
    ds_read_b128 v[44:47], v13 offset:48640
    ds_read_b128 v[48:51], v13 offset:51200
    v_mfma_f32_16x16x32_bf16 a[216:219], v[100:103], a[108:111], a[216:219]
    ds_read_b128 v[52:55], v13 offset:53760
    v_mfma_f32_16x16x32_bf16 a[220:223], v[84:87], a[104:107], a[220:223]
    buffer_load_dwordx4 v[212:215], v4, s[24:27], s73 offen offset:3072 sc1
    v_mfma_f32_16x16x32_bf16 a[220:223], a[244:247], a[108:111], a[220:223]
    v_mfma_f32_16x16x32_bf16 a[224:227], v[88:91], a[104:107], a[224:227]
    v_mfma_f32_16x16x32_bf16 a[224:227], v[148:151], a[108:111], a[224:227]
    s_add_u32 s73, s88, 53248
    v_mfma_f32_16x16x32_bf16 a[228:231], v[92:95], a[104:107], a[228:231]
    buffer_load_dwordx4 v[216:219], v4, s[24:27], s73 offen offset:0 sc1
    v_mfma_f32_16x16x32_bf16 a[228:231], v[152:155], a[108:111], a[228:231]
    s_waitcnt lgkmcnt(0)
    v_add_f32 v24, v24, v28
    v_mfma_f32_16x16x32_bf16 a[192:195], v[156:159], a[112:115], a[192:195]
    v_add_f32 v32, v32, v36
    v_fma_f32 v104, v32, s94, v24
    v_mfma_f32_16x16x32_bf16 a[192:195], a[16:19], a[116:119], a[192:195]
    v_add_f32 v25, v25, v29
    v_add_f32 v33, v33, v37
    v_mfma_f32_16x16x32_bf16 a[196:199], a[0:3], a[112:115], a[196:199]
    buffer_load_dwordx4 a[168:171], v4, s[24:27], s73 offen offset:1024 sc1
    v_fma_f32 v105, v33, s94, v25
    v_mfma_f32_16x16x32_bf16 a[196:199], a[20:23], a[116:119], a[196:199]
    v_add_f32 v26, v26, v30
    v_add_f32 v34, v34, v38
    v_mfma_f32_16x16x32_bf16 a[200:203], a[4:7], a[112:115], a[200:203]
    v_fma_f32 v106, v34, s94, v26
    v_add_f32 v27, v27, v31
    v_mfma_f32_16x16x32_bf16 a[200:203], a[24:27], a[116:119], a[200:203]
    v_add_f32 v35, v35, v39
    v_fma_f32 v107, v35, s94, v27
    v_mfma_f32_16x16x32_bf16 a[204:207], a[8:11], a[112:115], a[204:207]
    buffer_load_dwordx4 a[172:175], v4, s[24:27], s73 offen offset:2048 sc1
    v_add_f32 v40, v40, v44
    v_mfma_f32_16x16x32_bf16 a[204:207], a[28:31], a[116:119], a[204:207]
    v_add_f32 v48, v48, v52
    v_fma_f32 v108, v48, s94, v40
    v_mfma_f32_16x16x32_bf16 a[208:211], a[12:15], a[112:115], a[208:211]
    v_add_f32 v41, v41, v45
    v_add_f32 v49, v49, v53
    v_mfma_f32_16x16x32_bf16 a[208:211], a[32:35], a[116:119], a[208:211]
    v_fma_f32 v109, v49, s94, v41
    v_add_f32 v42, v42, v46
    v_mfma_f32_16x16x32_bf16 a[212:215], v[156:159], a[120:123], a[212:215]
    s_waitcnt vmcnt(12)
    v_cmp_le_u32 vcc, 554189312, v18
    s_cbranch_vccz L_fw_97
L_fd_99:
    v_mfma_f32_16x16x32_bf16 a[212:215], a[16:19], a[124:127], a[212:215]
    buffer_load_dwordx4 a[176:179], v4, s[24:27], s73 offen offset:3072 sc1
    v_add_f32 v50, v50, v54
    v_mfma_f32_16x16x32_bf16 a[216:219], a[0:3], a[120:123], a[216:219]
    v_fma_f32 v110, v50, s94, v42
    v_add_f32 v43, v43, v47
    v_mfma_f32_16x16x32_bf16 a[216:219], a[20:23], a[124:127], a[216:219]
    v_add_f32 v51, v51, v55
    v_fma_f32 v111, v51, s94, v43
    v_mfma_f32_16x16x32_bf16 a[220:223], a[4:7], a[120:123], a[220:223]
    s_add_u32 s73, s88, 57344
    ds_read_b128 v[24:27], v13 offset:10240
    v_mfma_f32_16x16x32_bf16 a[220:223], a[24:27], a[124:127], a[220:223]
    buffer_load_dwordx4 a[180:183], v4, s[24:27], s73 offen offset:0 sc1
    ds_read_b128 v[28:31], v13 offset:12800
    v_mfma_f32_16x16x32_bf16 a[224:227], a[8:11], a[120:123], a[224:227]
    ds_read_b128 v[32:35], v13 offset:15360
    ds_read_b128 v[36:39], v13 offset:17920
    v_mfma_f32_16x16x32_bf16 a[224:227], a[28:31], a[124:127], a[224:227]
    ds_read_b128 v[40:43], v13 offset:0
    ds_read_b128 v[44:47], v13 offset:2560
    v_mfma_f32_16x16x32_bf16 a[228:231], a[12:15], a[120:123], a[228:231]
    ds_read_b128 v[48:51], v13 offset:5120
    ds_read_b128 v[52:55], v13 offset:7680
    v_mfma_f32_16x16x32_bf16 a[228:231], a[32:35], a[124:127], a[228:231]
    buffer_load_dwordx4 a[184:187], v4, s[24:27], s73 offen offset:1024 sc1
    v_mfma_f32_16x16x32_bf16 a[192:195], a[36:39], a[128:131], a[192:195]
    v_mfma_f32_16x16x32_bf16 a[192:195], v[196:199], a[132:135], a[192:195]
    v_mfma_f32_16x16x32_bf16 a[196:199], a[40:43], a[128:131], a[196:199]
    v_mfma_f32_16x16x32_bf16 a[196:199], v[200:203], a[132:135], a[196:199]
    buffer_load_dwordx4 a[188:191], v4, s[24:27], s73 offen offset:2048 sc1
    v_mfma_f32_16x16x32_bf16 a[200:203], a[44:47], a[128:131], a[200:203]
    s_waitcnt lgkmcnt(0)
    v_add_f32 v24, v24, v28
    v_mfma_f32_16x16x32_bf16 a[200:203], v[204:207], a[132:135], a[200:203]
    v_add_f32 v32, v32, v36
    v_fma_f32 v112, v32, s94, v24
    v_mfma_f32_16x16x32_bf16 a[204:207], a[136:139], a[128:131], a[204:207]
    v_add_f32 v25, v25, v29
    v_add_f32 v33, v33, v37
    s_waitcnt vmcnt(15)
    v_mfma_f32_16x16x32_bf16 a[204:207], a[144:147], a[132:135], a[204:207]
    buffer_load_dwordx4 a[240:243], v4, s[24:27], s73 offen offset:3072 sc1
    v_fma_f32 v113, v33, s94, v25
    v_mfma_f32_16x16x32_bf16 a[208:211], a[140:143], a[128:131], a[208:211]
    v_add_f32 v26, v26, v30
    v_add_f32 v34, v34, v38
    s_waitcnt vmcnt(15)
    v_mfma_f32_16x16x32_bf16 a[208:211], a[148:151], a[132:135], a[208:211]
    v_fma_f32 v114, v34, s94, v26
    v_add_f32 v27, v27, v31
    s_waitcnt vmcnt(14)
    v_mfma_f32_16x16x32_bf16 a[212:215], a[36:39], a[152:155], a[212:215]
    v_add_f32 v35, v35, v39
    v_fma_f32 v115, v35, s94, v27
    s_waitcnt vmcnt(12)
    v_mfma_f32_16x16x32_bf16 a[212:215], v[196:199], a[156:159], a[212:215]
    buffer_load_dwordx4 v[136:139], v4, s[24:27], s70 offen offset:2048 sc1
    v_add_f32 v40, v40, v44
    v_mfma_f32_16x16x32_bf16 a[216:219], a[40:43], a[152:155], a[216:219]
    v_add_f32 v48, v48, v52
    v_fma_f32 v116, v48, s94, v40
    v_mfma_f32_16x16x32_bf16 a[216:219], v[200:203], a[156:159], a[216:219]
    v_add_f32 v41, v41, v45
    v_add_f32 v49, v49, v53
    v_mfma_f32_16x16x32_bf16 a[220:223], a[44:47], a[152:155], a[220:223]
    v_fma_f32 v117, v49, s94, v41
    v_add_f32 v42, v42, v46
    v_mfma_f32_16x16x32_bf16 a[220:223], v[204:207], a[156:159], a[220:223]
    buffer_load_dwordx4 v[140:143], v4, s[24:27], s70 offen offset:3072 sc1
    v_add_f32 v50, v50, v54
    v_mfma_f32_16x16x32_bf16 a[224:227], a[136:139], a[152:155], a[224:227]
    v_fma_f32 v118, v50, s94, v42
    v_add_f32 v43, v43, v47
    v_mfma_f32_16x16x32_bf16 a[224:227], a[144:147], a[156:159], a[224:227]
    v_add_f32 v51, v51, v55
    v_fma_f32 v119, v51, s94, v43
    v_mfma_f32_16x16x32_bf16 a[228:231], a[140:143], a[152:155], a[228:231]
    s_add_u32 s71, s87, 196608
    ds_read_b128 v[24:27], v14 offset:57344
    v_mfma_f32_16x16x32_bf16 a[228:231], a[148:151], a[156:159], a[228:231]
    buffer_load_dwordx4 v[144:147], v4, s[24:27], s71 offen offset:0 sc1
    ds_read_b128 v[28:31], v14 offset:59904
    s_waitcnt vmcnt(12)
    v_mfma_f32_16x16x32_bf16 a[192:195], v[208:211], a[160:163], a[192:195]
    v_mov_b32 v18, 0
    ds_read_b128 v[32:35], v14 offset:62464
    s_waitcnt vmcnt(7)
    v_mfma_f32_16x16x32_bf16 a[192:195], a[176:179], a[164:167], a[192:195]
    buffer_atomic_add v18, v19, s[24:27], s91 offen sc0 sc1
    ds_read_b128 v[36:39], v14 offset:65024
    v_mfma_f32_16x16x32_bf16 a[196:199], v[212:215], a[160:163], a[196:199]
    buffer_load_dwordx4 a[232:235], v4, s[24:27], s71 offen offset:1024 sc1
    s_waitcnt vmcnt(8)
    v_mfma_f32_16x16x32_bf16 a[196:199], a[180:183], a[164:167], a[196:199]
    s_nop 1
    ds_write_b128 v8, a[192:195] offset:0
    v_mfma_f32_16x16x32_bf16 a[200:203], v[216:219], a[160:163], a[200:203]
    s_waitcnt vmcnt(7)
    v_mfma_f32_16x16x32_bf16 a[200:203], a[184:187], a[164:167], a[200:203]
    buffer_load_dwordx4 a[236:239], v4, s[24:27], s71 offen offset:2048 sc1
    s_nop 0
    ds_write_b128 v8, a[196:199] offset:1024
    v_mfma_f32_16x16x32_bf16 a[204:207], a[168:171], a[160:163], a[204:207]
    s_waitcnt vmcnt(7)
    v_mfma_f32_16x16x32_bf16 a[204:207], a[188:191], a[164:167], a[204:207]
    buffer_load_dwordx4 v[124:127], v4, s[24:27], s71 offen offset:3072 sc1
    s_nop 0
    ds_write_b128 v8, a[200:203] offset:2048
    v_mfma_f32_16x16x32_bf16 a[208:211], a[172:175], a[160:163], a[208:211]
    s_add_u32 s71, s87, 200704
    s_waitcnt lgkmcnt(3)
    s_waitcnt vmcnt(7)
    v_mfma_f32_16x16x32_bf16 a[208:211], a[240:243], a[164:167], a[208:211]
    buffer_load_dwordx4 v[172:175], v4, s[24:27], s71 offen offset:0 sc1
    ds_write_b128 v8, a[204:207] offset:3072
    s_waitcnt vmcnt(7)
    v_mfma_f32_16x16x32_bf16 a[212:215], v[208:211], v[136:139], a[212:215]
    v_add_f32 v24, v24, v28
    v_add_f32 v32, v32, v36
    s_waitcnt vmcnt(6)
    v_mfma_f32_16x16x32_bf16 a[212:215], a[176:179], v[140:143], a[212:215]
    buffer_load_dwordx4 v[176:179], v4, s[24:27], s71 offen offset:1024 sc1
    ds_write_b128 v8, a[208:211] offset:4096
    v_mfma_f32_16x16x32_bf16 a[216:219], v[212:215], v[136:139], a[216:219]
    v_fma_f32 v120, v32, s94, v24
    v_add_f32 v25, v25, v29
    v_mfma_f32_16x16x32_bf16 a[216:219], a[180:183], v[140:143], a[216:219]
    buffer_load_dwordx4 v[180:183], v4, s[24:27], s71 offen offset:2048 sc1
    s_nop 0
    ds_write_b128 v8, a[212:215] offset:20480
    v_mfma_f32_16x16x32_bf16 a[220:223], v[216:219], v[136:139], a[220:223]
    v_add_f32 v33, v33, v37
    v_fma_f32 v121, v33, s94, v25
    v_mfma_f32_16x16x32_bf16 a[220:223], a[184:187], v[140:143], a[220:223]
    buffer_load_dwordx4 a[48:51], v4, s[24:27], s71 offen offset:3072 sc1
    ds_write_b128 v8, a[216:219] offset:21504
    v_mfma_f32_16x16x32_bf16 a[224:227], a[168:171], v[136:139], a[224:227]
    s_add_u32 s71, s87, 204800
    v_add_f32 v26, v26, v30
    v_mfma_f32_16x16x32_bf16 a[224:227], a[188:191], v[140:143], a[224:227]
    buffer_load_dwordx4 a[60:63], v4, s[24:27], s71 offen offset:0 sc1
    s_nop 0
    ds_write_b128 v8, a[220:223] offset:22528
    v_mfma_f32_16x16x32_bf16 a[228:231], a[172:175], v[136:139], a[228:231]
    v_add_f32 v34, v34, v38
    v_fma_f32 v122, v34, s94, v26
    v_mfma_f32_16x16x32_bf16 a[228:231], a[240:243], v[140:143], a[228:231]
    buffer_load_dwordx4 a[80:83], v4, s[24:27], s71 offen offset:1024 sc1
    ds_write_b128 v8, a[224:227] offset:23552
    s_waitcnt vmcnt(10)
    v_mfma_f32_16x16x32_bf16 v[56:59], v[220:223], v[144:147], 0
    v_add_f32 v27, v27, v31
    v_add_f32 v35, v35, v39
    s_waitcnt vmcnt(8)
    v_mfma_f32_16x16x32_bf16 v[56:59], v[240:243], a[232:235], v[56:59]
    buffer_load_dwordx4 a[88:91], v4, s[24:27], s71 offen offset:2048 sc1
    ds_write_b128 v8, a[228:231] offset:24576
    v_mfma_f32_16x16x32_bf16 v[60:63], v[224:227], v[144:147], 0
    v_fma_f32 v123, v35, s94, v27
    v_mfma_f32_16x16x32_bf16 v[60:63], v[244:247], a[232:235], v[60:63]
    buffer_load_dwordx4 a[96:99], v4, s[24:27], s71 offen offset:3072 sc1
    v_mfma_f32_16x16x32_bf16 v[64:67], v[228:231], v[144:147], 0
    v_mfma_f32_16x16x32_bf16 v[64:67], v[248:251], a[232:235], v[64:67]
    v_mfma_f32_16x16x32_bf16 v[68:71], v[232:235], v[144:147], 0
    v_mfma_f32_16x16x32_bf16 v[68:71], a[248:251], a[232:235], v[68:71]
    v_mfma_f32_16x16x32_bf16 v[72:75], v[236:239], v[144:147], 0
    v_mfma_f32_16x16x32_bf16 v[72:75], a[252:255], a[232:235], v[72:75]
    s_waitcnt vmcnt(9)
    v_mfma_f32_16x16x32_bf16 v[56:59], a[52:55], a[236:239], v[56:59]
    s_waitcnt vmcnt(8)
    v_mfma_f32_16x16x32_bf16 v[56:59], a[76:79], v[124:127], v[56:59]
    v_mfma_f32_16x16x32_bf16 v[60:63], a[56:59], a[236:239], v[60:63]
    v_mfma_f32_16x16x32_bf16 v[60:63], a[84:87], v[124:127], v[60:63]
    v_mfma_f32_16x16x32_bf16 v[64:67], a[64:67], a[236:239], v[64:67]
    v_mfma_f32_16x16x32_bf16 v[64:67], a[92:95], v[124:127], v[64:67]
    v_mfma_f32_16x16x32_bf16 v[68:71], a[68:71], a[236:239], v[68:71]
    v_mfma_f32_16x16x32_bf16 v[68:71], v[184:187], v[124:127], v[68:71]
    v_mfma_f32_16x16x32_bf16 v[72:75], a[72:75], a[236:239], v[72:75]
    v_mfma_f32_16x16x32_bf16 v[72:75], v[188:191], v[124:127], v[72:75]
    s_waitcnt vmcnt(7)
    v_mfma_f32_16x16x32_bf16 v[56:59], v[192:195], v[172:175], v[56:59]
    v_cmp_le_u32 vcc, 554189328, v18
    s_cbranch_vccz L_fw_100
L_fd_102:
    s_waitcnt vmcnt(6)
    v_mfma_f32_16x16x32_bf16 v[56:59], v[96:99], v[176:179], v[56:59]
    s_add_u32 s72, s87, 294912
    v_mfma_f32_16x16x32_bf16 v[60:63], v[80:83], v[172:175], v[60:63]
    buffer_load_dwordx4 a[100:103], v4, s[24:27], s72 offen offset:0 sc1
    v_mfma_f32_16x16x32_bf16 v[60:63], v[100:103], v[176:179], v[60:63]
    buffer_load_dwordx4 a[104:107], v4, s[24:27], s72 offen offset:1024 sc1
    v_mfma_f32_16x16x32_bf16 v[64:67], v[84:87], v[172:175], v[64:67]
    v_mfma_f32_16x16x32_bf16 v[64:67], a[244:247], v[176:179], v[64:67]
    v_mfma_f32_16x16x32_bf16 v[68:71], v[88:91], v[172:175], v[68:71]
    v_mfma_f32_16x16x32_bf16 v[68:71], v[148:151], v[176:179], v[68:71]
    buffer_load_dwordx4 a[108:111], v4, s[24:27], s72 offen offset:2048 sc1
    v_mfma_f32_16x16x32_bf16 v[72:75], v[92:95], v[172:175], v[72:75]
    v_mfma_f32_16x16x32_bf16 v[72:75], v[152:155], v[176:179], v[72:75]
    s_waitcnt vmcnt(8)
    v_mfma_f32_16x16x32_bf16 v[56:59], v[156:159], v[180:183], v[56:59]
    s_waitcnt lgkmcnt(0)
    s_barrier
    s_waitcnt vmcnt(7)
    v_mfma_f32_16x16x32_bf16 v[56:59], a[16:19], a[48:51], v[56:59]
    buffer_load_dwordx4 a[112:115], v4, s[24:27], s72 offen offset:3072 sc1
    ds_read_b128 v[24:27], v9 offset:0
    v_mfma_f32_16x16x32_bf16 v[60:63], a[0:3], v[180:183], v[60:63]
    ds_read_b128 v[28:31], v9 offset:5120
    ds_read_b128 v[32:35], v9 offset:10240
    v_mfma_f32_16x16x32_bf16 v[60:63], a[20:23], a[48:51], v[60:63]
    s_add_u32 s72, s87, 299008
    ds_read_b128 v[36:39], v9 offset:15360
    v_mfma_f32_16x16x32_bf16 v[64:67], a[4:7], v[180:183], v[64:67]
    buffer_load_dwordx4 a[116:119], v4, s[24:27], s72 offen offset:0 sc1
    ds_read_b128 v[40:43], v9 offset:20480
    v_mfma_f32_16x16x32_bf16 v[64:67], a[24:27], a[48:51], v[64:67]
    ds_read_b128 v[44:47], v9 offset:25600
    ds_read_b128 v[48:51], v9 offset:30720
    v_mfma_f32_16x16x32_bf16 v[68:71], a[8:11], v[180:183], v[68:71]
    ds_read_b128 v[52:55], v9 offset:35840
    v_mfma_f32_16x16x32_bf16 v[68:71], a[28:31], a[48:51], v[68:71]
    v_mfma_f32_16x16x32_bf16 v[72:75], a[12:15], v[180:183], v[72:75]
    buffer_load_dwordx4 a[120:123], v4, s[24:27], s72 offen offset:1024 sc1
    v_mfma_f32_16x16x32_bf16 v[72:75], a[32:35], a[48:51], v[72:75]
    s_waitcnt vmcnt(9)
    v_mfma_f32_16x16x32_bf16 v[56:59], a[36:39], a[60:63], v[56:59]
    s_waitcnt vmcnt(8)
    v_mfma_f32_16x16x32_bf16 v[56:59], v[196:199], a[80:83], v[56:59]
    v_mfma_f32_16x16x32_bf16 v[60:63], a[40:43], a[60:63], v[60:63]
    buffer_load_dwordx4 a[124:127], v4, s[24:27], s72 offen offset:2048 sc1
    s_waitcnt lgkmcnt(0)
    v_mfma_f32_16x16x32_bf16 v[60:63], v[200:203], a[80:83], v[60:63]
    v_add_f32 v24, v24, v28
    v_add_f32 v25, v25, v29
    v_mfma_f32_16x16x32_bf16 v[64:67], a[44:47], a[60:63], v[64:67]
    v_add_f32 v26, v26, v30
    v_add_f32 v27, v27, v31
    v_mfma_f32_16x16x32_bf16 v[64:67], v[204:207], a[80:83], v[64:67]
    v_add_f32 v32, v32, v36
    v_add_f32 v33, v33, v37
    v_mfma_f32_16x16x32_bf16 v[68:71], a[136:139], a[60:63], v[68:71]
    buffer_load_dwordx4 a[128:131], v4, s[24:27], s72 offen offset:3072 sc1
    v_add_f32 v34, v34, v38
    v_mfma_f32_16x16x32_bf16 v[68:71], a[144:147], a[80:83], v[68:71]
    v_add_f32 v35, v35, v39
    v_add_f32 v24, v24, v32
    v_mfma_f32_16x16x32_bf16 v[72:75], a[140:143], a[60:63], v[72:75]
    v_add_f32 v25, v25, v33
    v_add_f32 v26, v26, v34
    v_mfma_f32_16x16x32_bf16 v[72:75], a[148:151], a[80:83], v[72:75]
    s_add_u32 s72, s87, 303104
    v_add_f32 v27, v27, v35
    s_waitcnt vmcnt(9)
    v_mfma_f32_16x16x32_bf16 v[56:59], v[208:211], a[88:91], v[56:59]
    buffer_load_dwordx4 a[132:135], v4, s[24:27], s72 offen offset:0 sc1
    v_fmac_f32 v104, v24, v128
    s_waitcnt vmcnt(9)
    v_mfma_f32_16x16x32_bf16 v[56:59], a[176:179], a[96:99], v[56:59]
    v_fmac_f32 v105, v25, v128
    v_fmac_f32 v106, v26, v128
    v_mfma_f32_16x16x32_bf16 v[60:63], v[212:215], a[88:91], v[60:63]
    v_fmac_f32 v107, v27, v128
    v_cvt_pk_bf16_f32 v160, v104, v105
    v_mfma_f32_16x16x32_bf16 v[60:63], a[180:183], a[96:99], v[60:63]
    s_nop 1
    ds_write_b128 v8, v[56:59] offset:40960
    v_cvt_pk_bf16_f32 v161, v106, v107
    v_mfma_f32_16x16x32_bf16 v[64:67], v[216:219], a[88:91], v[64:67]
    buffer_load_dwordx4 a[152:155], v4, s[24:27], s72 offen offset:1024 sc1
    v_add_f32 v40, v40, v44
    v_mfma_f32_16x16x32_bf16 v[64:67], a[184:187], a[96:99], v[64:67]
    ds_write_b128 v8, v[60:63] offset:41984
    v_add_f32 v41, v41, v45
    v_mfma_f32_16x16x32_bf16 v[68:71], a[168:171], a[88:91], v[68:71]
    buffer_load_dwordx4 a[156:159], v4, s[24:27], s72 offen offset:2048 sc1
    v_add_f32 v42, v42, v46
    v_mfma_f32_16x16x32_bf16 v[68:71], a[188:191], a[96:99], v[68:71]
    s_nop 1
    ds_write_b128 v8, v[64:67] offset:43008
    v_add_f32 v43, v43, v47
    v_mfma_f32_16x16x32_bf16 v[72:75], a[172:175], a[88:91], v[72:75]
    buffer_load_dwordx4 a[160:163], v4, s[24:27], s72 offen offset:3072 sc1
    v_add_f32 v48, v48, v52
    v_mfma_f32_16x16x32_bf16 v[72:75], a[240:243], a[96:99], v[72:75]
    ds_write_b128 v8, v[68:71] offset:44032
    v_add_f32 v49, v49, v53
    s_waitcnt vmcnt(11)
    v_mfma_f32_16x16x32_bf16 a[192:195], v[220:223], a[100:103], 0
    v_add_f32 v50, v50, v54
    v_add_f32 v51, v51, v55
    s_waitcnt vmcnt(10)
    v_mfma_f32_16x16x32_bf16 a[192:195], v[240:243], a[104:107], a[192:195]
    ds_write_b128 v8, v[72:75] offset:45056
    v_add_f32 v40, v40, v48
    v_mfma_f32_16x16x32_bf16 a[196:199], v[224:227], a[100:103], 0
    v_add_f32 v41, v41, v49
    v_add_f32 v42, v42, v50
    v_mfma_f32_16x16x32_bf16 a[196:199], v[244:247], a[104:107], a[196:199]
    v_add_f32 v43, v43, v51
    v_fmac_f32 v108, v40, v129
    v_mfma_f32_16x16x32_bf16 a[200:203], v[228:231], a[100:103], 0
    v_fmac_f32 v109, v41, v129
    v_fmac_f32 v110, v42, v129
    v_mfma_f32_16x16x32_bf16 a[200:203], v[248:251], a[104:107], a[200:203]
    v_fmac_f32 v111, v43, v129
    v_cvt_pk_bf16_f32 v162, v108, v109
    v_mfma_f32_16x16x32_bf16 a[204:207], v[232:235], a[100:103], 0
    v_cvt_pk_bf16_f32 v163, v110, v111
    v_mfma_f32_16x16x32_bf16 a[204:207], a[248:251], a[104:107], a[204:207]
    buffer_store_dwordx2 v[160:161], v22, s[28:31], s92 offen offset:0
    v_mfma_f32_16x16x32_bf16 a[208:211], v[236:239], a[100:103], 0
    s_add_u32 s75, s92, 8192
    buffer_store_dwordx2 v[162:163], v22, s[28:31], s75 offen offset:2048
    v_mfma_f32_16x16x32_bf16 a[208:211], a[252:255], a[104:107], a[208:211]
    s_waitcnt vmcnt(11)
    v_mfma_f32_16x16x32_bf16 a[192:195], a[52:55], a[108:111], a[192:195]
    s_waitcnt lgkmcnt(0)
    s_barrier
    s_waitcnt vmcnt(10)
    v_mfma_f32_16x16x32_bf16 a[192:195], a[76:79], a[112:115], a[192:195]
    ds_read_b128 v[24:27], v9 offset:40960
    ds_read_b128 v[28:31], v9 offset:46080
    v_mfma_f32_16x16x32_bf16 a[196:199], a[56:59], a[108:111], a[196:199]
    ds_read_b128 v[32:35], v9 offset:51200
    ds_read_b128 v[36:39], v9 offset:56320
    v_mfma_f32_16x16x32_bf16 a[196:199], a[84:87], a[112:115], a[196:199]
    v_mfma_f32_16x16x32_bf16 a[200:203], a[64:67], a[108:111], a[200:203]
    v_mfma_f32_16x16x32_bf16 a[200:203], a[92:95], a[112:115], a[200:203]
    v_mfma_f32_16x16x32_bf16 a[204:207], a[68:71], a[108:111], a[204:207]
    v_mfma_f32_16x16x32_bf16 a[204:207], v[184:187], a[112:115], a[204:207]
    v_mfma_f32_16x16x32_bf16 a[208:211], a[72:75], a[108:111], a[208:211]
    s_waitcnt lgkmcnt(0)
    v_add_f32 v24, v24, v28
    v_mfma_f32_16x16x32_bf16 a[208:211], v[188:191], a[112:115], a[208:211]
    v_add_f32 v25, v25, v29
    v_add_f32 v26, v26, v30
    s_waitcnt vmcnt(9)
    v_mfma_f32_16x16x32_bf16 a[192:195], v[192:195], a[116:119], a[192:195]
    v_add_f32 v27, v27, v31
    v_add_f32 v32, v32, v36
    s_waitcnt vmcnt(8)
    v_mfma_f32_16x16x32_bf16 a[192:195], v[96:99], a[120:123], a[192:195]
    v_add_f32 v33, v33, v37
    v_add_f32 v34, v34, v38
    v_mfma_f32_16x16x32_bf16 a[196:199], v[80:83], a[116:119], a[196:199]
    v_add_f32 v35, v35, v39
    v_add_f32 v24, v24, v32
    v_mfma_f32_16x16x32_bf16 a[196:199], v[100:103], a[120:123], a[196:199]
    v_add_f32 v25, v25, v33
    v_add_f32 v26, v26, v34
    v_mfma_f32_16x16x32_bf16 a[200:203], v[84:87], a[116:119], a[200:203]
    v_add_f32 v27, v27, v35
    v_fmac_f32 v112, v24, v130
    v_mfma_f32_16x16x32_bf16 a[200:203], a[244:247], a[120:123], a[200:203]
    v_fmac_f32 v113, v25, v130
    v_fmac_f32 v114, v26, v130
    v_mfma_f32_16x16x32_bf16 a[204:207], v[88:91], a[116:119], a[204:207]
    v_fmac_f32 v115, v27, v130
    v_cvt_pk_bf16_f32 v164, v112, v113
    v_mfma_f32_16x16x32_bf16 a[204:207], v[148:151], a[120:123], a[204:207]
    v_cvt_pk_bf16_f32 v165, v114, v115
    v_mfma_f32_16x16x32_bf16 a[208:211], v[92:95], a[116:119], a[208:211]
    s_add_u32 s75, s92, 20480
    buffer_store_dwordx2 v[164:165], v22, s[28:31], s75 offen offset:0
    v_mfma_f32_16x16x32_bf16 a[208:211], v[152:155], a[120:123], a[208:211]
    s_waitcnt vmcnt(8)
    v_mfma_f32_16x16x32_bf16 a[192:195], v[156:159], a[124:127], a[192:195]
    s_waitcnt vmcnt(7)
    v_mfma_f32_16x16x32_bf16 a[192:195], a[16:19], a[128:131], a[192:195]
    v_mfma_f32_16x16x32_bf16 a[196:199], a[0:3], a[124:127], a[196:199]
    v_mfma_f32_16x16x32_bf16 a[196:199], a[20:23], a[128:131], a[196:199]
    v_mfma_f32_16x16x32_bf16 a[200:203], a[4:7], a[124:127], a[200:203]
    v_mfma_f32_16x16x32_bf16 a[200:203], a[24:27], a[128:131], a[200:203]
    v_mfma_f32_16x16x32_bf16 a[204:207], a[8:11], a[124:127], a[204:207]
    v_mfma_f32_16x16x32_bf16 a[204:207], a[28:31], a[128:131], a[204:207]
    v_mfma_f32_16x16x32_bf16 a[208:211], a[12:15], a[124:127], a[208:211]
    v_mfma_f32_16x16x32_bf16 a[208:211], a[32:35], a[128:131], a[208:211]
    s_waitcnt vmcnt(6)
    v_mfma_f32_16x16x32_bf16 a[192:195], a[36:39], a[132:135], a[192:195]
    s_waitcnt vmcnt(5)
    v_mfma_f32_16x16x32_bf16 a[192:195], v[196:199], a[152:155], a[192:195]
    v_mfma_f32_16x16x32_bf16 a[196:199], a[40:43], a[132:135], a[196:199]
    v_mfma_f32_16x16x32_bf16 a[196:199], v[200:203], a[152:155], a[196:199]
    v_mfma_f32_16x16x32_bf16 a[200:203], a[44:47], a[132:135], a[200:203]
    v_mfma_f32_16x16x32_bf16 a[200:203], v[204:207], a[152:155], a[200:203]
    v_mfma_f32_16x16x32_bf16 a[204:207], a[136:139], a[132:135], a[204:207]
    v_mfma_f32_16x16x32_bf16 a[204:207], a[144:147], a[152:155], a[204:207]
    v_mfma_f32_16x16x32_bf16 a[208:211], a[140:143], a[132:135], a[208:211]
    v_mfma_f32_16x16x32_bf16 a[208:211], a[148:151], a[152:155], a[208:211]
    s_waitcnt vmcnt(4)
    v_mfma_f32_16x16x32_bf16 a[192:195], v[208:211], a[156:159], a[192:195]
    s_waitcnt vmcnt(3)
    v_mfma_f32_16x16x32_bf16 a[192:195], a[176:179], a[160:163], a[192:195]
    v_mfma_f32_16x16x32_bf16 a[196:199], v[212:215], a[156:159], a[196:199]
    v_mfma_f32_16x16x32_bf16 a[196:199], a[180:183], a[160:163], a[196:199]
    v_add_u32 v8, 0xf000, v8
    s_nop 4
    ds_write_b128 v8, a[192:195] offset:0
    v_mfma_f32_16x16x32_bf16 a[200:203], v[216:219], a[156:159], a[200:203]
    s_branch L_pgx13
L_pg13:
    s_setpc_b64 s[40:41]
L_pgx13:
    v_mfma_f32_16x16x32_bf16 a[200:203], a[184:187], a[160:163], a[200:203]
    ds_write_b128 v8, a[196:199] offset:1024
    v_mfma_f32_16x16x32_bf16 a[204:207], a[168:171], a[156:159], a[204:207]
    v_mfma_f32_16x16x32_bf16 a[204:207], a[188:191], a[160:163], a[204:207]
    s_nop 4
    ds_write_b128 v8, a[200:203] offset:2048
    v_mfma_f32_16x16x32_bf16 a[208:211], a[172:175], a[156:159], a[208:211]
    v_mfma_f32_16x16x32_bf16 a[208:211], a[240:243], a[160:163], a[208:211]
    ds_write_b128 v8, a[204:207] offset:3072
    s_nop 6
    ds_write_b128 v8, a[208:211] offset:4096
    s_waitcnt lgkmcnt(0)
    s_barrier
    v_add_u32 v9, 0xf000, v9
    ds_read_b128 v[40:43], v9 offset:0
    ds_read_b128 v[44:47], v9 offset:5120
    ds_read_b128 v[48:51], v9 offset:10240
    ds_read_b128 v[52:55], v9 offset:15360
    ds_read_b128 v[24:27], v10 offset:4096
    ds_read_b128 v[28:31], v10 offset:9216
    ds_read_b128 v[32:35], v10 offset:14336
    ds_read_b128 v[36:39], v10 offset:19456
    s_waitcnt lgkmcnt(4)
    v_pk_add_f32 v[40:41], v[40:41], v[44:45]
    v_pk_add_f32 v[42:43], v[42:43], v[46:47]
    v_pk_add_f32 v[48:49], v[48:49], v[52:53]
    v_pk_add_f32 v[50:51], v[50:51], v[54:55]
    v_pk_add_f32 v[40:41], v[40:41], v[48:49]
    v_pk_add_f32 v[42:43], v[42:43], v[50:51]
    v_fmac_f32 v116, v40, v131
    v_fmac_f32 v117, v41, v131
    v_fmac_f32 v118, v42, v131
    v_fmac_f32 v119, v43, v131
    v_cvt_pk_bf16_f32 v166, v116, v117
    v_cvt_pk_bf16_f32 v167, v118, v119
    s_add_u32 s75, s92, 28672
    buffer_store_dwordx2 v[166:167], v22, s[28:31], s75 offen offset:2048
    s_waitcnt lgkmcnt(0)
    v_pk_add_f32 v[24:25], v[24:25], v[28:29]
    v_pk_add_f32 v[26:27], v[26:27], v[30:31]
    v_pk_add_f32 v[32:33], v[32:33], v[36:37]
    v_pk_add_f32 v[34:35], v[34:35], v[38:39]
    v_pk_add_f32 v[24:25], v[24:25], v[32:33]
    v_pk_add_f32 v[26:27], v[26:27], v[34:35]
    v_fmac_f32 v120, v24, v132
    v_fmac_f32 v121, v25, v132
    v_fmac_f32 v122, v26, v132
    v_fmac_f32 v123, v27, v132
    v_cvt_pk_bf16_f32 v168, v120, v121
    v_cvt_pk_bf16_f32 v169, v122, v123
    buffer_store_dwordx2 v[168:169], v23, s[28:31], s92 offen offset:32
    s_endpgm
L_onet0:
    s_setpc_b64 s[40:41]
L_one0:
    buffer_load_dwordx4 v[112:115], v250, s[24:27], s62 offen sc1
    buffer_load_dwordx4 v[116:119], v251, s[24:27], s62 offen sc1
    v_mov_b32 v240, 0x4227c5ac
    s_waitcnt vmcnt(4)
    v_fma_f32 v208, v208, s55, v240
    v_fma_f32 v209, v209, s55, v240
    v_fma_f32 v210, v210, s55, v240
    v_fma_f32 v211, v211, s55, v240
    v_fma_f32 v212, v212, s55, v240
    v_fma_f32 v213, v213, s55, v240
    v_fma_f32 v214, v214, s55, v240
    v_fma_f32 v215, v215, s55, v240
    v_rsq_f32 v208, v208
    v_rsq_f32 v209, v209
    v_rsq_f32 v210, v210
    v_rsq_f32 v211, v211
    v_rsq_f32 v212, v212
    v_rsq_f32 v213, v213
    v_rsq_f32 v214, v214
    v_rsq_f32 v215, v215
    s_cmp_eq_u32 s38, 0
    s_cselect_b32 s56, 0, -1
    s_waitcnt vmcnt(2)
    v_lshlrev_b32 v160, 16, v96
    v_lshlrev_b32 v161, 16, v97
    v_lshlrev_b32 v162, 16, v98
    v_lshlrev_b32 v163, 16, v99
    v_lshlrev_b32 v164, 16, v100
    v_lshlrev_b32 v165, 16, v101
    v_lshlrev_b32 v166, 16, v102
    v_lshlrev_b32 v167, 16, v103
    v_pk_mul_f32 v[240:241], v[160:161], v[208:209]
    v_pk_mul_f32 v[242:243], v[162:163], v[210:211]
    v_pk_mul_f32 v[244:245], v[164:165], v[212:213]
    v_pk_mul_f32 v[246:247], v[166:167], v[214:215]
    v_cvt_pk_bf16_f32 v224, v240, v241
    v_cvt_pk_bf16_f32 v225, v242, v243
    v_cvt_pk_bf16_f32 v226, v244, v245
    v_cvt_pk_bf16_f32 v227, v246, v247
    ds_write_b128 v90, v[224:227] offset:0
    v_and_b32 v168, 0xffff0000, v96
    v_and_b32 v169, 0xffff0000, v97
    v_and_b32 v170, 0xffff0000, v98
    v_and_b32 v171, 0xffff0000, v99
    v_and_b32 v172, 0xffff0000, v100
    v_and_b32 v173, 0xffff0000, v101
    v_and_b32 v174, 0xffff0000, v102
    v_and_b32 v175, 0xffff0000, v103
    v_pk_mul_f32 v[240:241], v[168:169], v[208:209]
    v_pk_mul_f32 v[242:243], v[170:171], v[210:211]
    v_pk_mul_f32 v[244:245], v[172:173], v[212:213]
    v_pk_mul_f32 v[246:247], v[174:175], v[214:215]
    v_cvt_pk_bf16_f32 v228, v240, v241
    v_cvt_pk_bf16_f32 v229, v242, v243
    v_cvt_pk_bf16_f32 v230, v244, v245
    v_cvt_pk_bf16_f32 v231, v246, v247
    v_and_b32 v228, s56, v228
    v_and_b32 v229, s56, v229
    v_and_b32 v230, s56, v230
    v_and_b32 v231, s56, v231
    ds_write_b128 v90, v[228:231] offset:4096
    s_waitcnt lgkmcnt(0)
    v_mul_u32_u24 v246, 4096, v1
    v_mov_b32 v247, 32768
    s_waitcnt vmcnt(0)
    s_barrier
    s_bitcmp1_b32 0xf000ff00, s34
    s_cbranch_scc1 L_gs_39
    s_cmp_lg_u32 s32, 0
    s_cbranch_scc1 L_sg_41
    s_mov_b64 exec, 0xffff
    buffer_atomic_add v247, v246, s[24:27], s43 offen offset:0 sc1
    s_mov_b64 exec, -1
L_sg_41:
L_gt_40:
    ds_read_b64_tr_b16 v[128:129], v88 offset:0
    ds_read_b64_tr_b16 v[130:131], v88 offset:1024
    ds_read_b64_tr_b16 v[144:145], v88 offset:4096
    ds_read_b64_tr_b16 v[146:147], v88 offset:5120
    ds_read_b64_tr_b16 v[136:137], v88 offset:2048
    ds_read_b64_tr_b16 v[138:139], v88 offset:3072
    ds_read_b64_tr_b16 v[152:153], v88 offset:6144
    ds_read_b64_tr_b16 v[154:155], v88 offset:7168
    ds_read_b64_tr_b16 v[132:133], v89 offset:0
    ds_read_b64_tr_b16 v[134:135], v89 offset:1024
    ds_read_b64_tr_b16 v[148:149], v89 offset:4096
    ds_read_b64_tr_b16 v[150:151], v89 offset:5120
    ds_read_b64_tr_b16 v[140:141], v89 offset:2048
    ds_read_b64_tr_b16 v[142:143], v89 offset:3072
    ds_read_b64_tr_b16 v[156:157], v89 offset:6144
    s_waitcnt lgkmcnt(11)
    ds_read_b64_tr_b16 v[158:159], v89 offset:7168
    v_mfma_f32_16x16x32_bf16 v[192:195], v[128:131], v[8:11], 0
    v_lshlrev_b32 v176, 16, v112
    v_mfma_f32_16x16x32_bf16 v[192:195], v[144:147], v[16:19], v[192:195]
    v_and_b32 v177, 0xffff0000, v112
    v_lshlrev_b32 v178, 16, v113
    v_mfma_f32_16x16x32_bf16 v[200:203], v[144:147], v[8:11], 0
    v_and_b32 v179, 0xffff0000, v113
    v_lshlrev_b32 v180, 16, v114
    v_mfma_f32_16x16x32_bf16 v[200:203], v[128:131], v[24:27], v[200:203]
    v_and_b32 v181, 0xffff0000, v114
    v_lshlrev_b32 v182, 16, v115
    s_waitcnt lgkmcnt(8)
    v_mfma_f32_16x16x32_bf16 v[192:195], v[136:139], v[12:15], v[192:195]
    v_and_b32 v183, 0xffff0000, v115
    v_lshlrev_b32 v184, 16, v116
    v_mfma_f32_16x16x32_bf16 v[192:195], v[152:155], v[20:23], v[192:195]
    v_and_b32 v185, 0xffff0000, v116
    v_lshlrev_b32 v186, 16, v117
    v_mfma_f32_16x16x32_bf16 v[200:203], v[152:155], v[12:15], v[200:203]
    v_and_b32 v187, 0xffff0000, v117
    v_lshlrev_b32 v188, 16, v118
    v_mfma_f32_16x16x32_bf16 v[200:203], v[136:139], v[28:31], v[200:203]
    v_and_b32 v189, 0xffff0000, v118
    v_lshlrev_b32 v190, 16, v119
    s_waitcnt lgkmcnt(4)
    v_mfma_f32_16x16x32_bf16 v[196:199], v[132:135], v[8:11], 0
    v_and_b32 v191, 0xffff0000, v119
    v_mfma_f32_16x16x32_bf16 v[196:199], v[148:151], v[16:19], v[196:199]
    v_mul_f32 v240, v192, v56
    v_mul_f32 v241, v193, v57
    v_mul_f32 v242, v194, v58
    v_mfma_f32_16x16x32_bf16 v[204:207], v[148:151], v[8:11], 0
    v_mul_f32 v243, v195, v59
    v_fmac_f32 v240, v200, v64
    v_fmac_f32 v241, v201, v65
    v_mfma_f32_16x16x32_bf16 v[204:207], v[132:135], v[24:27], v[204:207]
    v_fmac_f32 v242, v202, v66
    v_fmac_f32 v243, v203, v67
    s_waitcnt lgkmcnt(0)
    v_mfma_f32_16x16x32_bf16 v[196:199], v[140:143], v[12:15], v[196:199]
    v_mul_f32 v200, v200, v56
    v_mul_f32 v201, v201, v57
    v_mfma_f32_16x16x32_bf16 v[196:199], v[156:159], v[20:23], v[196:199]
    v_mul_f32 v202, v202, v58
    v_mul_f32 v203, v203, v59
    v_mfma_f32_16x16x32_bf16 v[204:207], v[156:159], v[12:15], v[204:207]
    v_fma_f32 v200, -v192, v64, v200
    v_fma_f32 v201, -v193, v65, v201
    v_mfma_f32_16x16x32_bf16 v[204:207], v[140:143], v[28:31], v[204:207]
    v_fma_f32 v202, -v194, v66, v202
    v_fma_f32 v203, -v195, v67, v203
    v_cvt_pk_bf16_f32 v224, v240, v241
    v_cvt_pk_bf16_f32 v228, v200, v201
    v_cvt_pk_bf16_f32 v225, v242, v243
    v_cvt_pk_bf16_f32 v229, v202, v203
    v_pk_mul_f32 v[244:245], v[196:197], v[60:61]
    v_pk_mul_f32 v[246:247], v[198:199], v[62:63]
    v_pk_fma_f32 v[244:245], v[204:205], v[68:69], v[244:245]
    v_pk_fma_f32 v[246:247], v[206:207], v[70:71], v[246:247]
    v_pk_mul_f32 v[204:205], v[204:205], v[60:61]
    v_pk_mul_f32 v[206:207], v[206:207], v[62:63]
    v_pk_fma_f32 v[204:205], v[196:197], v[68:69], v[204:205] neg_lo:[1,0,0] neg_hi:[1,0,0]
    v_pk_fma_f32 v[206:207], v[198:199], v[70:71], v[206:207] neg_lo:[1,0,0] neg_hi:[1,0,0]
    v_cvt_pk_bf16_f32 v226, v244, v245
    v_cvt_pk_bf16_f32 v230, v204, v205
    v_cvt_pk_bf16_f32 v227, v246, v247
    v_cvt_pk_bf16_f32 v231, v206, v207
    s_nop 0
    v_mfma_f32_16x16x32_bf16 v[192:195], v[32:35], v[224:227], 0
    v_mfma_f32_16x16x32_bf16 v[192:195], v[40:43], v[228:231], v[192:195]
    v_mfma_f32_16x16x32_bf16 v[200:203], v[32:35], v[228:231], 0
    v_mfma_f32_16x16x32_bf16 v[200:203], v[48:51], v[224:227], v[200:203]
    v_mfma_f32_16x16x32_bf16 v[196:199], v[36:39], v[224:227], 0
    v_mfma_f32_16x16x32_bf16 v[196:199], v[44:47], v[228:231], v[196:199]
    s_nop 3
    v_mul_f32 v240, v192, v176
    v_mul_f32 v241, v193, v177
    v_fma_f32 v240, -v200, v184, v240
    v_mfma_f32_16x16x32_bf16 v[204:207], v[36:39], v[228:231], 0
    v_fma_f32 v241, -v201, v185, v241
    v_mul_f32 v200, v200, v176
    v_mul_f32 v201, v201, v177
    v_mfma_f32_16x16x32_bf16 v[204:207], v[52:55], v[224:227], v[204:207]
    v_fmac_f32 v200, v192, v184
    v_fmac_f32 v201, v193, v185
    v_cvt_pk_bf16_f32 v232, v240, v241
    v_cvt_pk_bf16_f32 v236, v200, v201
    v_pk_mul_f32 v[242:243], v[194:195], v[178:179]
    v_pk_mul_f32 v[244:245], v[196:197], v[180:181]
    v_pk_mul_f32 v[246:247], v[198:199], v[182:183]
    v_pk_fma_f32 v[242:243], v[202:203], v[186:187], v[242:243] neg_lo:[1,0,0] neg_hi:[1,0,0]
    v_pk_fma_f32 v[244:245], v[204:205], v[188:189], v[244:245] neg_lo:[1,0,0] neg_hi:[1,0,0]
    v_pk_fma_f32 v[246:247], v[206:207], v[190:191], v[246:247] neg_lo:[1,0,0] neg_hi:[1,0,0]
    v_pk_mul_f32 v[202:203], v[202:203], v[178:179]
    v_pk_mul_f32 v[204:205], v[204:205], v[180:181]
    v_pk_mul_f32 v[206:207], v[206:207], v[182:183]
    v_pk_fma_f32 v[202:203], v[194:195], v[186:187], v[202:203]
    v_pk_fma_f32 v[204:205], v[196:197], v[188:189], v[204:205]
    v_pk_fma_f32 v[206:207], v[198:199], v[190:191], v[206:207]
    v_cvt_pk_bf16_f32 v233, v242, v243
    v_cvt_pk_bf16_f32 v237, v202, v203
    v_cvt_pk_bf16_f32 v234, v244, v245
    v_cvt_pk_bf16_f32 v238, v204, v205
    v_cvt_pk_bf16_f32 v235, v246, v247
    v_cvt_pk_bf16_f32 v239, v206, v207
    s_nop 0
    v_mfma_f32_16x16x32_bf16 v[192:195], v[232:235], v[32:35], 0
    v_mfma_f32_16x16x32_bf16 v[192:195], v[236:239], v[48:51], v[192:195]
    v_mfma_f32_16x16x32_bf16 v[200:203], v[236:239], v[32:35], 0
    v_mfma_f32_16x16x32_bf16 v[200:203], v[232:235], v[40:43], v[200:203]
    v_mfma_f32_16x16x32_bf16 v[196:199], v[232:235], v[36:39], 0
    v_mfma_f32_16x16x32_bf16 v[196:199], v[236:239], v[52:55], v[196:199]
    s_nop 3
    v_mul_f32 v240, v192, v72
    v_mul_f32 v241, v193, v73
    v_fma_f32 v240, -v200, v80, v240
    v_mfma_f32_16x16x32_bf16 v[204:207], v[236:239], v[36:39], 0
    v_fma_f32 v241, -v201, v81, v241
    v_mul_f32 v200, v200, v72
    v_mul_f32 v201, v201, v73
    v_mfma_f32_16x16x32_bf16 v[204:207], v[232:235], v[44:47], v[204:207]
    v_fmac_f32 v200, v192, v80
    v_fmac_f32 v201, v193, v81
    v_cvt_pk_bf16_f32 v224, v240, v241
    v_cvt_pk_bf16_f32 v228, v200, v201
    v_pk_mul_f32 v[242:243], v[194:195], v[74:75]
    v_pk_mul_f32 v[244:245], v[196:197], v[76:77]
    v_pk_mul_f32 v[246:247], v[198:199], v[78:79]
    v_pk_fma_f32 v[242:243], v[202:203], v[82:83], v[242:243] neg_lo:[1,0,0] neg_hi:[1,0,0]
    v_pk_fma_f32 v[244:245], v[204:205], v[84:85], v[244:245] neg_lo:[1,0,0] neg_hi:[1,0,0]
    v_pk_fma_f32 v[246:247], v[206:207], v[86:87], v[246:247] neg_lo:[1,0,0] neg_hi:[1,0,0]
    v_pk_mul_f32 v[202:203], v[202:203], v[74:75]
    v_pk_mul_f32 v[204:205], v[204:205], v[76:77]
    v_pk_mul_f32 v[206:207], v[206:207], v[78:79]
    v_pk_fma_f32 v[202:203], v[194:195], v[82:83], v[202:203]
    v_pk_fma_f32 v[204:205], v[196:197], v[84:85], v[204:205]
    v_pk_fma_f32 v[206:207], v[198:199], v[86:87], v[206:207]
    v_cvt_pk_bf16_f32 v225, v242, v243
    v_cvt_pk_bf16_f32 v229, v202, v203
    ds_write_b64 v91, v[224:225] offset:16384
    ds_write_b64 v91, v[228:229] offset:20992
    v_cvt_pk_bf16_f32 v226, v244, v245
    v_cvt_pk_bf16_f32 v230, v204, v205
    v_cvt_pk_bf16_f32 v227, v246, v247
    v_cvt_pk_bf16_f32 v231, v206, v207
    ds_write_b64 v91, v[226:227] offset:18688
    ds_write_b64 v91, v[230:231] offset:23296
    s_waitcnt lgkmcnt(0)
    s_cmp_lg_u32 s32, 0
    s_cbranch_scc1 L_sm_42
    v_mov_b32 v95, 0
    s_mov_b64 exec, 0xff
    buffer_atomic_add v95, v93, s[24:27], s97 offen offset:0 sc0 sc1
    s_mov_b64 exec, -1
L_sm_42:
    s_barrier
    ds_read_b128 v[128:131], v92 offset:16384
    ds_read_b128 v[144:147], v92 offset:20992
    ds_read_b128 v[136:139], v92 offset:16448
    ds_read_b128 v[152:155], v92 offset:21056
    ds_read_b128 v[132:135], v92 offset:16960
    ds_read_b128 v[148:151], v92 offset:21568
    ds_read_b128 v[140:143], v92 offset:17024
    ds_read_b128 v[156:159], v92 offset:21632
    v_cvt_pk_bf16_f32 v240, v168, v169
    v_cvt_pk_bf16_f32 v241, v170, v171
    v_cvt_pk_bf16_f32 v242, v172, v173
    v_cvt_pk_bf16_f32 v243, v174, v175
    s_waitcnt lgkmcnt(6)
    v_mfma_f32_16x16x32_bf16 v[192:195], v[128:131], v[8:11], v[160:163]
    v_mfma_f32_16x16x32_bf16 v[192:195], v[144:147], v[24:27], v[192:195]
    s_waitcnt lgkmcnt(4)
    v_mfma_f32_16x16x32_bf16 v[192:195], v[136:139], v[12:15], v[192:195]
    v_mfma_f32_16x16x32_bf16 v[192:195], v[152:155], v[28:31], v[192:195]
    s_waitcnt lgkmcnt(2)
    v_mfma_f32_16x16x32_bf16 v[196:199], v[132:135], v[8:11], v[164:167]
    v_mfma_f32_16x16x32_bf16 v[196:199], v[148:151], v[24:27], v[196:199]
    s_waitcnt lgkmcnt(0)
    v_mfma_f32_16x16x32_bf16 v[196:199], v[140:143], v[12:15], v[196:199]
    v_mfma_f32_16x16x32_bf16 v[196:199], v[156:159], v[28:31], v[196:199]
    v_mfma_f32_16x16x32_bf16 v[200:203], v[144:147], v[8:11], v[168:171]
    v_mfma_f32_16x16x32_bf16 v[200:203], v[128:131], v[16:19], v[200:203]
    v_mfma_f32_16x16x32_bf16 v[200:203], v[152:155], v[12:15], v[200:203]
    v_cvt_pk_bf16_f32 v224, v192, v193
    v_cvt_pk_bf16_f32 v225, v194, v195
    v_mfma_f32_16x16x32_bf16 v[200:203], v[136:139], v[20:23], v[200:203]
    s_nop 1
    v_cvt_pk_bf16_f32 v226, v196, v197
    v_mfma_f32_16x16x32_bf16 v[204:207], v[148:151], v[8:11], v[172:175]
    v_cvt_pk_bf16_f32 v227, v198, v199
    v_mfma_f32_16x16x32_bf16 v[204:207], v[132:135], v[16:19], v[204:207]
    buffer_store_dwordx4 v[224:227], v248, s[24:27], s58 offen offset:0 sc1
    v_mfma_f32_16x16x32_bf16 v[204:207], v[156:159], v[12:15], v[204:207]
    v_cvt_pk_bf16_f32 v228, v200, v201
    v_mfma_f32_16x16x32_bf16 v[204:207], v[140:143], v[20:23], v[204:207]
    v_cvt_pk_bf16_f32 v229, v202, v203
    v_bfi_b32 v228, s56, v228, v240
    v_bfi_b32 v229, s56, v229, v241
    s_nop 4
    v_cvt_pk_bf16_f32 v230, v204, v205
    v_cvt_pk_bf16_f32 v231, v206, v207
    v_bfi_b32 v230, s56, v230, v242
    v_bfi_b32 v231, s56, v231, v243
    buffer_store_dwordx4 v[228:231], v248, s[24:27], s58 offen offset:1024 sc1
    s_cmp_lg_u32 s32, 0
    s_cbranch_scc1 L_pe_46
    s_mov_b32 s42, 65536
    s_mov_b64 exec, 0xff
    s_waitcnt vmcnt(2)
    s_branch L_pc_44
L_pl_43:
    v_mov_b32 v95, 0
    buffer_atomic_add v95, v93, s[24:27], s97 offen offset:0 sc0 sc1
    s_waitcnt vmcnt(0)
L_pc_44:
    v_and_b32 v94, 524288, v95
    v_cmp_ne_u32 vcc, 524288, v94
    s_cbranch_vccz L_pd_45
    s_sub_u32 s42, s42, 1
    s_cbranch_scc0 L_pl_43
L_pd_45:
    s_mov_b64 exec, -1
L_pe_46:
    s_branch L_join_30
L_gs_39:
    buffer_store_dwordx4 v[184:187], v202, s[24:27], s54 offen sc1
    buffer_store_dwordx4 v[188:191], v203, s[24:27], s54 offen sc1
    buffer_store_dwordx4 v[192:195], v204, s[24:27], s54 offen sc1
    buffer_store_dwordx4 v[196:199], v205, s[24:27], s54 offen sc1
    buffer_store_dwordx4 v[216:219], v206, s[24:27], s54 offen sc1
    v_lshrrev_b32 v148, 2, v1
    v_and_b32 v148, 3, v148
    v_and_b32 v149, 1, v3
    v_lshl_add_u32 v148, v149, 3, v148
    v_mul_u32_u24 v148, 1280, v148
    v_lshrrev_b32 v150, 1, v3
    v_mul_u32_u24 v151, 80, v150
    s_mul_i32 s46, s32, 160
    s_add_u32 s46, s46, 45056
    v_add3_u32 v148, v148, v151, s46
    v_and_b32 v151, 1, v1
    v_mul_u32_u24 v151, 40, v151
    v_and_b32 v152, 2, v1
    v_mul_u32_u24 v152, 320, v152
    v_add3_u32 v148, v148, v151, v152
    ds_read_b64_tr_b16 v[128:129], v148 offset:0
    ds_read_b64_tr_b16 v[130:131], v148 offset:5120
    ds_read_b64_tr_b16 v[132:133], v148 offset:8
    ds_read_b64_tr_b16 v[134:135], v148 offset:5128
    ds_read_b64_tr_b16 v[136:137], v148 offset:16
    ds_read_b64_tr_b16 v[138:139], v148 offset:5136
    ds_read_b64_tr_b16 v[140:141], v148 offset:24
    ds_read_b64_tr_b16 v[142:143], v148 offset:5144
    ds_read_b64_tr_b16 v[144:145], v148 offset:32
    ds_read_b64_tr_b16 v[146:147], v148 offset:5152
    v_mul_u32_u24 v150, 245760, v150
    v_lshl_add_u32 v150, v149, 8, v150
    v_lshl_add_u32 v150, v2, 4, v150
    s_lshr_b32 s46, s37, 1
    s_lshl3_add_u32 s46, s46, s37
    s_lshl_b32 s46, s46, 9
    s_mul_i32 s47, s32, 491520
    s_add_u32 s46, s46, s47
    s_add_u32 s47, s46, 29548544
    s_add_u32 s48, s46, 29552640
    s_waitcnt lgkmcnt(8)
    buffer_store_dwordx4 v[128:131], v150, s[24:27], s47 offen offset:0 sc1
    s_waitcnt lgkmcnt(6)
    buffer_store_dwordx4 v[132:135], v150, s[24:27], s47 offen offset:1024 sc1
    s_waitcnt lgkmcnt(4)
    buffer_store_dwordx4 v[136:139], v150, s[24:27], s47 offen offset:2048 sc1
    s_waitcnt lgkmcnt(2)
    buffer_store_dwordx4 v[140:143], v150, s[24:27], s47 offen offset:3072 sc1
    s_waitcnt lgkmcnt(0)
    buffer_store_dwordx4 v[144:147], v150, s[24:27], s48 offen offset:0 sc1
    s_branch L_gt_40
L_onee0:
L_fw_58:
    s_mov_b32 s42, 65536
L_fl_59:
    v_mov_b32 v18, 0
    buffer_atomic_add v18, v107, s[24:27], s97 offen offset:0 sc0 sc1
    s_sub_u32 s42, s42, 1
    s_waitcnt vmcnt(0)
    s_cbranch_scc1 L_fd_60
    v_cmp_gt_u32 vcc, v108, v18
    s_cbranch_vccnz L_fl_59
    s_branch L_fd_60
L_fw_61:
    s_mov_b32 s42, 65536
L_fl_62:
    v_mov_b32 v18, 0
    buffer_atomic_add v18, v19, s[24:27], s91 offen sc0 sc1
    s_sub_u32 s42, s42, 1
    s_waitcnt vmcnt(0)
    s_cbranch_scc1 L_fd_63
    v_cmp_le_u32 vcc, 536870912, v18
    s_cbranch_vccz L_fl_62
    s_branch L_fd_63
L_fw_64:
    s_mov_b32 s42, 65536
L_fl_65:
    v_mov_b32 v18, 0
    buffer_atomic_add v18, v19, s[24:27], s91 offen sc0 sc1
    s_sub_u32 s42, s42, 1
    s_waitcnt vmcnt(0)
    s_cbranch_scc1 L_fd_66
    v_cmp_le_u32 vcc, 553648128, v18
    s_cbranch_vccz L_fl_65
    s_branch L_fd_66
L_fw_67:
    s_mov_b32 s42, 65536
L_fl_68:
    v_mov_b32 v18, 0
    buffer_atomic_add v18, v19, s[24:27], s91 offen sc0 sc1
    s_sub_u32 s42, s42, 1
    s_waitcnt vmcnt(0)
    s_cbranch_scc1 L_fd_69
    v_cmp_le_u32 vcc, 554172416, v18
    s_cbranch_vccz L_fl_68
    s_branch L_fd_69
L_onet1:
    s_setpc_b64 s[40:41]
L_one1:
    buffer_load_dwordx4 a[80:83], v4, s[24:27], s82 offen offset:2048 sc1
    s_add_u32 s82, s82, 12288
    buffer_load_dwordx4 a[84:87], v4, s[24:27], s83 offen offset:0 sc1
    buffer_load_dwordx4 a[88:91], v4, s[24:27], s83 offen offset:1024 sc1
    buffer_load_dwordx4 a[92:95], v4, s[24:27], s83 offen offset:2048 sc1
    s_add_u32 s83, s83, 12288
    buffer_load_dwordx4 a[96:99], v4, s[24:27], s80 offen offset:0 sc1
    buffer_load_dwordx4 a[100:103], v4, s[24:27], s80 offen offset:1024 sc1
    v_mov_b32 v240, 0x4227c5ac
    s_waitcnt vmcnt(8)
    v_fma_f32 v208, v208, s55, v240
    v_fma_f32 v209, v209, s55, v240
    v_fma_f32 v210, v210, s55, v240
    v_fma_f32 v211, v211, s55, v240
    v_fma_f32 v212, v212, s55, v240
    v_fma_f32 v213, v213, s55, v240
    v_fma_f32 v214, v214, s55, v240
    v_fma_f32 v215, v215, s55, v240
    v_rsq_f32 v208, v208
    v_rsq_f32 v209, v209
    v_rsq_f32 v210, v210
    v_rsq_f32 v211, v211
    v_rsq_f32 v212, v212
    v_rsq_f32 v213, v213
    v_rsq_f32 v214, v214
    v_rsq_f32 v215, v215
    s_cmp_eq_u32 s38, 0
    s_cselect_b32 s56, 0, -1
    s_waitcnt vmcnt(6)
    v_lshlrev_b32 v160, 16, v96
    v_lshlrev_b32 v161, 16, v97
    v_lshlrev_b32 v162, 16, v98
    v_lshlrev_b32 v163, 16, v99
    v_lshlrev_b32 v164, 16, v100
    v_lshlrev_b32 v165, 16, v101
    v_lshlrev_b32 v166, 16, v102
    v_lshlrev_b32 v167, 16, v103
    v_pk_mul_f32 v[240:241], v[160:161], v[208:209]
    v_pk_mul_f32 v[242:243], v[162:163], v[210:211]
    v_pk_mul_f32 v[244:245], v[164:165], v[212:213]
    v_pk_mul_f32 v[246:247], v[166:167], v[214:215]
    v_cvt_pk_bf16_f32 v224, v240, v241
    v_cvt_pk_bf16_f32 v225, v242, v243
    v_cvt_pk_bf16_f32 v226, v244, v245
    v_cvt_pk_bf16_f32 v227, v246, v247
    ds_write_b128 v90, v[224:227] offset:0
    v_and_b32 v168, 0xffff0000, v96
    v_and_b32 v169, 0xffff0000, v97
    v_and_b32 v170, 0xffff0000, v98
    v_and_b32 v171, 0xffff0000, v99
    v_and_b32 v172, 0xffff0000, v100
    v_and_b32 v173, 0xffff0000, v101
    v_and_b32 v174, 0xffff0000, v102
    v_and_b32 v175, 0xffff0000, v103
    v_pk_mul_f32 v[240:241], v[168:169], v[208:209]
    v_pk_mul_f32 v[242:243], v[170:171], v[210:211]
    v_pk_mul_f32 v[244:245], v[172:173], v[212:213]
    v_pk_mul_f32 v[246:247], v[174:175], v[214:215]
    v_cvt_pk_bf16_f32 v228, v240, v241
    v_cvt_pk_bf16_f32 v229, v242, v243
    v_cvt_pk_bf16_f32 v230, v244, v245
    v_cvt_pk_bf16_f32 v231, v246, v247
    v_and_b32 v228, s56, v228
    v_and_b32 v229, s56, v229
    v_and_b32 v230, s56, v230
    v_and_b32 v231, s56, v231
    ds_write_b128 v90, v[228:231] offset:4096
    s_waitcnt lgkmcnt(0)
    s_barrier
    ds_read_b64_tr_b16 v[128:129], v88 offset:0
    ds_read_b64_tr_b16 v[130:131], v88 offset:1024
    ds_read_b64_tr_b16 v[144:145], v88 offset:4096
    ds_read_b64_tr_b16 v[146:147], v88 offset:5120
    ds_read_b64_tr_b16 v[136:137], v88 offset:2048
    ds_read_b64_tr_b16 v[138:139], v88 offset:3072
    ds_read_b64_tr_b16 v[152:153], v88 offset:6144
    ds_read_b64_tr_b16 v[154:155], v88 offset:7168
    ds_read_b64_tr_b16 v[132:133], v89 offset:0
    ds_read_b64_tr_b16 v[134:135], v89 offset:1024
    ds_read_b64_tr_b16 v[148:149], v89 offset:4096
    ds_read_b64_tr_b16 v[150:151], v89 offset:5120
    ds_read_b64_tr_b16 v[140:141], v89 offset:2048
    ds_read_b64_tr_b16 v[142:143], v89 offset:3072
    ds_read_b64_tr_b16 v[156:157], v89 offset:6144
    s_waitcnt lgkmcnt(11)
    ds_read_b64_tr_b16 v[158:159], v89 offset:7168
    buffer_load_dwordx4 a[104:107], v4, s[24:27], s80 offen offset:2048 sc1
    s_add_u32 s80, s80, 12288
    buffer_load_dwordx4 a[108:111], v4, s[24:27], s81 offen offset:0 sc1
    buffer_load_dwordx4 a[112:115], v4, s[24:27], s81 offen offset:1024 sc1
    v_mfma_f32_16x16x32_bf16 v[192:195], v[128:131], v[8:11], 0
    v_lshlrev_b32 v176, 16, v112
    v_and_b32 v177, 0xffff0000, v112
    v_mfma_f32_16x16x32_bf16 v[192:195], v[144:147], v[16:19], v[192:195]
    v_lshlrev_b32 v178, 16, v113
    v_and_b32 v179, 0xffff0000, v113
    buffer_load_dwordx4 a[116:119], v4, s[24:27], s81 offen offset:2048 sc1
    s_add_u32 s81, s81, 12288
    v_mfma_f32_16x16x32_bf16 v[200:203], v[144:147], v[8:11], 0
    v_lshlrev_b32 v180, 16, v114
    v_and_b32 v181, 0xffff0000, v114
    v_mfma_f32_16x16x32_bf16 v[200:203], v[128:131], v[24:27], v[200:203]
    v_lshlrev_b32 v182, 16, v115
    v_and_b32 v183, 0xffff0000, v115
    s_waitcnt lgkmcnt(8)
    v_mfma_f32_16x16x32_bf16 v[192:195], v[136:139], v[12:15], v[192:195]
    buffer_load_dwordx4 a[120:123], v4, s[24:27], s82 offen offset:0 sc1
    v_lshlrev_b32 v184, 16, v116
    v_mfma_f32_16x16x32_bf16 v[192:195], v[152:155], v[20:23], v[192:195]
    v_and_b32 v185, 0xffff0000, v116
    v_lshlrev_b32 v186, 16, v117
    v_mfma_f32_16x16x32_bf16 v[200:203], v[152:155], v[12:15], v[200:203]
    v_and_b32 v187, 0xffff0000, v117
    buffer_load_dwordx4 a[124:127], v4, s[24:27], s82 offen offset:1024 sc1
    v_mfma_f32_16x16x32_bf16 v[200:203], v[136:139], v[28:31], v[200:203]
    v_lshlrev_b32 v188, 16, v118
    v_and_b32 v189, 0xffff0000, v118
    s_waitcnt lgkmcnt(4)
    v_mfma_f32_16x16x32_bf16 v[196:199], v[132:135], v[8:11], 0
    v_lshlrev_b32 v190, 16, v119
    v_and_b32 v191, 0xffff0000, v119
    v_mfma_f32_16x16x32_bf16 v[196:199], v[148:151], v[16:19], v[196:199]
    v_mul_f32 v240, v192, v56
    v_mul_f32 v241, v193, v57
    v_mul_f32 v242, v194, v58
    v_mfma_f32_16x16x32_bf16 v[204:207], v[148:151], v[8:11], 0
    v_mul_f32 v243, v195, v59
    v_fmac_f32 v240, v200, v64
    v_fmac_f32 v241, v201, v65
    v_mfma_f32_16x16x32_bf16 v[204:207], v[132:135], v[24:27], v[204:207]
    v_fmac_f32 v242, v202, v66
    v_fmac_f32 v243, v203, v67
    s_waitcnt lgkmcnt(0)
    v_mfma_f32_16x16x32_bf16 v[196:199], v[140:143], v[12:15], v[196:199]
    v_mul_f32 v200, v200, v56
    v_mul_f32 v201, v201, v57
    v_mfma_f32_16x16x32_bf16 v[196:199], v[156:159], v[20:23], v[196:199]
    v_mul_f32 v202, v202, v58
    v_mul_f32 v203, v203, v59
    v_mfma_f32_16x16x32_bf16 v[204:207], v[156:159], v[12:15], v[204:207]
    v_fma_f32 v200, -v192, v64, v200
    v_fma_f32 v201, -v193, v65, v201
    v_mfma_f32_16x16x32_bf16 v[204:207], v[140:143], v[28:31], v[204:207]
    v_fma_f32 v202, -v194, v66, v202
    v_fma_f32 v203, -v195, v67, v203
    v_cvt_pk_bf16_f32 v224, v240, v241
    v_cvt_pk_bf16_f32 v228, v200, v201
    v_cvt_pk_bf16_f32 v225, v242, v243
    v_cvt_pk_bf16_f32 v229, v202, v203
    buffer_load_dwordx4 a[128:131], v4, s[24:27], s82 offen offset:2048 sc1
    s_add_u32 s82, s82, 12288
    buffer_load_dwordx4 a[132:135], v4, s[24:27], s83 offen offset:0 sc1
    buffer_load_dwordx4 a[136:139], v4, s[24:27], s83 offen offset:1024 sc1
    v_pk_mul_f32 v[244:245], v[196:197], v[60:61]
    v_pk_mul_f32 v[246:247], v[198:199], v[62:63]
    v_pk_fma_f32 v[244:245], v[204:205], v[68:69], v[244:245]
    v_pk_fma_f32 v[246:247], v[206:207], v[70:71], v[246:247]
    v_pk_mul_f32 v[204:205], v[204:205], v[60:61]
    v_pk_mul_f32 v[206:207], v[206:207], v[62:63]
    v_pk_fma_f32 v[204:205], v[196:197], v[68:69], v[204:205] neg_lo:[1,0,0] neg_hi:[1,0,0]
    v_pk_fma_f32 v[206:207], v[198:199], v[70:71], v[206:207] neg_lo:[1,0,0] neg_hi:[1,0,0]
    s_branch L_pgx14
L_pg14:
    s_setpc_b64 s[40:41]
L_pgx14:
    v_cvt_pk_bf16_f32 v226, v244, v245
    v_cvt_pk_bf16_f32 v230, v204, v205
    v_cvt_pk_bf16_f32 v227, v246, v247
    v_cvt_pk_bf16_f32 v231, v206, v207
    s_nop 0
    v_mfma_f32_16x16x32_bf16 v[192:195], v[32:35], v[224:227], 0
    buffer_load_dwordx4 a[140:143], v4, s[24:27], s83 offen offset:2048 sc1
    s_add_u32 s83, s83, 12288
    v_mfma_f32_16x16x32_bf16 v[192:195], v[40:43], v[228:231], v[192:195]
    buffer_load_dwordx4 a[144:147], v4, s[24:27], s80 offen offset:0 sc1
    v_mfma_f32_16x16x32_bf16 v[200:203], v[32:35], v[228:231], 0
    v_mfma_f32_16x16x32_bf16 v[200:203], v[48:51], v[224:227], v[200:203]
    v_mfma_f32_16x16x32_bf16 v[196:199], v[36:39], v[224:227], 0
    v_mfma_f32_16x16x32_bf16 v[196:199], v[44:47], v[228:231], v[196:199]
    s_nop 2
    v_mul_f32 v240, v192, v176
    v_mul_f32 v241, v193, v177
    s_nop 0
    v_fma_f32 v240, -v200, v184, v240
    v_mfma_f32_16x16x32_bf16 v[204:207], v[36:39], v[228:231], 0
    v_fma_f32 v241, -v201, v185, v241
    v_mul_f32 v200, v200, v176
    v_mul_f32 v201, v201, v177
    v_mfma_f32_16x16x32_bf16 v[204:207], v[52:55], v[224:227], v[204:207]
    v_fmac_f32 v200, v192, v184
    v_fmac_f32 v201, v193, v185
    v_cvt_pk_bf16_f32 v232, v240, v241
    v_cvt_pk_bf16_f32 v236, v200, v201
    buffer_load_dwordx4 a[148:151], v4, s[24:27], s80 offen offset:1024 sc1
    buffer_load_dwordx4 a[152:155], v4, s[24:27], s80 offen offset:2048 sc1
    s_add_u32 s80, s80, 12288
    v_pk_mul_f32 v[242:243], v[194:195], v[178:179]
    v_pk_mul_f32 v[244:245], v[196:197], v[180:181]
    v_pk_mul_f32 v[246:247], v[198:199], v[182:183]
    v_pk_fma_f32 v[242:243], v[202:203], v[186:187], v[242:243] neg_lo:[1,0,0] neg_hi:[1,0,0]
    v_pk_fma_f32 v[244:245], v[204:205], v[188:189], v[244:245] neg_lo:[1,0,0] neg_hi:[1,0,0]
    v_pk_fma_f32 v[246:247], v[206:207], v[190:191], v[246:247] neg_lo:[1,0,0] neg_hi:[1,0,0]
    v_pk_mul_f32 v[202:203], v[202:203], v[178:179]
    v_pk_mul_f32 v[204:205], v[204:205], v[180:181]
    v_pk_mul_f32 v[206:207], v[206:207], v[182:183]
    v_pk_fma_f32 v[202:203], v[194:195], v[186:187], v[202:203]
    v_pk_fma_f32 v[204:205], v[196:197], v[188:189], v[204:205]
    v_pk_fma_f32 v[206:207], v[198:199], v[190:191], v[206:207]
    v_cvt_pk_bf16_f32 v233, v242, v243
    v_cvt_pk_bf16_f32 v237, v202, v203
    v_cvt_pk_bf16_f32 v234, v244, v245
    v_cvt_pk_bf16_f32 v238, v204, v205
    v_cvt_pk_bf16_f32 v235, v246, v247
    v_cvt_pk_bf16_f32 v239, v206, v207
    s_nop 0
    v_mfma_f32_16x16x32_bf16 v[192:195], v[232:235], v[32:35], 0
    buffer_load_dwordx4 a[156:159], v4, s[24:27], s81 offen offset:0 sc1
    v_mfma_f32_16x16x32_bf16 v[192:195], v[236:239], v[48:51], v[192:195]
    buffer_load_dwordx4 a[160:163], v4, s[24:27], s81 offen offset:1024 sc1
    v_mfma_f32_16x16x32_bf16 v[200:203], v[236:239], v[32:35], 0
    v_mfma_f32_16x16x32_bf16 v[200:203], v[232:235], v[40:43], v[200:203]
    v_mfma_f32_16x16x32_bf16 v[196:199], v[232:235], v[36:39], 0
    v_mfma_f32_16x16x32_bf16 v[196:199], v[236:239], v[52:55], v[196:199]
    s_nop 2
    v_mul_f32 v240, v192, v72
    v_mul_f32 v241, v193, v73
    s_nop 0
    v_fma_f32 v240, -v200, v80, v240
    v_mfma_f32_16x16x32_bf16 v[204:207], v[236:239], v[36:39], 0
    v_fma_f32 v241, -v201, v81, v241
    v_mul_f32 v200, v200, v72
    v_mul_f32 v201, v201, v73
    v_mfma_f32_16x16x32_bf16 v[204:207], v[232:235], v[44:47], v[204:207]
    v_fmac_f32 v200, v192, v80
    v_fmac_f32 v201, v193, v81
    v_cvt_pk_bf16_f32 v224, v240, v241
    v_cvt_pk_bf16_f32 v228, v200, v201
    v_pk_mul_f32 v[242:243], v[194:195], v[74:75]
    v_pk_mul_f32 v[244:245], v[196:197], v[76:77]
    v_pk_mul_f32 v[246:247], v[198:199], v[78:79]
    v_pk_fma_f32 v[242:243], v[202:203], v[82:83], v[242:243] neg_lo:[1,0,0] neg_hi:[1,0,0]
    v_pk_fma_f32 v[244:245], v[204:205], v[84:85], v[244:245] neg_lo:[1,0,0] neg_hi:[1,0,0]
    v_pk_fma_f32 v[246:247], v[206:207], v[86:87], v[246:247] neg_lo:[1,0,0] neg_hi:[1,0,0]
    v_pk_mul_f32 v[202:203], v[202:203], v[74:75]
    v_pk_mul_f32 v[204:205], v[204:205], v[76:77]
    v_pk_mul_f32 v[206:207], v[206:207], v[78:79]
    v_pk_fma_f32 v[202:203], v[194:195], v[82:83], v[202:203]
    v_pk_fma_f32 v[204:205], v[196:197], v[84:85], v[204:205]
    v_pk_fma_f32 v[206:207], v[198:199], v[86:87], v[206:207]
    v_cvt_pk_bf16_f32 v225, v242, v243
    v_cvt_pk_bf16_f32 v229, v202, v203
    ds_write_b64 v91, v[224:225] offset:16384
    ds_write_b64 v91, v[228:229] offset:20992
    v_cvt_pk_bf16_f32 v226, v244, v245
    v_cvt_pk_bf16_f32 v230, v204, v205
    v_cvt_pk_bf16_f32 v227, v246, v247
    v_cvt_pk_bf16_f32 v231, v206, v207
    ds_write_b64 v91, v[226:227] offset:18688
    ds_write_b64 v91, v[230:231] offset:23296
    buffer_load_dwordx4 a[164:167], v4, s[24:27], s81 offen offset:2048 sc1
    s_add_u32 s81, s81, 12288
    buffer_load_dwordx4 a[168:171], v4, s[24:27], s82 offen offset:0 sc1
    s_waitcnt lgkmcnt(0)
    s_barrier
    ds_read_b128 v[128:131], v92 offset:16384
    ds_read_b128 v[144:147], v92 offset:20992
    ds_read_b128 v[136:139], v92 offset:16448
    ds_read_b128 v[152:155], v92 offset:21056
    ds_read_b128 v[132:135], v92 offset:16960
    ds_read_b128 v[148:151], v92 offset:21568
    ds_read_b128 v[140:143], v92 offset:17024
    ds_read_b128 v[156:159], v92 offset:21632
    buffer_load_dwordx4 a[172:175], v4, s[24:27], s82 offen offset:1024 sc1
    buffer_load_dwordx4 a[176:179], v4, s[24:27], s82 offen offset:2048 sc1
    s_add_u32 s82, s82, 12288
    v_cvt_pk_bf16_f32 v240, v168, v169
    v_cvt_pk_bf16_f32 v241, v170, v171
    v_cvt_pk_bf16_f32 v242, v172, v173
    v_cvt_pk_bf16_f32 v243, v174, v175
    s_waitcnt lgkmcnt(6)
    v_mfma_f32_16x16x32_bf16 v[192:195], v[128:131], v[8:11], v[160:163]
    buffer_load_dwordx4 a[180:183], v4, s[24:27], s83 offen offset:0 sc1
    v_mfma_f32_16x16x32_bf16 v[192:195], v[144:147], v[24:27], v[192:195]
    s_waitcnt lgkmcnt(4)
    v_mfma_f32_16x16x32_bf16 v[192:195], v[136:139], v[12:15], v[192:195]
    v_mfma_f32_16x16x32_bf16 v[192:195], v[152:155], v[28:31], v[192:195]
    s_waitcnt lgkmcnt(2)
    v_mfma_f32_16x16x32_bf16 v[196:199], v[132:135], v[8:11], v[164:167]
    v_mfma_f32_16x16x32_bf16 v[196:199], v[148:151], v[24:27], v[196:199]
    s_waitcnt lgkmcnt(0)
    v_mfma_f32_16x16x32_bf16 v[196:199], v[140:143], v[12:15], v[196:199]
    v_mfma_f32_16x16x32_bf16 v[196:199], v[156:159], v[28:31], v[196:199]
    v_mfma_f32_16x16x32_bf16 v[200:203], v[144:147], v[8:11], v[168:171]
    v_mfma_f32_16x16x32_bf16 v[200:203], v[128:131], v[16:19], v[200:203]
    v_mfma_f32_16x16x32_bf16 v[200:203], v[152:155], v[12:15], v[200:203]
    v_cvt_pk_bf16_f32 v224, v192, v193
    v_cvt_pk_bf16_f32 v225, v194, v195
    v_mfma_f32_16x16x32_bf16 v[200:203], v[136:139], v[20:23], v[200:203]
    s_nop 1
    v_cvt_pk_bf16_f32 v226, v196, v197
    v_mfma_f32_16x16x32_bf16 v[204:207], v[148:151], v[8:11], v[172:175]
    v_cvt_pk_bf16_f32 v227, v198, v199
    v_mfma_f32_16x16x32_bf16 v[204:207], v[132:135], v[16:19], v[204:207]
    buffer_store_dwordx4 v[224:227], v248, s[24:27], s58 offen offset:0 sc1
    v_mfma_f32_16x16x32_bf16 v[204:207], v[156:159], v[12:15], v[204:207]
    v_cvt_pk_bf16_f32 v228, v200, v201
    v_mfma_f32_16x16x32_bf16 v[204:207], v[140:143], v[20:23], v[204:207]
    v_cvt_pk_bf16_f32 v229, v202, v203
    v_bfi_b32 v228, s56, v228, v240
    v_bfi_b32 v229, s56, v229, v241
    s_nop 4
    v_cvt_pk_bf16_f32 v230, v204, v205
    v_cvt_pk_bf16_f32 v231, v206, v207
    v_bfi_b32 v230, s56, v230, v242
    v_bfi_b32 v231, s56, v231, v243
    buffer_store_dwordx4 v[228:231], v248, s[24:27], s58 offen offset:1024 sc1
    s_branch L_join_73
L_onee1:
L_fw_91:
    s_mov_b32 s42, 65536
L_fl_92:
    v_mov_b32 v18, 0
    buffer_atomic_add v18, v107, s[24:27], s97 offen offset:4 sc0 sc1
    s_sub_u32 s42, s42, 1
    s_waitcnt vmcnt(0)
    s_cbranch_scc1 L_fd_93
    v_cmp_gt_u32 vcc, v108, v18
    s_cbranch_vccnz L_fl_92
    s_branch L_fd_93
L_fw_94:
    s_mov_b32 s42, 65536
L_fl_95:
    v_mov_b32 v18, 0
    buffer_atomic_add v18, v19, s[24:27], s91 offen sc0 sc1
    s_sub_u32 s42, s42, 1
    s_waitcnt vmcnt(0)
    s_cbranch_scc1 L_fd_96
    v_cmp_le_u32 vcc, 554188800, v18
    s_cbranch_vccz L_fl_95
    s_branch L_fd_96
L_fw_97:
    s_mov_b32 s42, 65536
L_fl_98:
    v_mov_b32 v18, 0
    buffer_atomic_add v18, v19, s[24:27], s91 offen sc0 sc1
    s_sub_u32 s42, s42, 1
    s_waitcnt vmcnt(0)
    s_cbranch_scc1 L_fd_99
    v_cmp_le_u32 vcc, 554189312, v18
    s_cbranch_vccz L_fl_98
    s_branch L_fd_99
L_fw_100:
    s_mov_b32 s42, 65536
L_fl_101:
    v_mov_b32 v18, 0
    buffer_atomic_add v18, v19, s[24:27], s91 offen sc0 sc1
    s_sub_u32 s42, s42, 1
    s_waitcnt vmcnt(0)
    s_cbranch_scc1 L_fd_102
    v_cmp_le_u32 vcc, 554189328, v18
    s_cbranch_vccz L_fl_101
    s_branch L_fd_102
L_m4:
L_fftt:
    s_setpc_b64 s[40:41]
L_fftc:
    v_lshlrev_b32 v252, 2, v3
    v_cvt_f32_u32 v252, v252
    v_cvt_f32_u32 v254, v2
    s_lshl_b32 s46, s32, 4
    v_add_u32 v248, s46, v2
    v_cvt_f32_u32 v72, v248
    s_mov_b32 s47, 0x80008000
    v_mul_f32 v253, 0x3c800000, v72
    v_mul_f32 v240, v253, v252
    v_add_f32 v241, v240, v253
    v_fma_f32 v242, v253, 2.0, v240
    v_fma_f32 v243, v253, 2.0, v241
    v_mul_f32 v248, 0x41800000, v253
    v_add_f32 v244, v240, v248
    v_add_f32 v245, v241, v248
    v_add_f32 v246, v242, v248
    v_add_f32 v247, v243, v248
    v_cos_f32 v248, v240
    v_cos_f32 v249, v241
    v_sin_f32 v250, v240
    v_sin_f32 v251, v241
    v_cvt_pk_bf16_f32 v8, v248, v249
    v_cvt_pk_bf16_f32 v16, v250, v251
    v_cos_f32 v248, v242
    v_cos_f32 v249, v243
    v_sin_f32 v250, v242
    v_sin_f32 v251, v243
    v_cvt_pk_bf16_f32 v9, v248, v249
    v_cvt_pk_bf16_f32 v17, v250, v251
    v_cos_f32 v248, v244
    v_cos_f32 v249, v245
    v_sin_f32 v250, v244
    v_sin_f32 v251, v245
    v_cvt_pk_bf16_f32 v10, v248, v249
    v_cvt_pk_bf16_f32 v18, v250, v251
    v_cos_f32 v248, v246
    v_cos_f32 v249, v247
    v_sin_f32 v250, v246
    v_sin_f32 v251, v247
    v_cvt_pk_bf16_f32 v11, v248, v249
    v_cvt_pk_bf16_f32 v19, v250, v251
    v_and_b32 v248, 1, v2
    v_mul_lo_u32 v248, v248, s47
    v_xor_b32 v12, v248, v8
    v_xor_b32 v20, v248, v16
    v_xor_b32 v13, v248, v9
    v_xor_b32 v21, v248, v17
    v_xor_b32 v14, v248, v10
    v_xor_b32 v22, v248, v18
    v_xor_b32 v15, v248, v11
    v_xor_b32 v23, v248, v19
    v_xor_b32 v24, s47, v16
    v_xor_b32 v25, s47, v17
    v_xor_b32 v26, s47, v18
    v_xor_b32 v27, s47, v19
    v_xor_b32 v28, s47, v20
    v_xor_b32 v29, s47, v21
    v_xor_b32 v30, s47, v22
    v_xor_b32 v31, s47, v23
    v_mul_f32 v253, 0x3a000000, v72
    v_mul_f32 v240, v253, v252
    v_add_f32 v241, v240, v253
    v_fma_f32 v242, v253, 2.0, v240
    v_fma_f32 v243, v253, 2.0, v241
    v_mul_f32 v248, 0x41800000, v253
    v_add_f32 v244, v240, v248
    v_add_f32 v245, v241, v248
    v_add_f32 v246, v242, v248
    v_add_f32 v247, v243, v248
    v_cos_f32 v56, v240
    v_sin_f32 v64, v240
    v_cos_f32 v57, v241
    v_sin_f32 v65, v241
    v_cos_f32 v58, v242
    v_sin_f32 v66, v242
    v_cos_f32 v59, v243
    v_sin_f32 v67, v243
    v_cos_f32 v60, v244
    v_sin_f32 v68, v244
    v_cos_f32 v61, v245
    v_sin_f32 v69, v245
    v_cos_f32 v62, v246
    v_sin_f32 v70, v246
    v_cos_f32 v63, v247
    v_sin_f32 v71, v247
    v_mul_f32 v253, 0x3d000000, v254
    v_mul_f32 v240, v253, v252
    v_add_f32 v241, v240, v253
    v_fma_f32 v242, v253, 2.0, v240
    v_fma_f32 v243, v253, 2.0, v241
    v_mul_f32 v248, 0x41800000, v253
    v_add_f32 v244, v240, v248
    v_add_f32 v245, v241, v248
    v_add_f32 v246, v242, v248
    v_add_f32 v247, v243, v248
    v_cos_f32 v248, v240
    v_cos_f32 v249, v241
    v_sin_f32 v250, v240
    v_sin_f32 v251, v241
    v_cvt_pk_bf16_f32 v32, v248, v249
    v_cvt_pk_bf16_f32 v40, v250, v251
    v_cos_f32 v248, v242
    v_cos_f32 v249, v243
    v_sin_f32 v250, v242
    v_sin_f32 v251, v243
    v_cvt_pk_bf16_f32 v33, v248, v249
    v_cvt_pk_bf16_f32 v41, v250, v251
    v_cos_f32 v248, v244
    v_cos_f32 v249, v245
    v_sin_f32 v250, v244
    v_sin_f32 v251, v245
    v_cvt_pk_bf16_f32 v34, v248, v249
    v_cvt_pk_bf16_f32 v42, v250, v251
    v_cos_f32 v248, v246
    v_cos_f32 v249, v247
    v_sin_f32 v250, v246
    v_sin_f32 v251, v247
    v_cvt_pk_bf16_f32 v35, v248, v249
    v_cvt_pk_bf16_f32 v43, v250, v251
    v_xor_b32 v36, 0x80000000, v32
    v_xor_b32 v44, 0x80000000, v40
    v_xor_b32 v37, 0x80000000, v33
    v_xor_b32 v45, 0x80000000, v41
    v_xor_b32 v38, 0x80000000, v34
    v_xor_b32 v46, 0x80000000, v42
    v_xor_b32 v39, 0x80000000, v35
    v_xor_b32 v47, 0x80000000, v43
    v_xor_b32 v48, s47, v40
    v_xor_b32 v49, s47, v41
    v_xor_b32 v50, s47, v42
    v_xor_b32 v51, s47, v43
    v_xor_b32 v52, s47, v44
    v_xor_b32 v53, s47, v45
    v_xor_b32 v54, s47, v46
    v_xor_b32 v55, s47, v47
    v_cvt_f32_u32 v248, s46
    v_add_f32 v248, v248, v252
    v_mul_f32 v253, 0x3a000000, v254
    v_mul_f32 v240, v253, v248
    v_add_f32 v241, v240, v253
    v_fma_f32 v242, v253, 2.0, v240
    v_fma_f32 v243, v253, 2.0, v241
    v_mul_f32 v253, 0x3a000000, v254
    v_add_f32 v253, 0x3c000000, v253
    v_mul_f32 v244, v253, v248
    v_add_f32 v245, v244, v253
    v_fma_f32 v246, v253, 2.0, v244
    v_fma_f32 v247, v253, 2.0, v245
    v_cos_f32 v72, v240
    v_sin_f32 v80, v240
    v_cos_f32 v73, v241
    v_sin_f32 v81, v241
    s_nop 1
    s_setpc_b64 s[40:41]
L_fftd:
    v_cos_f32 v74, v242
    v_sin_f32 v82, v242
    v_cos_f32 v75, v243
    v_sin_f32 v83, v243
    v_cos_f32 v76, v244
    v_sin_f32 v84, v244
    v_cos_f32 v77, v245
    v_sin_f32 v85, v245
    v_cos_f32 v78, v246
    v_sin_f32 v86, v246
    v_cos_f32 v79, v247
    v_sin_f32 v87, v247
    s_lshl_b32 s48, s32, 10
    v_lshrrev_b32 v248, 1, v2
    v_and_b32 v248, 2, v248
    v_xor_b32 v248, v248, v3
    v_lshlrev_b32 v248, 4, v248
    v_lshl_add_u32 v248, v2, 6, v248
    v_add_u32 v90, s48, v248
    v_lshrrev_b32 v248, 2, v1
    v_lshlrev_b32 v248, 6, v248
    v_and_b32 v249, 3, v1
    v_lshl_add_u32 v248, v249, 3, v248
    v_and_b32 v249, 1, v3
    v_lshl_add_u32 v88, v249, 5, v248
    v_xor_b32 v89, 32, v88
    s_lshr_b32 s48, s32, 1
    s_lshl_b32 s48, s48, 6
    s_and_b32 s49, s32, 1
    s_lshl_b32 s49, s49, 3
    s_add_u32 s48, s48, s49
    v_mul_u32_u24 v91, 144, v2
    v_lshl_add_u32 v91, v3, 4, v91
    v_add_u32 v91, s48, v91
    v_and_b32 v248, 12, v2
    v_add_u32 v248, v248, v2
    v_mul_u32_u24 v248, 144, v248
    v_lshl_add_u32 v92, v3, 4, v248
    s_nop 1
    s_setpc_b64 s[40:41]
    s_endpgm
    s_endpgm
    s_endpgm
    s_endpgm
    s_endpgm
    s_endpgm
    s_endpgm
    s_endpgm
    s_endpgm
    s_endpgm
    s_endpgm
    s_endpgm
    s_endpgm
    s_endpgm
    s_endpgm
    s_endpgm
    s_endpgm
    s_endpgm
    s_endpgm
    s_endpgm
    s_endpgm
    s_endpgm
    s_endpgm
    s_endpgm
    s_endpgm
    s_endpgm
    s_endpgm
    s_endpgm
    s_endpgm
    s_endpgm
    s_endpgm
    s_endpgm
    s_endpgm
    s_endpgm
    s_endpgm
    s_endpgm
    s_endpgm
    s_endpgm
    s_endpgm
    s_endpgm
    s_endpgm
    s_endpgm
    s_endpgm
    s_endpgm
    s_endpgm
    s_endpgm
    s_endpgm
    s_endpgm
    s_endpgm
    s_endpgm
    s_endpgm
    s_endpgm
    s_endpgm
    s_endpgm
    s_endpgm
    s_endpgm
    s_endpgm
    s_endpgm
    s_endpgm
    s_endpgm
    s_endpgm
    s_endpgm
    s_endpgm
    s_endpgm
    s_endpgm
    s_endpgm
    s_endpgm
    s_endpgm
    s_endpgm
    s_endpgm
    s_endpgm
    s_endpgm
    s_endpgm
    s_endpgm
    s_endpgm
    s_endpgm
    s_endpgm
    s_endpgm
    s_endpgm
    s_endpgm
    s_endpgm
    s_endpgm
    s_endpgm
    s_endpgm
    s_endpgm
    s_endpgm
    s_endpgm
    s_endpgm
    s_endpgm
    s_endpgm
    s_endpgm
    s_endpgm
    s_endpgm
    s_endpgm
    s_endpgm
    s_endpgm
    s_endpgm
    s_endpgm
    s_endpgm
    s_endpgm
    s_endpgm
    s_endpgm
    s_endpgm
    s_endpgm
    s_endpgm
    s_endpgm
    s_endpgm
    s_endpgm
    s_endpgm
    s_endpgm
    s_endpgm
    s_endpgm
    s_endpgm
    s_endpgm
    s_endpgm
    s_endpgm
    s_endpgm
    s_endpgm
    s_endpgm
    s_endpgm
    s_endpgm
    s_endpgm
    s_endpgm
    s_endpgm
    s_endpgm
    s_endpgm
    s_endpgm
    s_endpgm
L_text_end:
.section .rodata,"a"
.p2align 6
.amdhsa_kernel interleave_layers__spectral_gfnet__glu_gated_reglu__prompt_kernel
  .amdhsa_next_free_vgpr 512
  .amdhsa_next_free_sgpr 102
  .amdhsa_accum_offset 256
  .amdhsa_group_segment_fixed_size 0
  .amdhsa_kernarg_size 80
  .amdhsa_user_sgpr_count 2
  .amdhsa_user_sgpr_kernarg_segment_ptr 1
  .amdhsa_system_sgpr_workgroup_id_x 1
  .amdhsa_float_denorm_mode_32 3
.end_amdhsa_kernel
```
